```python
import torch

def _softmax(x, axis=-1):
    return torch.softmax(x, dim=axis)
def _gelu(x):
    return torch.nn.functional.gelu(x, approximate="tanh")
def _silu(x):
    return torch.nn.functional.silu(x)
def _sigmoid(x):
    return torch.sigmoid(x)
def _layernorm(x, axis=-1, eps=1e-5):
    m = x.mean(dim=axis, keepdim=True)
    v = x.var(dim=axis, keepdim=True, unbiased=False)
    return (x - m) / torch.sqrt(v + eps)
def _scatter_add(tgt, idx, src, axis=0):
    return tgt.clone().index_add_(axis, idx, src)
def _segment_sum(src, seg, n):
    out = torch.zeros((n,) + src.shape[1:], dtype=src.dtype)
    return out.index_add_(0, seg, src)
def _pad(x, pw):
    flat = tuple(v for pair in reversed(pw) for v in pair)
    return torch.nn.functional.pad(x, flat)

kernel_name = 'sequential_preLN__mha_block__mixer_token_mlp__prompt'

def setup_inputs():

    _w = (lambda a: (lambda t: t.to(torch.bfloat16) if t.is_floating_point() else t)(torch.as_tensor(a)))
    def _A_setup():
        B, S, D, H = 1, 2048, 512, 32
        return {
            "x": _w((lambda *s: torch.randn(*s, dtype=torch.bfloat16) * 0.05)(B, S, D)),
            "wqkv": _w((lambda *s: torch.randn(*s, dtype=torch.bfloat16) * 0.05)(D, 3 * D)),
            "wo": _w((lambda *s: torch.randn(*s, dtype=torch.bfloat16) * 0.05)(D, D)),
        }
    _A_in = _A_setup()

    def _B_setup():
        B, S, D, F = 1, 2048, 512, 1376
        return {
            "x": _w((lambda *s: torch.randn(*s, dtype=torch.bfloat16) * 0.05)(B, S, D)),
            "w1": _w((lambda *s: torch.randn(*s, dtype=torch.bfloat16) * 0.8)(S, F) * (S ** -0.5)),
            "b1": _w((lambda *s: torch.randn(*s, dtype=torch.bfloat16) * 12.8)(F) * 0.02),
            "w2": _w((lambda *s: torch.randn(*s, dtype=torch.bfloat16) * 0.2)(F, S) * (F ** -0.5)),
            "b2": _w((lambda *s: torch.randn(*s, dtype=torch.bfloat16) * 3.2)(S) * 0.02),
        }
    _B_in = _B_setup()

    return {
        "A_x": _A_in["x"],
        "A_wqkv": _A_in["wqkv"],
        "A_wo": _A_in["wo"],
        "B_x": _B_in["x"],
        "B_w1": _B_in["w1"],
        "B_b1": _B_in["b1"],
        "B_w2": _B_in["w2"],
        "B_b2": _B_in["b2"],
    }

def reference(A_x, A_wqkv, A_wo, B_x, B_w1, B_b1, B_w2, B_b2):
    def _A_ref(x, wqkv, wo):
        B, S, D = x.shape
        H = 32
        Dh = D // H
        qkv = (lambda x, *d: x.permute(*d))((x @ wqkv).reshape(B, S, 3, H, Dh), 2, 0, 3, 1, 4)
        q, k, v = qkv[0], qkv[1], qkv[2]
        scores = torch.einsum("bhqd,bhkd->bhqk", q, k) * (Dh ** -0.5)
        p = _softmax(scores, axis=-1)
        o = torch.einsum("bhqk,bhkd->bhqd", p, v)
        return (lambda x, *d: x.permute(*d))(o, 0, 2, 1, 3).reshape(B, S, D) @ wo

    def _B_ref(x, w1, b1, w2, b2):
        B, S, D = x.shape
        h = _layernorm(x, axis=-1)
        u = torch.einsum("bsd,sf->bdf", h, w1) + b1
        u = _gelu(u)
        y = torch.einsum("bdf,fs->bds", u, w2) + b2
        return (lambda x, *d: x.permute(*d))(y, 0, 2, 1)

    x = A_x
    h = x + _A_ref(_layernorm(x, axis=-1), A_wqkv, A_wo)
    h2 = h + _B_ref(_layernorm(h, axis=-1), B_w1, B_b1, B_w2, B_b2)
    return h2
```

```asm
; @launch grid=(256,1,1) block=(256,1,1) lds=163840
.amdgcn_target "amdgcn-amd-amdhsa--gfx950"
.text
.globl sequential_preLN__mha_block__mixer_token_mlp__prompt_kernel
.p2align 8
.type sequential_preLN__mha_block__mixer_token_mlp__prompt_kernel,@function
sequential_preLN__mha_block__mixer_token_mlp__prompt_kernel:
s_cmp_ge_u32 s2, 256
s_cbranch_scc1 L_exit
s_load_dwordx16 s[48:63], s[0:1], 0
s_load_dwordx4 s[64:67], s[0:1], 64
s_load_dwordx2 s[68:69], s[0:1], 80
v_lshrrev_b32 v1, 6, v0
v_and_b32 v0, 63, v0
v_readfirstlane_b32 s3, v1
s_and_b32 s46, s2, 7
s_lshr_b32 s47, s2, 3
v_lshlrev_b32 v6, 4, v0
s_lshr_b32 s96, s46, 1
s_lshl_b32 s96, s96, 2
s_lshr_b32 s97, s47, 3
s_add_u32 s90, s96, s97
s_and_b32 s96, s46, 1
s_lshl_b32 s96, s96, 3
s_and_b32 s97, s47, 7
s_add_u32 s91, s96, s97
s_lshl_b32 s96, s90, 17
s_lshl_b32 s97, s3, 15
s_add_u32 s92, s96, s97
s_mov_b32 s93, 0
s_lshl_b32 s94, s3, 12
s_mul_i32 s95, s3, 3072
s_add_u32 s95, s95, 16384
v_lshrrev_b32 v1, 3, v0
v_lshlrev_b32 v1, 10, v1
v_and_b32 v2, 7, v0
v_lshrrev_b32 v3, 4, v0
v_add_u32 v4, 0, v3
v_xor_b32 v4, v2, v4
v_lshlrev_b32 v4, 4, v4
v_add_u32 v4, v1, v4
v_add_u32 v8, 0, v4
v_add_u32 v4, 4, v3
v_xor_b32 v4, v2, v4
v_lshlrev_b32 v4, 4, v4
v_add_u32 v4, v1, v4
v_add_u32 v9, 7168, v4
v_add_u32 v4, 0, v3
v_xor_b32 v4, v2, v4
v_lshlrev_b32 v4, 4, v4
v_add_u32 v4, v1, v4
v_add_u32 v10, 14336, v4
v_add_u32 v4, 4, v3
v_xor_b32 v4, v2, v4
v_lshlrev_b32 v4, 4, v4
v_add_u32 v4, v1, v4
v_add_u32 v11, 21504, v4
v_lshrrev_b32 v1, 2, v0
s_lshl_b32 s96, s3, 4
v_add_u32 v1, s96, v1
v_mul_u32_u24 v1, 3072, v1
v_and_b32 v2, 3, v0
v_lshlrev_b32 v2, 4, v2
s_lshl_b32 s97, s91, 6
v_add3_u32 v12, v1, v2, s97
s_waitcnt lgkmcnt(0)
s_mov_b32 s8, s48
s_and_b32 s9, s49, 0xffff
s_mov_b32 s10, 0x200000
s_mov_b32 s11, 0x20000
s_mov_b32 s12, s50
s_and_b32 s13, s51, 0xffff
s_mov_b32 s14, 0x180000
s_mov_b32 s15, 0x20000
s_add_u32 m0, s94, 0
s_nop 0
buffer_load_dwordx4 v8, s[8:11], s92 offen offset:0 lds
buffer_load_dwordx4 v9, s[8:11], s92 offen offset:1024 lds
buffer_load_dwordx4 v10, s[8:11], s92 offen offset:2048 lds
buffer_load_dwordx4 v11, s[8:11], s92 offen offset:3072 lds
s_add_u32 s92, s92, 128
s_add_u32 m0, s95, 0
s_nop 0
buffer_load_dwordx4 v12, s[12:15], s93 offen offset:0 lds
buffer_load_dwordx4 v12, s[12:15], s93 offen offset:1024 lds
buffer_load_dwordx4 v12, s[12:15], s93 offen offset:2048 lds
s_add_u32 s93, s93, 196608
s_mov_b32 s40, s68
s_and_b32 s41, s69, 0xffff
s_mov_b32 s42, 0x1000000
s_mov_b32 s43, 0x20000
s_mov_b32 s44, s66
s_mov_b32 s45, s67
s_or_b32 s96, s2, s3
s_cmp_lg_u32 s96, 0
s_cbranch_scc1 L_noinit_1
v_lshlrev_b32 v1, 8, v0
v_mov_b32 v2, 0
buffer_store_dword v2, v1, s[40:43], 0 offen sc0 sc1
v_add_u32 v1, 0x4000, v1
buffer_store_dword v2, v1, s[40:43], 0 offen sc0 sc1
L_noinit_1:
s_add_u32 m0, s94, 28672
s_nop 0
buffer_load_dwordx4 v8, s[8:11], s92 offen offset:0 lds
buffer_load_dwordx4 v9, s[8:11], s92 offen offset:1024 lds
buffer_load_dwordx4 v10, s[8:11], s92 offen offset:2048 lds
buffer_load_dwordx4 v11, s[8:11], s92 offen offset:3072 lds
s_add_u32 s92, s92, 128
s_add_u32 m0, s95, 28672
s_nop 0
buffer_load_dwordx4 v12, s[12:15], s93 offen offset:0 lds
buffer_load_dwordx4 v12, s[12:15], s93 offen offset:1024 lds
buffer_load_dwordx4 v12, s[12:15], s93 offen offset:2048 lds
s_add_u32 s93, s93, 196608
s_add_u32 m0, s94, 57344
s_nop 0
buffer_load_dwordx4 v8, s[8:11], s92 offen offset:0 lds
buffer_load_dwordx4 v9, s[8:11], s92 offen offset:1024 lds
buffer_load_dwordx4 v10, s[8:11], s92 offen offset:2048 lds
buffer_load_dwordx4 v11, s[8:11], s92 offen offset:3072 lds
s_add_u32 s92, s92, 128
s_add_u32 m0, s95, 57344
s_nop 0
buffer_load_dwordx4 v12, s[12:15], s93 offen offset:0 lds
buffer_load_dwordx4 v12, s[12:15], s93 offen offset:1024 lds
buffer_load_dwordx4 v12, s[12:15], s93 offen offset:2048 lds
s_add_u32 s93, s93, 196608
v_and_b32 v1, 31, v0
v_lshlrev_b32 v1, 10, v1
s_and_b32 s96, s91, 7
s_lshl_b32 s96, s96, 7
s_lshl_b32 s97, s90, 17
s_add_u32 s96, s96, s97
s_lshl_b32 s97, s3, 15
s_add_u32 s96, s96, s97
s_mov_b32 s74, -1
s_mov_b32 s75, 0
s_mov_b64 exec, s[74:75]
buffer_load_dword v200, v1, s[8:11], s96 offen
s_mov_b64 exec, -1
v_and_b32 v1, 31, v0
s_and_b32 s96, s90, 3
s_lshl_b32 s96, s96, 7
s_lshl_b32 s97, s3, 5
s_add_u32 s96, s96, s97
v_add_u32 v1, s96, v1
v_mul_u32_u24 v1, 3072, v1
v_lshrrev_b32 v2, 5, v0
v_lshl_add_u32 v1, v2, 10, v1
s_lshl_b32 s96, s91, 6
buffer_load_dword v201, v1, s[12:15], s96 offen
s_mov_b64 exec, s[74:75]
buffer_load_dword v202, v1, s[12:15], s96 offen offset:2048
s_mov_b64 exec, -1
s_mov_b32 s16, s52
s_and_b32 s17, s53, 0xffff
s_mov_b32 s18, 0x80000
s_mov_b32 s19, 0x20000
s_mov_b32 s20, s56
s_and_b32 s21, s57, 0xffff
s_mov_b32 s22, 0x560000
s_mov_b32 s23, 0x20000
s_mov_b32 s28, s58
s_and_b32 s29, s59, 0xffff
s_mov_b32 s30, 0xac0
s_mov_b32 s31, 0x20000
s_mov_b32 s24, s60
s_and_b32 s25, s61, 0xffff
s_mov_b32 s26, 0x560000
s_mov_b32 s27, 0x20000
s_mov_b32 s32, s62
s_and_b32 s33, s63, 0xffff
s_mov_b32 s34, 0x1000
s_mov_b32 s35, 0x20000
s_mov_b32 s36, s64
s_and_b32 s37, s65, 0xffff
s_mov_b32 s38, 0x200000
s_mov_b32 s39, 0x20000
s_lshl_b32 s98, s90, 2
s_add_u32 s98, s98, s3
s_lshl_b32 s99, s91, 1
s_lshl_b32 s48, s99, 16
s_lshl_b32 s49, s98, 10
s_add_u32 s48, s48, s49
s_add_u32 s48, s48, 0x100000
s_add_u32 s49, s48, 0x10000
s_lshl_b32 s50, s99, 17
s_lshl_b32 s51, s98, 11
s_add_u32 s50, s50, s51
s_add_u32 s50, s50, 0x300000
s_add_u32 s51, s50, 0x20000
s_add_u32 s52, s50, 1024
s_lshl_b32 s53, s99, 8
s_lshl_b32 s54, s98, 2
s_add_u32 s53, s53, s54
s_add_u32 s53, s53, 0x48000
s_lshl_b32 s67, s91, 8
s_add_u32 s67, s67, 0
s_lshl_b32 s96, s2, 10
s_lshl_b32 s97, s3, 8
s_add_u32 s96, s96, s97
s_add_u32 s96, s96, 0x8000
v_mov_b32 v1, -1
v_lshlrev_b32 v2, 2, v0
buffer_store_dword v1, v2, s[40:43], s96 offen sc1
v_and_b32 v1, 31, v0
v_lshrrev_b32 v2, 5, v0
v_lshrrev_b32 v3, 1, v1
v_and_b32 v3, 7, v3
v_lshlrev_b32 v4, 7, v1
v_add_u32 v4, s94, v4
v_and_b32 v1, 15, v0
v_lshrrev_b32 v1, 2, v1
v_lshl_add_u32 v1, v2, 3, v1
v_lshlrev_b32 v1, 6, v1
v_bfe_u32 v5, v0, 4, 1
v_lshl_add_u32 v1, v5, 5, v1
v_and_b32 v5, 3, v0
v_lshl_add_u32 v1, v5, 3, v1
v_add_u32 v1, 16384, v1
s_add_u32 s96, s3, 0
s_and_b32 s96, s96, 3
s_lshl_b32 s97, s96, 1
v_add_u32 v5, s97, v2
v_xor_b32 v5, v5, v3
v_lshl_add_u32 v16, v5, 4, v4
s_mul_i32 s96, s96, 3072
v_add_u32 v28, s96, v1
s_add_u32 s96, s3, 1
s_and_b32 s96, s96, 3
s_lshl_b32 s97, s96, 1
v_add_u32 v5, s97, v2
v_xor_b32 v5, v5, v3
v_lshl_add_u32 v17, v5, 4, v4
s_mul_i32 s96, s96, 3072
v_add_u32 v29, s96, v1
s_add_u32 s96, s3, 2
s_and_b32 s96, s96, 3
s_lshl_b32 s97, s96, 1
v_add_u32 v5, s97, v2
v_xor_b32 v5, v5, v3
v_lshl_add_u32 v18, v5, 4, v4
s_mul_i32 s96, s96, 3072
v_add_u32 v30, s96, v1
s_add_u32 s96, s3, 3
s_and_b32 s96, s96, 3
s_lshl_b32 s97, s96, 1
v_add_u32 v5, s97, v2
v_xor_b32 v5, v5, v3
v_lshl_add_u32 v19, v5, 4, v4
s_mul_i32 s96, s96, 3072
v_add_u32 v31, s96, v1
v_mov_b32 v40, 0x3f803f80
v_mov_b32 v41, 0x3f803f80
v_mov_b32 v42, 0x3f803f80
v_mov_b32 v43, 0x3f803f80
v_add_u32 v20, 57344, v16
v_add_u32 v32, 57344, v28
v_add_u32 v21, 57344, v17
v_add_u32 v33, 57344, v29
v_add_u32 v22, 57344, v18
v_add_u32 v34, 57344, v30
v_add_u32 v23, 57344, v19
v_add_u32 v35, 57344, v31
v_add_u32 v24, 114688, v16
v_add_u32 v36, 114688, v28
v_add_u32 v25, 114688, v17
v_add_u32 v37, 114688, v29
v_add_u32 v26, 114688, v18
v_add_u32 v38, 114688, v30
v_add_u32 v27, 114688, v19
v_add_u32 v39, 114688, v31
v_and_b32 v1, 31, v0
v_lshlrev_b32 v1, 2, v1
s_lshl_b32 s96, s3, 8
s_add_u32 s96, s96, 159232
v_add_u32 v211, s96, v1
s_mul_i32 s97, s3, 384
s_add_u32 s97, s97, 156672
v_add_u32 v209, s97, v1
v_add_u32 v13, 156928, v1
v_lshlrev_b32 v2, 2, v0
v_add_u32 v14, 156672, v2
s_lshl_b32 s97, s3, 8
s_add_u32 s97, s97, 158208
v_add_u32 v15, s97, v2
v_lshrrev_b32 v4, 5, v0
v_lshlrev_b32 v214, 8, v4
v_lshlrev_b32 v4, 4, v4
v_add_u32 v210, s97, v4
v_add_u32 v212, s96, v4
v_and_b32 v3, 15, v0
v_lshl_add_u32 v2, v3, 4, v214
v_bfe_u32 v4, v0, 4, 1
v_lshlrev_b32 v4, 17, v4
v_add_u32 v213, v2, v4
v_and_b32 v1, 3, v0
v_cmp_eq_u32 s[88:89], 1, v1
v_cmp_eq_u32 s[78:79], 2, v1
v_cmp_eq_u32 s[76:77], 3, v1
s_mov_b32 s74, -1
s_mov_b32 s75, 0
s_mov_b32 s83, 0xffff0000
s_waitcnt vmcnt(18)
s_barrier
s_or_b32 s96, s2, s3
s_cmp_lg_u32 s96, 0
s_cbranch_scc1 L_noflag_2
v_mov_b32 v1, 0
v_mov_b32 v2, 1
global_store_dword v1, v2, s[44:45] sc0 sc1
L_noflag_2:
ds_read_b128 v[44:47], v16 offset:0
ds_read_b64_tr_b16 v[52:53], v28 offset:0
ds_read_b64_tr_b16 v[54:55], v28 offset:256
ds_read_b64_tr_b16 v[56:57], v28 offset:1024
ds_read_b64_tr_b16 v[58:59], v28 offset:1280
ds_read_b64_tr_b16 v[60:61], v28 offset:2048
ds_read_b64_tr_b16 v[62:63], v28 offset:2304
s_waitcnt lgkmcnt(0)
v_mfma_f32_32x32x16_bf16 v[80:95], v[52:55], v[44:47], 0
ds_read_b128 v[48:51], v17 offset:0
ds_read_b64_tr_b16 v[64:65], v29 offset:0
ds_read_b64_tr_b16 v[66:67], v29 offset:256
v_mfma_f32_4x4x4_16b_bf16 v[240:243], v[44:45], v[44:45], 0
v_mfma_f32_4x4x4_16b_bf16 v[248:251], v[44:45], v[40:41], 0
v_mfma_f32_32x32x16_bf16 v[96:111], v[56:59], v[44:47], 0
ds_read_b64_tr_b16 v[68:69], v29 offset:1024
ds_read_b64_tr_b16 v[70:71], v29 offset:1280
ds_read_b64_tr_b16 v[72:73], v29 offset:2048
ds_read_b64_tr_b16 v[74:75], v29 offset:2304
v_mfma_f32_4x4x4_16b_bf16 v[244:247], v[46:47], v[46:47], 0
v_mfma_f32_4x4x4_16b_bf16 v[252:255], v[46:47], v[40:41], 0
v_mfma_f32_32x32x16_bf16 v[112:127], v[44:47], v[60:63], 0
s_add_u32 m0, s94, 86016
s_nop 0
buffer_load_dwordx4 v8, s[8:11], s92 offen offset:0 lds
buffer_load_dwordx4 v9, s[8:11], s92 offen offset:1024 lds
v_mfma_f32_32x32x16_bf16 v[144:159], v[40:43], v[52:55], 0
v_mfma_f32_32x32x16_bf16 v[160:175], v[40:43], v[56:59], 0
v_mfma_f32_32x32x16_bf16 v[176:191], v[40:43], v[60:63], 0
s_waitcnt lgkmcnt(0)
v_mfma_f32_32x32x16_bf16 v[80:95], v[64:67], v[48:51], v[80:95]
ds_read_b128 v[44:47], v18 offset:0
ds_read_b64_tr_b16 v[52:53], v30 offset:0
ds_read_b64_tr_b16 v[54:55], v30 offset:256
v_mfma_f32_4x4x4_16b_bf16 v[240:243], v[48:49], v[48:49], v[240:243]
v_mfma_f32_4x4x4_16b_bf16 v[248:251], v[48:49], v[40:41], v[248:251]
v_mfma_f32_32x32x16_bf16 v[96:111], v[68:71], v[48:51], v[96:111]
ds_read_b64_tr_b16 v[56:57], v30 offset:1024
ds_read_b64_tr_b16 v[58:59], v30 offset:1280
ds_read_b64_tr_b16 v[60:61], v30 offset:2048
ds_read_b64_tr_b16 v[62:63], v30 offset:2304
v_mfma_f32_4x4x4_16b_bf16 v[244:247], v[50:51], v[50:51], v[244:247]
v_mfma_f32_4x4x4_16b_bf16 v[252:255], v[50:51], v[40:41], v[252:255]
v_mfma_f32_32x32x16_bf16 v[112:127], v[48:51], v[72:75], v[112:127]
buffer_load_dwordx4 v10, s[8:11], s92 offen offset:2048 lds
buffer_load_dwordx4 v11, s[8:11], s92 offen offset:3072 lds
s_add_u32 s92, s92, 128
s_waitcnt lgkmcnt(0)
v_mfma_f32_32x32x16_bf16 v[80:95], v[52:55], v[44:47], v[80:95]
ds_read_b128 v[48:51], v19 offset:0
ds_read_b64_tr_b16 v[64:65], v31 offset:0
ds_read_b64_tr_b16 v[66:67], v31 offset:256
v_mfma_f32_4x4x4_16b_bf16 v[240:243], v[44:45], v[44:45], v[240:243]
v_mfma_f32_4x4x4_16b_bf16 v[248:251], v[44:45], v[40:41], v[248:251]
v_mfma_f32_32x32x16_bf16 v[96:111], v[56:59], v[44:47], v[96:111]
ds_read_b64_tr_b16 v[68:69], v31 offset:1024
ds_read_b64_tr_b16 v[70:71], v31 offset:1280
ds_read_b64_tr_b16 v[72:73], v31 offset:2048
ds_read_b64_tr_b16 v[74:75], v31 offset:2304
v_mfma_f32_4x4x4_16b_bf16 v[244:247], v[46:47], v[46:47], v[244:247]
v_mfma_f32_4x4x4_16b_bf16 v[252:255], v[46:47], v[40:41], v[252:255]
v_mfma_f32_32x32x16_bf16 v[112:127], v[44:47], v[60:63], v[112:127]
s_add_u32 m0, s95, 86016
s_nop 0
buffer_load_dwordx4 v12, s[12:15], s93 offen offset:0 lds
buffer_load_dwordx4 v12, s[12:15], s93 offen offset:1024 lds
s_waitcnt lgkmcnt(0)
s_waitcnt vmcnt(17)
s_barrier
v_mfma_f32_32x32x16_bf16 v[80:95], v[64:67], v[48:51], v[80:95]
ds_read_b128 v[44:47], v16 offset:28672
ds_read_b64_tr_b16 v[52:53], v28 offset:28672
ds_read_b64_tr_b16 v[54:55], v28 offset:28928
v_mfma_f32_4x4x4_16b_bf16 v[240:243], v[48:49], v[48:49], v[240:243]
v_mfma_f32_4x4x4_16b_bf16 v[248:251], v[48:49], v[40:41], v[248:251]
v_mfma_f32_32x32x16_bf16 v[96:111], v[68:71], v[48:51], v[96:111]
ds_read_b64_tr_b16 v[56:57], v28 offset:29696
ds_read_b64_tr_b16 v[58:59], v28 offset:29952
ds_read_b64_tr_b16 v[60:61], v28 offset:30720
ds_read_b64_tr_b16 v[62:63], v28 offset:30976
v_mfma_f32_4x4x4_16b_bf16 v[244:247], v[50:51], v[50:51], v[244:247]
v_mfma_f32_4x4x4_16b_bf16 v[252:255], v[50:51], v[40:41], v[252:255]
v_mfma_f32_32x32x16_bf16 v[112:127], v[48:51], v[72:75], v[112:127]
buffer_load_dwordx4 v12, s[12:15], s93 offen offset:2048 lds
s_add_u32 s93, s93, 196608
s_waitcnt lgkmcnt(0)
v_mfma_f32_32x32x16_bf16 v[80:95], v[52:55], v[44:47], v[80:95]
ds_read_b128 v[48:51], v17 offset:28672
ds_read_b64_tr_b16 v[64:65], v29 offset:28672
ds_read_b64_tr_b16 v[66:67], v29 offset:28928
v_mfma_f32_4x4x4_16b_bf16 v[240:243], v[44:45], v[44:45], v[240:243]
v_mfma_f32_4x4x4_16b_bf16 v[248:251], v[44:45], v[40:41], v[248:251]
v_mfma_f32_32x32x16_bf16 v[96:111], v[56:59], v[44:47], v[96:111]
ds_read_b64_tr_b16 v[68:69], v29 offset:29696
ds_read_b64_tr_b16 v[70:71], v29 offset:29952
ds_read_b64_tr_b16 v[72:73], v29 offset:30720
ds_read_b64_tr_b16 v[74:75], v29 offset:30976
v_mfma_f32_4x4x4_16b_bf16 v[244:247], v[46:47], v[46:47], v[244:247]
v_mfma_f32_4x4x4_16b_bf16 v[252:255], v[46:47], v[40:41], v[252:255]
v_mfma_f32_32x32x16_bf16 v[112:127], v[44:47], v[60:63], v[112:127]
s_add_u32 m0, s94, 114688
s_nop 0
buffer_load_dwordx4 v8, s[8:11], s92 offen offset:0 lds
buffer_load_dwordx4 v9, s[8:11], s92 offen offset:1024 lds
v_mfma_f32_32x32x16_bf16 v[144:159], v[40:43], v[52:55], v[144:159]
v_mfma_f32_32x32x16_bf16 v[160:175], v[40:43], v[56:59], v[160:175]
v_mfma_f32_32x32x16_bf16 v[176:191], v[40:43], v[60:63], v[176:191]
s_waitcnt lgkmcnt(0)
v_mfma_f32_32x32x16_bf16 v[80:95], v[64:67], v[48:51], v[80:95]
ds_read_b128 v[44:47], v18 offset:28672
ds_read_b64_tr_b16 v[52:53], v30 offset:28672
ds_read_b64_tr_b16 v[54:55], v30 offset:28928
v_mfma_f32_4x4x4_16b_bf16 v[240:243], v[48:49], v[48:49], v[240:243]
v_mfma_f32_4x4x4_16b_bf16 v[248:251], v[48:49], v[40:41], v[248:251]
v_mfma_f32_32x32x16_bf16 v[96:111], v[68:71], v[48:51], v[96:111]
ds_read_b64_tr_b16 v[56:57], v30 offset:29696
ds_read_b64_tr_b16 v[58:59], v30 offset:29952
ds_read_b64_tr_b16 v[60:61], v30 offset:30720
ds_read_b64_tr_b16 v[62:63], v30 offset:30976
v_mfma_f32_4x4x4_16b_bf16 v[244:247], v[50:51], v[50:51], v[244:247]
v_mfma_f32_4x4x4_16b_bf16 v[252:255], v[50:51], v[40:41], v[252:255]
v_mfma_f32_32x32x16_bf16 v[112:127], v[48:51], v[72:75], v[112:127]
buffer_load_dwordx4 v10, s[8:11], s92 offen offset:2048 lds
buffer_load_dwordx4 v11, s[8:11], s92 offen offset:3072 lds
s_add_u32 s92, s92, 128
s_waitcnt lgkmcnt(0)
v_mfma_f32_32x32x16_bf16 v[80:95], v[52:55], v[44:47], v[80:95]
ds_read_b128 v[48:51], v19 offset:28672
ds_read_b64_tr_b16 v[64:65], v31 offset:28672
ds_read_b64_tr_b16 v[66:67], v31 offset:28928
v_mfma_f32_4x4x4_16b_bf16 v[240:243], v[44:45], v[44:45], v[240:243]
v_mfma_f32_4x4x4_16b_bf16 v[248:251], v[44:45], v[40:41], v[248:251]
v_mfma_f32_32x32x16_bf16 v[96:111], v[56:59], v[44:47], v[96:111]
ds_read_b64_tr_b16 v[68:69], v31 offset:29696
ds_read_b64_tr_b16 v[70:71], v31 offset:29952
ds_read_b64_tr_b16 v[72:73], v31 offset:30720
ds_read_b64_tr_b16 v[74:75], v31 offset:30976
v_mfma_f32_4x4x4_16b_bf16 v[244:247], v[46:47], v[46:47], v[244:247]
v_mfma_f32_4x4x4_16b_bf16 v[252:255], v[46:47], v[40:41], v[252:255]
v_mfma_f32_32x32x16_bf16 v[112:127], v[44:47], v[60:63], v[112:127]
s_add_u32 m0, s95, 114688
s_nop 0
buffer_load_dwordx4 v12, s[12:15], s93 offen offset:0 lds
buffer_load_dwordx4 v12, s[12:15], s93 offen offset:1024 lds
s_waitcnt lgkmcnt(0)
s_waitcnt vmcnt(17)
s_barrier
v_mfma_f32_32x32x16_bf16 v[80:95], v[64:67], v[48:51], v[80:95]
ds_read_b128 v[44:47], v20 offset:0
ds_read_b64_tr_b16 v[52:53], v32 offset:0
ds_read_b64_tr_b16 v[54:55], v32 offset:256
v_mfma_f32_4x4x4_16b_bf16 v[240:243], v[48:49], v[48:49], v[240:243]
v_mfma_f32_4x4x4_16b_bf16 v[248:251], v[48:49], v[40:41], v[248:251]
v_mfma_f32_32x32x16_bf16 v[96:111], v[68:71], v[48:51], v[96:111]
ds_read_b64_tr_b16 v[56:57], v32 offset:1024
ds_read_b64_tr_b16 v[58:59], v32 offset:1280
ds_read_b64_tr_b16 v[60:61], v32 offset:2048
ds_read_b64_tr_b16 v[62:63], v32 offset:2304
v_mfma_f32_4x4x4_16b_bf16 v[244:247], v[50:51], v[50:51], v[244:247]
v_mfma_f32_4x4x4_16b_bf16 v[252:255], v[50:51], v[40:41], v[252:255]
v_mfma_f32_32x32x16_bf16 v[112:127], v[48:51], v[72:75], v[112:127]
buffer_load_dwordx4 v12, s[12:15], s93 offen offset:2048 lds
s_add_u32 s93, s93, 196608
s_waitcnt lgkmcnt(0)
v_mfma_f32_32x32x16_bf16 v[80:95], v[52:55], v[44:47], v[80:95]
ds_read_b128 v[48:51], v21 offset:0
ds_read_b64_tr_b16 v[64:65], v33 offset:0
ds_read_b64_tr_b16 v[66:67], v33 offset:256
v_mfma_f32_4x4x4_16b_bf16 v[240:243], v[44:45], v[44:45], v[240:243]
v_mfma_f32_4x4x4_16b_bf16 v[248:251], v[44:45], v[40:41], v[248:251]
v_mfma_f32_32x32x16_bf16 v[96:111], v[56:59], v[44:47], v[96:111]
ds_read_b64_tr_b16 v[68:69], v33 offset:1024
ds_read_b64_tr_b16 v[70:71], v33 offset:1280
ds_read_b64_tr_b16 v[72:73], v33 offset:2048
ds_read_b64_tr_b16 v[74:75], v33 offset:2304
v_mfma_f32_4x4x4_16b_bf16 v[244:247], v[46:47], v[46:47], v[244:247]
v_mfma_f32_4x4x4_16b_bf16 v[252:255], v[46:47], v[40:41], v[252:255]
v_mfma_f32_32x32x16_bf16 v[112:127], v[44:47], v[60:63], v[112:127]
s_add_u32 m0, s94, 0
s_nop 0
buffer_load_dwordx4 v8, s[8:11], s92 offen offset:0 lds
buffer_load_dwordx4 v9, s[8:11], s92 offen offset:1024 lds
v_mfma_f32_32x32x16_bf16 v[144:159], v[40:43], v[52:55], v[144:159]
v_mfma_f32_32x32x16_bf16 v[160:175], v[40:43], v[56:59], v[160:175]
v_mfma_f32_32x32x16_bf16 v[176:191], v[40:43], v[60:63], v[176:191]
s_waitcnt lgkmcnt(0)
v_mfma_f32_32x32x16_bf16 v[80:95], v[64:67], v[48:51], v[80:95]
ds_read_b128 v[44:47], v22 offset:0
ds_read_b64_tr_b16 v[52:53], v34 offset:0
ds_read_b64_tr_b16 v[54:55], v34 offset:256
v_mfma_f32_4x4x4_16b_bf16 v[240:243], v[48:49], v[48:49], v[240:243]
v_mfma_f32_4x4x4_16b_bf16 v[248:251], v[48:49], v[40:41], v[248:251]
v_mfma_f32_32x32x16_bf16 v[96:111], v[68:71], v[48:51], v[96:111]
ds_read_b64_tr_b16 v[56:57], v34 offset:1024
ds_read_b64_tr_b16 v[58:59], v34 offset:1280
ds_read_b64_tr_b16 v[60:61], v34 offset:2048
ds_read_b64_tr_b16 v[62:63], v34 offset:2304
v_mfma_f32_4x4x4_16b_bf16 v[244:247], v[50:51], v[50:51], v[244:247]
v_mfma_f32_4x4x4_16b_bf16 v[252:255], v[50:51], v[40:41], v[252:255]
v_mfma_f32_32x32x16_bf16 v[112:127], v[48:51], v[72:75], v[112:127]
buffer_load_dwordx4 v10, s[8:11], s92 offen offset:2048 lds
buffer_load_dwordx4 v11, s[8:11], s92 offen offset:3072 lds
s_add_u32 s92, s92, 128
s_waitcnt lgkmcnt(0)
v_mfma_f32_32x32x16_bf16 v[80:95], v[52:55], v[44:47], v[80:95]
ds_read_b128 v[48:51], v23 offset:0
ds_read_b64_tr_b16 v[64:65], v35 offset:0
ds_read_b64_tr_b16 v[66:67], v35 offset:256
v_mfma_f32_4x4x4_16b_bf16 v[240:243], v[44:45], v[44:45], v[240:243]
v_mfma_f32_4x4x4_16b_bf16 v[248:251], v[44:45], v[40:41], v[248:251]
v_mfma_f32_32x32x16_bf16 v[96:111], v[56:59], v[44:47], v[96:111]
ds_read_b64_tr_b16 v[68:69], v35 offset:1024
ds_read_b64_tr_b16 v[70:71], v35 offset:1280
ds_read_b64_tr_b16 v[72:73], v35 offset:2048
ds_read_b64_tr_b16 v[74:75], v35 offset:2304
v_mfma_f32_4x4x4_16b_bf16 v[244:247], v[46:47], v[46:47], v[244:247]
v_mfma_f32_4x4x4_16b_bf16 v[252:255], v[46:47], v[40:41], v[252:255]
v_mfma_f32_32x32x16_bf16 v[112:127], v[44:47], v[60:63], v[112:127]
s_add_u32 m0, s95, 0
s_nop 0
buffer_load_dwordx4 v12, s[12:15], s93 offen offset:0 lds
buffer_load_dwordx4 v12, s[12:15], s93 offen offset:1024 lds
s_waitcnt lgkmcnt(0)
s_waitcnt vmcnt(13)
s_barrier
v_mfma_f32_32x32x16_bf16 v[80:95], v[64:67], v[48:51], v[80:95]
ds_read_b128 v[44:47], v20 offset:28672
ds_read_b64_tr_b16 v[52:53], v32 offset:28672
ds_read_b64_tr_b16 v[54:55], v32 offset:28928
v_mfma_f32_4x4x4_16b_bf16 v[240:243], v[48:49], v[48:49], v[240:243]
v_mfma_f32_4x4x4_16b_bf16 v[248:251], v[48:49], v[40:41], v[248:251]
v_mfma_f32_32x32x16_bf16 v[96:111], v[68:71], v[48:51], v[96:111]
ds_read_b64_tr_b16 v[56:57], v32 offset:29696
ds_read_b64_tr_b16 v[58:59], v32 offset:29952
ds_read_b64_tr_b16 v[60:61], v32 offset:30720
ds_read_b64_tr_b16 v[62:63], v32 offset:30976
v_mfma_f32_4x4x4_16b_bf16 v[244:247], v[50:51], v[50:51], v[244:247]
v_mfma_f32_4x4x4_16b_bf16 v[252:255], v[50:51], v[40:41], v[252:255]
v_mfma_f32_32x32x16_bf16 v[112:127], v[48:51], v[72:75], v[112:127]
buffer_load_dwordx4 v12, s[12:15], s93 offen offset:2048 lds
s_add_u32 s93, s93, 196608
s_waitcnt lgkmcnt(0)
v_mfma_f32_32x32x16_bf16 v[80:95], v[52:55], v[44:47], v[80:95]
ds_read_b128 v[48:51], v21 offset:28672
ds_read_b64_tr_b16 v[64:65], v33 offset:28672
ds_read_b64_tr_b16 v[66:67], v33 offset:28928
v_mfma_f32_4x4x4_16b_bf16 v[240:243], v[44:45], v[44:45], v[240:243]
v_mfma_f32_4x4x4_16b_bf16 v[248:251], v[44:45], v[40:41], v[248:251]
v_mfma_f32_32x32x16_bf16 v[96:111], v[56:59], v[44:47], v[96:111]
ds_read_b64_tr_b16 v[68:69], v33 offset:29696
ds_read_b64_tr_b16 v[70:71], v33 offset:29952
ds_read_b64_tr_b16 v[72:73], v33 offset:30720
ds_read_b64_tr_b16 v[74:75], v33 offset:30976
v_mfma_f32_4x4x4_16b_bf16 v[244:247], v[46:47], v[46:47], v[244:247]
v_mfma_f32_4x4x4_16b_bf16 v[252:255], v[46:47], v[40:41], v[252:255]
v_mfma_f32_32x32x16_bf16 v[112:127], v[44:47], v[60:63], v[112:127]
s_add_u32 m0, s94, 28672
s_nop 0
buffer_load_dwordx4 v8, s[8:11], s92 offen offset:0 lds
buffer_load_dwordx4 v9, s[8:11], s92 offen offset:1024 lds
v_mfma_f32_32x32x16_bf16 v[144:159], v[40:43], v[52:55], v[144:159]
v_mfma_f32_32x32x16_bf16 v[160:175], v[40:43], v[56:59], v[160:175]
v_mfma_f32_32x32x16_bf16 v[176:191], v[40:43], v[60:63], v[176:191]
s_waitcnt lgkmcnt(0)
v_mfma_f32_32x32x16_bf16 v[80:95], v[64:67], v[48:51], v[80:95]
ds_read_b128 v[44:47], v22 offset:28672
ds_read_b64_tr_b16 v[52:53], v34 offset:28672
ds_read_b64_tr_b16 v[54:55], v34 offset:28928
v_mfma_f32_4x4x4_16b_bf16 v[240:243], v[48:49], v[48:49], v[240:243]
v_mfma_f32_4x4x4_16b_bf16 v[248:251], v[48:49], v[40:41], v[248:251]
v_mfma_f32_32x32x16_bf16 v[96:111], v[68:71], v[48:51], v[96:111]
ds_read_b64_tr_b16 v[56:57], v34 offset:29696
ds_read_b64_tr_b16 v[58:59], v34 offset:29952
ds_read_b64_tr_b16 v[60:61], v34 offset:30720
ds_read_b64_tr_b16 v[62:63], v34 offset:30976
v_mfma_f32_4x4x4_16b_bf16 v[244:247], v[50:51], v[50:51], v[244:247]
v_mfma_f32_4x4x4_16b_bf16 v[252:255], v[50:51], v[40:41], v[252:255]
v_mfma_f32_32x32x16_bf16 v[112:127], v[48:51], v[72:75], v[112:127]
buffer_load_dwordx4 v10, s[8:11], s92 offen offset:2048 lds
buffer_load_dwordx4 v11, s[8:11], s92 offen offset:3072 lds
s_add_u32 s92, s92, 128
s_waitcnt lgkmcnt(0)
v_mfma_f32_32x32x16_bf16 v[80:95], v[52:55], v[44:47], v[80:95]
ds_read_b128 v[48:51], v23 offset:28672
ds_read_b64_tr_b16 v[64:65], v35 offset:28672
ds_read_b64_tr_b16 v[66:67], v35 offset:28928
v_mfma_f32_4x4x4_16b_bf16 v[240:243], v[44:45], v[44:45], v[240:243]
v_mfma_f32_4x4x4_16b_bf16 v[248:251], v[44:45], v[40:41], v[248:251]
v_mfma_f32_32x32x16_bf16 v[96:111], v[56:59], v[44:47], v[96:111]
ds_read_b64_tr_b16 v[68:69], v35 offset:29696
ds_read_b64_tr_b16 v[70:71], v35 offset:29952
ds_read_b64_tr_b16 v[72:73], v35 offset:30720
ds_read_b64_tr_b16 v[74:75], v35 offset:30976
v_mfma_f32_4x4x4_16b_bf16 v[244:247], v[46:47], v[46:47], v[244:247]
v_mfma_f32_4x4x4_16b_bf16 v[252:255], v[46:47], v[40:41], v[252:255]
v_mfma_f32_32x32x16_bf16 v[112:127], v[44:47], v[60:63], v[112:127]
s_add_u32 m0, s95, 28672
s_nop 0
buffer_load_dwordx4 v12, s[12:15], s93 offen offset:0 lds
buffer_load_dwordx4 v12, s[12:15], s93 offen offset:1024 lds
s_waitcnt lgkmcnt(0)
s_waitcnt vmcnt(13)
s_barrier
v_mfma_f32_32x32x16_bf16 v[80:95], v[64:67], v[48:51], v[80:95]
ds_read_b128 v[44:47], v24 offset:0
ds_read_b64_tr_b16 v[52:53], v36 offset:0
ds_read_b64_tr_b16 v[54:55], v36 offset:256
v_mfma_f32_4x4x4_16b_bf16 v[240:243], v[48:49], v[48:49], v[240:243]
v_mfma_f32_4x4x4_16b_bf16 v[248:251], v[48:49], v[40:41], v[248:251]
v_mfma_f32_32x32x16_bf16 v[96:111], v[68:71], v[48:51], v[96:111]
ds_read_b64_tr_b16 v[56:57], v36 offset:1024
ds_read_b64_tr_b16 v[58:59], v36 offset:1280
ds_read_b64_tr_b16 v[60:61], v36 offset:2048
ds_read_b64_tr_b16 v[62:63], v36 offset:2304
v_mfma_f32_4x4x4_16b_bf16 v[244:247], v[50:51], v[50:51], v[244:247]
v_mfma_f32_4x4x4_16b_bf16 v[252:255], v[50:51], v[40:41], v[252:255]
v_mfma_f32_32x32x16_bf16 v[112:127], v[48:51], v[72:75], v[112:127]
buffer_load_dwordx4 v12, s[12:15], s93 offen offset:2048 lds
s_add_u32 s93, s93, 196608
s_waitcnt lgkmcnt(0)
v_mfma_f32_32x32x16_bf16 v[80:95], v[52:55], v[44:47], v[80:95]
ds_read_b128 v[48:51], v25 offset:0
ds_read_b64_tr_b16 v[64:65], v37 offset:0
ds_read_b64_tr_b16 v[66:67], v37 offset:256
v_mfma_f32_4x4x4_16b_bf16 v[240:243], v[44:45], v[44:45], v[240:243]
v_mfma_f32_4x4x4_16b_bf16 v[248:251], v[44:45], v[40:41], v[248:251]
v_mfma_f32_32x32x16_bf16 v[96:111], v[56:59], v[44:47], v[96:111]
ds_read_b64_tr_b16 v[68:69], v37 offset:1024
ds_read_b64_tr_b16 v[70:71], v37 offset:1280
ds_read_b64_tr_b16 v[72:73], v37 offset:2048
ds_read_b64_tr_b16 v[74:75], v37 offset:2304
v_mfma_f32_4x4x4_16b_bf16 v[244:247], v[46:47], v[46:47], v[244:247]
v_mfma_f32_4x4x4_16b_bf16 v[252:255], v[46:47], v[40:41], v[252:255]
v_mfma_f32_32x32x16_bf16 v[112:127], v[44:47], v[60:63], v[112:127]
s_add_u32 m0, s94, 57344
s_nop 0
buffer_load_dwordx4 v8, s[8:11], s92 offen offset:0 lds
buffer_load_dwordx4 v9, s[8:11], s92 offen offset:1024 lds
v_mfma_f32_32x32x16_bf16 v[144:159], v[40:43], v[52:55], v[144:159]
v_mfma_f32_32x32x16_bf16 v[160:175], v[40:43], v[56:59], v[160:175]
v_mfma_f32_32x32x16_bf16 v[176:191], v[40:43], v[60:63], v[176:191]
s_waitcnt lgkmcnt(0)
v_mfma_f32_32x32x16_bf16 v[80:95], v[64:67], v[48:51], v[80:95]
ds_read_b128 v[44:47], v26 offset:0
ds_read_b64_tr_b16 v[52:53], v38 offset:0
ds_read_b64_tr_b16 v[54:55], v38 offset:256
v_mfma_f32_4x4x4_16b_bf16 v[240:243], v[48:49], v[48:49], v[240:243]
v_mfma_f32_4x4x4_16b_bf16 v[248:251], v[48:49], v[40:41], v[248:251]
v_mfma_f32_32x32x16_bf16 v[96:111], v[68:71], v[48:51], v[96:111]
ds_read_b64_tr_b16 v[56:57], v38 offset:1024
ds_read_b64_tr_b16 v[58:59], v38 offset:1280
ds_read_b64_tr_b16 v[60:61], v38 offset:2048
ds_read_b64_tr_b16 v[62:63], v38 offset:2304
v_mfma_f32_4x4x4_16b_bf16 v[244:247], v[50:51], v[50:51], v[244:247]
v_mfma_f32_4x4x4_16b_bf16 v[252:255], v[50:51], v[40:41], v[252:255]
v_mfma_f32_32x32x16_bf16 v[112:127], v[48:51], v[72:75], v[112:127]
buffer_load_dwordx4 v10, s[8:11], s92 offen offset:2048 lds
buffer_load_dwordx4 v11, s[8:11], s92 offen offset:3072 lds
s_add_u32 s92, s92, 128
s_waitcnt lgkmcnt(0)
v_mfma_f32_32x32x16_bf16 v[80:95], v[52:55], v[44:47], v[80:95]
ds_read_b128 v[48:51], v27 offset:0
ds_read_b64_tr_b16 v[64:65], v39 offset:0
ds_read_b64_tr_b16 v[66:67], v39 offset:256
v_mfma_f32_4x4x4_16b_bf16 v[240:243], v[44:45], v[44:45], v[240:243]
v_mfma_f32_4x4x4_16b_bf16 v[248:251], v[44:45], v[40:41], v[248:251]
v_mfma_f32_32x32x16_bf16 v[96:111], v[56:59], v[44:47], v[96:111]
ds_read_b64_tr_b16 v[68:69], v39 offset:1024
ds_read_b64_tr_b16 v[70:71], v39 offset:1280
ds_read_b64_tr_b16 v[72:73], v39 offset:2048
ds_read_b64_tr_b16 v[74:75], v39 offset:2304
v_mfma_f32_4x4x4_16b_bf16 v[244:247], v[46:47], v[46:47], v[244:247]
v_mfma_f32_4x4x4_16b_bf16 v[252:255], v[46:47], v[40:41], v[252:255]
v_mfma_f32_32x32x16_bf16 v[112:127], v[44:47], v[60:63], v[112:127]
s_add_u32 m0, s95, 57344
s_nop 0
buffer_load_dwordx4 v12, s[12:15], s93 offen offset:0 lds
buffer_load_dwordx4 v12, s[12:15], s93 offen offset:1024 lds
s_waitcnt lgkmcnt(0)
s_waitcnt vmcnt(13)
s_barrier
v_mfma_f32_32x32x16_bf16 v[80:95], v[64:67], v[48:51], v[80:95]
ds_read_b128 v[44:47], v16 offset:0
ds_read_b64_tr_b16 v[52:53], v28 offset:0
ds_read_b64_tr_b16 v[54:55], v28 offset:256
v_mfma_f32_4x4x4_16b_bf16 v[240:243], v[48:49], v[48:49], v[240:243]
v_mfma_f32_4x4x4_16b_bf16 v[248:251], v[48:49], v[40:41], v[248:251]
v_mfma_f32_32x32x16_bf16 v[96:111], v[68:71], v[48:51], v[96:111]
ds_read_b64_tr_b16 v[56:57], v28 offset:1024
ds_read_b64_tr_b16 v[58:59], v28 offset:1280
ds_read_b64_tr_b16 v[60:61], v28 offset:2048
ds_read_b64_tr_b16 v[62:63], v28 offset:2304
v_mfma_f32_4x4x4_16b_bf16 v[244:247], v[50:51], v[50:51], v[244:247]
v_mfma_f32_4x4x4_16b_bf16 v[252:255], v[50:51], v[40:41], v[252:255]
v_mfma_f32_32x32x16_bf16 v[112:127], v[48:51], v[72:75], v[112:127]
buffer_load_dwordx4 v12, s[12:15], s93 offen offset:2048 lds
s_add_u32 s93, s93, 196608
s_waitcnt lgkmcnt(0)
v_mfma_f32_32x32x16_bf16 v[80:95], v[52:55], v[44:47], v[80:95]
ds_read_b128 v[48:51], v17 offset:0
ds_read_b64_tr_b16 v[64:65], v29 offset:0
ds_read_b64_tr_b16 v[66:67], v29 offset:256
v_mfma_f32_4x4x4_16b_bf16 v[240:243], v[44:45], v[44:45], v[240:243]
v_mfma_f32_4x4x4_16b_bf16 v[248:251], v[44:45], v[40:41], v[248:251]
v_mfma_f32_32x32x16_bf16 v[96:111], v[56:59], v[44:47], v[96:111]
ds_read_b64_tr_b16 v[68:69], v29 offset:1024
ds_read_b64_tr_b16 v[70:71], v29 offset:1280
ds_read_b64_tr_b16 v[72:73], v29 offset:2048
ds_read_b64_tr_b16 v[74:75], v29 offset:2304
v_mfma_f32_4x4x4_16b_bf16 v[244:247], v[46:47], v[46:47], v[244:247]
v_mfma_f32_4x4x4_16b_bf16 v[252:255], v[46:47], v[40:41], v[252:255]
v_mfma_f32_32x32x16_bf16 v[112:127], v[44:47], v[60:63], v[112:127]
v_mfma_f32_32x32x16_bf16 v[144:159], v[40:43], v[52:55], v[144:159]
v_mfma_f32_32x32x16_bf16 v[160:175], v[40:43], v[56:59], v[160:175]
v_mfma_f32_32x32x16_bf16 v[176:191], v[40:43], v[60:63], v[176:191]
s_waitcnt lgkmcnt(0)
v_mfma_f32_32x32x16_bf16 v[80:95], v[64:67], v[48:51], v[80:95]
ds_read_b128 v[44:47], v18 offset:0
ds_read_b64_tr_b16 v[52:53], v30 offset:0
ds_read_b64_tr_b16 v[54:55], v30 offset:256
v_mfma_f32_4x4x4_16b_bf16 v[240:243], v[48:49], v[48:49], v[240:243]
v_mfma_f32_4x4x4_16b_bf16 v[248:251], v[48:49], v[40:41], v[248:251]
v_mfma_f32_32x32x16_bf16 v[96:111], v[68:71], v[48:51], v[96:111]
ds_read_b64_tr_b16 v[56:57], v30 offset:1024
ds_read_b64_tr_b16 v[58:59], v30 offset:1280
ds_read_b64_tr_b16 v[60:61], v30 offset:2048
ds_read_b64_tr_b16 v[62:63], v30 offset:2304
v_mfma_f32_4x4x4_16b_bf16 v[244:247], v[50:51], v[50:51], v[244:247]
v_mfma_f32_4x4x4_16b_bf16 v[252:255], v[50:51], v[40:41], v[252:255]
v_mfma_f32_32x32x16_bf16 v[112:127], v[48:51], v[72:75], v[112:127]
s_waitcnt lgkmcnt(0)
v_mfma_f32_32x32x16_bf16 v[80:95], v[52:55], v[44:47], v[80:95]
ds_read_b128 v[48:51], v19 offset:0
ds_read_b64_tr_b16 v[64:65], v31 offset:0
ds_read_b64_tr_b16 v[66:67], v31 offset:256
v_mfma_f32_4x4x4_16b_bf16 v[240:243], v[44:45], v[44:45], v[240:243]
v_mfma_f32_4x4x4_16b_bf16 v[248:251], v[44:45], v[40:41], v[248:251]
v_mfma_f32_32x32x16_bf16 v[96:111], v[56:59], v[44:47], v[96:111]
ds_read_b64_tr_b16 v[68:69], v31 offset:1024
ds_read_b64_tr_b16 v[70:71], v31 offset:1280
ds_read_b64_tr_b16 v[72:73], v31 offset:2048
ds_read_b64_tr_b16 v[74:75], v31 offset:2304
v_mfma_f32_4x4x4_16b_bf16 v[244:247], v[46:47], v[46:47], v[244:247]
v_mfma_f32_4x4x4_16b_bf16 v[252:255], v[46:47], v[40:41], v[252:255]
v_mfma_f32_32x32x16_bf16 v[112:127], v[44:47], v[60:63], v[112:127]
s_waitcnt lgkmcnt(0)
s_waitcnt vmcnt(7)
s_barrier
v_mfma_f32_32x32x16_bf16 v[80:95], v[64:67], v[48:51], v[80:95]
ds_read_b128 v[44:47], v16 offset:28672
ds_read_b64_tr_b16 v[52:53], v28 offset:28672
ds_read_b64_tr_b16 v[54:55], v28 offset:28928
v_mfma_f32_4x4x4_16b_bf16 v[240:243], v[48:49], v[48:49], v[240:243]
v_mfma_f32_4x4x4_16b_bf16 v[248:251], v[48:49], v[40:41], v[248:251]
v_mfma_f32_32x32x16_bf16 v[96:111], v[68:71], v[48:51], v[96:111]
ds_read_b64_tr_b16 v[56:57], v28 offset:29696
ds_read_b64_tr_b16 v[58:59], v28 offset:29952
ds_read_b64_tr_b16 v[60:61], v28 offset:30720
ds_read_b64_tr_b16 v[62:63], v28 offset:30976
v_mfma_f32_4x4x4_16b_bf16 v[244:247], v[50:51], v[50:51], v[244:247]
v_mfma_f32_4x4x4_16b_bf16 v[252:255], v[50:51], v[40:41], v[252:255]
v_mfma_f32_32x32x16_bf16 v[112:127], v[48:51], v[72:75], v[112:127]
v_mov_b32 v1, 0
global_load_dword v79, v1, s[44:45] sc1
s_waitcnt lgkmcnt(0)
v_mfma_f32_32x32x16_bf16 v[80:95], v[52:55], v[44:47], v[80:95]
ds_read_b128 v[48:51], v17 offset:28672
ds_read_b64_tr_b16 v[64:65], v29 offset:28672
ds_read_b64_tr_b16 v[66:67], v29 offset:28928
v_mfma_f32_4x4x4_16b_bf16 v[240:243], v[44:45], v[44:45], v[240:243]
v_mfma_f32_4x4x4_16b_bf16 v[248:251], v[44:45], v[40:41], v[248:251]
v_mfma_f32_32x32x16_bf16 v[96:111], v[56:59], v[44:47], v[96:111]
ds_read_b64_tr_b16 v[68:69], v29 offset:29696
ds_read_b64_tr_b16 v[70:71], v29 offset:29952
ds_read_b64_tr_b16 v[72:73], v29 offset:30720
ds_read_b64_tr_b16 v[74:75], v29 offset:30976
v_mfma_f32_4x4x4_16b_bf16 v[244:247], v[46:47], v[46:47], v[244:247]
v_mfma_f32_4x4x4_16b_bf16 v[252:255], v[46:47], v[40:41], v[252:255]
v_mfma_f32_32x32x16_bf16 v[112:127], v[44:47], v[60:63], v[112:127]
v_mfma_f32_32x32x16_bf16 v[144:159], v[40:43], v[52:55], v[144:159]
v_mfma_f32_32x32x16_bf16 v[160:175], v[40:43], v[56:59], v[160:175]
v_mfma_f32_32x32x16_bf16 v[176:191], v[40:43], v[60:63], v[176:191]
s_waitcnt lgkmcnt(0)
v_mfma_f32_32x32x16_bf16 v[80:95], v[64:67], v[48:51], v[80:95]
ds_read_b128 v[44:47], v18 offset:28672
ds_read_b64_tr_b16 v[52:53], v30 offset:28672
ds_read_b64_tr_b16 v[54:55], v30 offset:28928
v_mfma_f32_4x4x4_16b_bf16 v[240:243], v[48:49], v[48:49], v[240:243]
v_mfma_f32_4x4x4_16b_bf16 v[248:251], v[48:49], v[40:41], v[248:251]
v_mfma_f32_32x32x16_bf16 v[96:111], v[68:71], v[48:51], v[96:111]
ds_read_b64_tr_b16 v[56:57], v30 offset:29696
ds_read_b64_tr_b16 v[58:59], v30 offset:29952
ds_read_b64_tr_b16 v[60:61], v30 offset:30720
ds_read_b64_tr_b16 v[62:63], v30 offset:30976
v_mfma_f32_4x4x4_16b_bf16 v[244:247], v[50:51], v[50:51], v[244:247]
v_mfma_f32_4x4x4_16b_bf16 v[252:255], v[50:51], v[40:41], v[252:255]
v_mfma_f32_32x32x16_bf16 v[112:127], v[48:51], v[72:75], v[112:127]
s_waitcnt lgkmcnt(0)
v_mfma_f32_32x32x16_bf16 v[80:95], v[52:55], v[44:47], v[80:95]
ds_read_b128 v[48:51], v19 offset:28672
ds_read_b64_tr_b16 v[64:65], v31 offset:28672
ds_read_b64_tr_b16 v[66:67], v31 offset:28928
v_mfma_f32_4x4x4_16b_bf16 v[240:243], v[44:45], v[44:45], v[240:243]
v_mfma_f32_4x4x4_16b_bf16 v[248:251], v[44:45], v[40:41], v[248:251]
v_mfma_f32_32x32x16_bf16 v[96:111], v[56:59], v[44:47], v[96:111]
ds_read_b64_tr_b16 v[68:69], v31 offset:29696
ds_read_b64_tr_b16 v[70:71], v31 offset:29952
ds_read_b64_tr_b16 v[72:73], v31 offset:30720
ds_read_b64_tr_b16 v[74:75], v31 offset:30976
v_mfma_f32_4x4x4_16b_bf16 v[244:247], v[46:47], v[46:47], v[244:247]
v_mfma_f32_4x4x4_16b_bf16 v[252:255], v[46:47], v[40:41], v[252:255]
v_mfma_f32_32x32x16_bf16 v[112:127], v[44:47], v[60:63], v[112:127]
s_waitcnt lgkmcnt(0)
s_waitcnt vmcnt(1)
s_barrier
v_mfma_f32_32x32x16_bf16 v[80:95], v[64:67], v[48:51], v[80:95]
ds_read_b128 v[44:47], v20 offset:0
ds_read_b64_tr_b16 v[52:53], v32 offset:0
ds_read_b64_tr_b16 v[54:55], v32 offset:256
v_mfma_f32_4x4x4_16b_bf16 v[240:243], v[48:49], v[48:49], v[240:243]
v_mfma_f32_4x4x4_16b_bf16 v[248:251], v[48:49], v[40:41], v[248:251]
v_mfma_f32_32x32x16_bf16 v[96:111], v[68:71], v[48:51], v[96:111]
ds_read_b64_tr_b16 v[56:57], v32 offset:1024
ds_read_b64_tr_b16 v[58:59], v32 offset:1280
ds_read_b64_tr_b16 v[60:61], v32 offset:2048
ds_read_b64_tr_b16 v[62:63], v32 offset:2304
v_mfma_f32_4x4x4_16b_bf16 v[244:247], v[50:51], v[50:51], v[244:247]
v_mfma_f32_4x4x4_16b_bf16 v[252:255], v[50:51], v[40:41], v[252:255]
v_mfma_f32_32x32x16_bf16 v[112:127], v[48:51], v[72:75], v[112:127]
s_waitcnt lgkmcnt(0)
v_mfma_f32_32x32x16_bf16 v[80:95], v[52:55], v[44:47], v[80:95]
ds_read_b128 v[48:51], v21 offset:0
ds_read_b64_tr_b16 v[64:65], v33 offset:0
ds_read_b64_tr_b16 v[66:67], v33 offset:256
v_mfma_f32_4x4x4_16b_bf16 v[240:243], v[44:45], v[44:45], v[240:243]
v_mfma_f32_4x4x4_16b_bf16 v[248:251], v[44:45], v[40:41], v[248:251]
v_mfma_f32_32x32x16_bf16 v[96:111], v[56:59], v[44:47], v[96:111]
ds_read_b64_tr_b16 v[68:69], v33 offset:1024
ds_read_b64_tr_b16 v[70:71], v33 offset:1280
ds_read_b64_tr_b16 v[72:73], v33 offset:2048
ds_read_b64_tr_b16 v[74:75], v33 offset:2304
v_mfma_f32_4x4x4_16b_bf16 v[244:247], v[46:47], v[46:47], v[244:247]
v_mfma_f32_4x4x4_16b_bf16 v[252:255], v[46:47], v[40:41], v[252:255]
v_mfma_f32_32x32x16_bf16 v[112:127], v[44:47], v[60:63], v[112:127]
v_mfma_f32_32x32x16_bf16 v[144:159], v[40:43], v[52:55], v[144:159]
v_mfma_f32_32x32x16_bf16 v[160:175], v[40:43], v[56:59], v[160:175]
v_mfma_f32_32x32x16_bf16 v[176:191], v[40:43], v[60:63], v[176:191]
s_waitcnt lgkmcnt(0)
v_mfma_f32_32x32x16_bf16 v[80:95], v[64:67], v[48:51], v[80:95]
ds_read_b128 v[44:47], v22 offset:0
ds_read_b64_tr_b16 v[52:53], v34 offset:0
ds_read_b64_tr_b16 v[54:55], v34 offset:256
v_mfma_f32_4x4x4_16b_bf16 v[240:243], v[48:49], v[48:49], v[240:243]
v_mfma_f32_4x4x4_16b_bf16 v[248:251], v[48:49], v[40:41], v[248:251]
v_mfma_f32_32x32x16_bf16 v[96:111], v[68:71], v[48:51], v[96:111]
ds_read_b64_tr_b16 v[56:57], v34 offset:1024
ds_read_b64_tr_b16 v[58:59], v34 offset:1280
ds_read_b64_tr_b16 v[60:61], v34 offset:2048
ds_read_b64_tr_b16 v[62:63], v34 offset:2304
v_mfma_f32_4x4x4_16b_bf16 v[244:247], v[50:51], v[50:51], v[244:247]
v_mfma_f32_4x4x4_16b_bf16 v[252:255], v[50:51], v[40:41], v[252:255]
v_mfma_f32_32x32x16_bf16 v[112:127], v[48:51], v[72:75], v[112:127]
s_waitcnt lgkmcnt(0)
v_mfma_f32_32x32x16_bf16 v[80:95], v[52:55], v[44:47], v[80:95]
ds_read_b128 v[48:51], v23 offset:0
ds_read_b64_tr_b16 v[64:65], v35 offset:0
ds_read_b64_tr_b16 v[66:67], v35 offset:256
v_mfma_f32_4x4x4_16b_bf16 v[240:243], v[44:45], v[44:45], v[240:243]
v_mfma_f32_4x4x4_16b_bf16 v[248:251], v[44:45], v[40:41], v[248:251]
v_mfma_f32_32x32x16_bf16 v[96:111], v[56:59], v[44:47], v[96:111]
ds_read_b64_tr_b16 v[68:69], v35 offset:1024
ds_read_b64_tr_b16 v[70:71], v35 offset:1280
ds_read_b64_tr_b16 v[72:73], v35 offset:2048
ds_read_b64_tr_b16 v[74:75], v35 offset:2304
v_mfma_f32_4x4x4_16b_bf16 v[244:247], v[46:47], v[46:47], v[244:247]
v_mfma_f32_4x4x4_16b_bf16 v[252:255], v[46:47], v[40:41], v[252:255]
v_mfma_f32_32x32x16_bf16 v[112:127], v[44:47], v[60:63], v[112:127]
ds_write_b32 v209, v144 offset:0
ds_write_b32 v209, v160 offset:128
ds_write_b32 v209, v176 offset:256
s_waitcnt lgkmcnt(0)
v_mfma_f32_32x32x16_bf16 v[80:95], v[64:67], v[48:51], v[80:95]
v_mfma_f32_4x4x4_16b_bf16 v[240:243], v[48:49], v[48:49], v[240:243]
v_mfma_f32_4x4x4_16b_bf16 v[248:251], v[48:49], v[40:41], v[248:251]
v_mfma_f32_32x32x16_bf16 v[96:111], v[68:71], v[48:51], v[96:111]
v_mfma_f32_4x4x4_16b_bf16 v[244:247], v[50:51], v[50:51], v[244:247]
v_mfma_f32_4x4x4_16b_bf16 v[252:255], v[50:51], v[40:41], v[252:255]
v_mfma_f32_32x32x16_bf16 v[112:127], v[48:51], v[72:75], v[112:127]
s_waitcnt lgkmcnt(0)
s_barrier
ds_read_b32 v192, v14 offset:0
ds_read_b32 v193, v14 offset:384
ds_read_b32 v194, v14 offset:768
ds_read_b32 v195, v14 offset:1152
ds_read_b32 v196, v13 offset:0
ds_read_b32 v197, v13 offset:384
ds_read_b32 v198, v13 offset:768
ds_read_b32 v199, v13 offset:1152
v_pk_add_f32 v[240:241], v[240:241], v[244:245]
v_pk_add_f32 v[248:249], v[248:249], v[252:253]
v_pk_add_f32 v[242:243], v[242:243], v[246:247]
v_pk_add_f32 v[250:251], v[250:251], v[254:255]
v_cndmask_b32 v43, v240, v241, s[88:89]
v_cndmask_b32 v42, v248, v249, s[88:89]
v_cndmask_b32 v43, v43, v242, s[78:79]
v_cndmask_b32 v42, v42, v250, s[78:79]
v_cndmask_b32 v43, v43, v243, s[76:77]
v_cndmask_b32 v42, v42, v251, s[76:77]
s_waitcnt lgkmcnt(0)
v_pk_add_f32 v[192:193], v[192:193], v[194:195]
v_pk_add_f32 v[196:197], v[196:197], v[198:199]
v_add_f32 v192, v192, v193
v_add_f32 v208, v196, v197
ds_write_b32 v15, v192
ds_read_b128 v[160:163], v210 offset:128
ds_read_b128 v[164:167], v210 offset:160
ds_read_b128 v[168:171], v210 offset:192
ds_read_b128 v[172:175], v210 offset:224
ds_read_b128 v[144:147], v210 offset:0
ds_read_b128 v[148:151], v210 offset:32
ds_read_b128 v[152:155], v210 offset:64
ds_read_b128 v[156:159], v210 offset:96
v_mov_b32 v128, v42
v_mov_b32 v129, v43
s_nop 0
v_permlane32_swap_b32 v42, v128
v_permlane32_swap_b32 v43, v129
v_add_f32 v42, v42, v128
v_add_f32 v43, v43, v129
v_mul_f32 v130, 0x3b000000, v42
v_mul_f32 v128, 0x3b000000, v43
ds_write_b32 v211, v130 offset:128
v_fma_f32 v128, -v130, v130, v128
v_max_f32 v128, 0, v128
v_add_f32 v128, 0x3727c5ac, v128
v_rsq_f32 v132, v128
ds_read_b128 v[192:195], v212 offset:128
ds_read_b128 v[196:199], v212 offset:160
ds_read_b128 v[200:203], v212 offset:192
ds_read_b128 v[204:207], v212 offset:224
ds_write_b32 v211, v132
v_mul_f32 v134, 0x3eb8aa3b, v132
ds_read_b128 v[176:179], v212 offset:0
ds_read_b128 v[180:183], v212 offset:32
ds_read_b128 v[184:187], v212 offset:64
ds_read_b128 v[188:191], v212 offset:96
s_waitcnt lgkmcnt(14)
v_pk_fma_f32 v[96:97], v[130:131], v[160:161], v[96:97] op_sel_hi:[0,1,1] neg_lo:[1,0,0] neg_hi:[1,0,0]
v_pk_fma_f32 v[98:99], v[130:131], v[162:163], v[98:99] op_sel_hi:[0,1,1] neg_lo:[1,0,0] neg_hi:[1,0,0]
v_pk_fma_f32 v[100:101], v[130:131], v[164:165], v[100:101] op_sel_hi:[0,1,1] neg_lo:[1,0,0] neg_hi:[1,0,0]
v_pk_fma_f32 v[102:103], v[130:131], v[166:167], v[102:103] op_sel_hi:[0,1,1] neg_lo:[1,0,0] neg_hi:[1,0,0]
v_pk_fma_f32 v[104:105], v[130:131], v[168:169], v[104:105] op_sel_hi:[0,1,1] neg_lo:[1,0,0] neg_hi:[1,0,0]
v_pk_fma_f32 v[106:107], v[130:131], v[170:171], v[106:107] op_sel_hi:[0,1,1] neg_lo:[1,0,0] neg_hi:[1,0,0]
v_pk_fma_f32 v[108:109], v[130:131], v[172:173], v[108:109] op_sel_hi:[0,1,1] neg_lo:[1,0,0] neg_hi:[1,0,0]
v_pk_fma_f32 v[110:111], v[130:131], v[174:175], v[110:111] op_sel_hi:[0,1,1] neg_lo:[1,0,0] neg_hi:[1,0,0]
v_pk_mul_f32 v[96:97], v[132:133], v[96:97] op_sel_hi:[0,1]
v_pk_mul_f32 v[98:99], v[132:133], v[98:99] op_sel_hi:[0,1]
v_pk_mul_f32 v[100:101], v[132:133], v[100:101] op_sel_hi:[0,1]
v_pk_mul_f32 v[102:103], v[132:133], v[102:103] op_sel_hi:[0,1]
v_pk_mul_f32 v[104:105], v[132:133], v[104:105] op_sel_hi:[0,1]
v_pk_mul_f32 v[106:107], v[132:133], v[106:107] op_sel_hi:[0,1]
v_pk_mul_f32 v[108:109], v[132:133], v[108:109] op_sel_hi:[0,1]
v_pk_mul_f32 v[110:111], v[132:133], v[110:111] op_sel_hi:[0,1]
v_cvt_pk_bf16_f32 v224, v96, v97
v_cvt_pk_bf16_f32 v225, v98, v99
v_cvt_pk_bf16_f32 v226, v100, v101
v_cvt_pk_bf16_f32 v227, v102, v103
v_cvt_pk_bf16_f32 v228, v104, v105
v_cvt_pk_bf16_f32 v229, v106, v107
v_cvt_pk_bf16_f32 v230, v108, v109
v_cvt_pk_bf16_f32 v231, v110, v111
buffer_store_dwordx4 v[224:227], v6, s[40:43], s50 offen sc1
buffer_store_dwordx4 v[228:231], v6, s[40:43], s51 offen sc1
s_waitcnt lgkmcnt(10)
v_pk_fma_f32 v[80:81], v[130:131], v[144:145], v[80:81] op_sel_hi:[0,1,1] neg_lo:[1,0,0] neg_hi:[1,0,0]
v_pk_fma_f32 v[82:83], v[130:131], v[146:147], v[82:83] op_sel_hi:[0,1,1] neg_lo:[1,0,0] neg_hi:[1,0,0]
v_pk_fma_f32 v[84:85], v[130:131], v[148:149], v[84:85] op_sel_hi:[0,1,1] neg_lo:[1,0,0] neg_hi:[1,0,0]
v_pk_fma_f32 v[86:87], v[130:131], v[150:151], v[86:87] op_sel_hi:[0,1,1] neg_lo:[1,0,0] neg_hi:[1,0,0]
v_pk_fma_f32 v[88:89], v[130:131], v[152:153], v[88:89] op_sel_hi:[0,1,1] neg_lo:[1,0,0] neg_hi:[1,0,0]
v_pk_fma_f32 v[90:91], v[130:131], v[154:155], v[90:91] op_sel_hi:[0,1,1] neg_lo:[1,0,0] neg_hi:[1,0,0]
v_pk_fma_f32 v[92:93], v[130:131], v[156:157], v[92:93] op_sel_hi:[0,1,1] neg_lo:[1,0,0] neg_hi:[1,0,0]
v_pk_fma_f32 v[94:95], v[130:131], v[158:159], v[94:95] op_sel_hi:[0,1,1] neg_lo:[1,0,0] neg_hi:[1,0,0]
v_pk_mul_f32 v[80:81], v[134:135], v[80:81] op_sel_hi:[0,1]
v_pk_mul_f32 v[82:83], v[134:135], v[82:83] op_sel_hi:[0,1]
v_pk_mul_f32 v[84:85], v[134:135], v[84:85] op_sel_hi:[0,1]
v_pk_mul_f32 v[86:87], v[134:135], v[86:87] op_sel_hi:[0,1]
v_pk_mul_f32 v[88:89], v[134:135], v[88:89] op_sel_hi:[0,1]
v_pk_mul_f32 v[90:91], v[134:135], v[90:91] op_sel_hi:[0,1]
v_pk_mul_f32 v[92:93], v[134:135], v[92:93] op_sel_hi:[0,1]
v_pk_mul_f32 v[94:95], v[134:135], v[94:95] op_sel_hi:[0,1]
v_cvt_pk_bf16_f32 v216, v80, v81
v_cvt_pk_bf16_f32 v217, v82, v83
v_cvt_pk_bf16_f32 v218, v84, v85
v_cvt_pk_bf16_f32 v219, v86, v87
v_cvt_pk_bf16_f32 v220, v88, v89
v_cvt_pk_bf16_f32 v221, v90, v91
v_cvt_pk_bf16_f32 v222, v92, v93
v_cvt_pk_bf16_f32 v223, v94, v95
buffer_store_dwordx4 v[216:219], v6, s[40:43], s48 offen sc1
buffer_store_dwordx4 v[220:223], v6, s[40:43], s49 offen sc1
s_waitcnt lgkmcnt(0)
v_pk_fma_f32 v[112:113], v[208:209], v[192:193], v[112:113] op_sel_hi:[0,1,1] neg_lo:[1,0,0] neg_hi:[1,0,0]
v_pk_fma_f32 v[114:115], v[208:209], v[194:195], v[114:115] op_sel_hi:[0,1,1] neg_lo:[1,0,0] neg_hi:[1,0,0]
v_pk_fma_f32 v[116:117], v[208:209], v[196:197], v[116:117] op_sel_hi:[0,1,1] neg_lo:[1,0,0] neg_hi:[1,0,0]
v_pk_fma_f32 v[118:119], v[208:209], v[198:199], v[118:119] op_sel_hi:[0,1,1] neg_lo:[1,0,0] neg_hi:[1,0,0]
v_pk_fma_f32 v[120:121], v[208:209], v[200:201], v[120:121] op_sel_hi:[0,1,1] neg_lo:[1,0,0] neg_hi:[1,0,0]
v_pk_fma_f32 v[122:123], v[208:209], v[202:203], v[122:123] op_sel_hi:[0,1,1] neg_lo:[1,0,0] neg_hi:[1,0,0]
v_pk_fma_f32 v[124:125], v[208:209], v[204:205], v[124:125] op_sel_hi:[0,1,1] neg_lo:[1,0,0] neg_hi:[1,0,0]
v_pk_fma_f32 v[126:127], v[208:209], v[206:207], v[126:127] op_sel_hi:[0,1,1] neg_lo:[1,0,0] neg_hi:[1,0,0]
v_pk_mul_f32 v[112:113], v[176:177], v[112:113]
v_pk_mul_f32 v[114:115], v[178:179], v[114:115]
v_pk_mul_f32 v[116:117], v[180:181], v[116:117]
v_pk_mul_f32 v[118:119], v[182:183], v[118:119]
v_pk_mul_f32 v[120:121], v[184:185], v[120:121]
v_pk_mul_f32 v[122:123], v[186:187], v[122:123]
v_pk_mul_f32 v[124:125], v[188:189], v[124:125]
v_pk_mul_f32 v[126:127], v[190:191], v[126:127]
v_cvt_pk_bf16_f32 v232, v112, v113
v_cvt_pk_bf16_f32 v233, v114, v115
v_cvt_pk_bf16_f32 v234, v116, v117
v_cvt_pk_bf16_f32 v235, v118, v119
v_cvt_pk_bf16_f32 v236, v120, v121
v_cvt_pk_bf16_f32 v237, v122, v123
v_cvt_pk_bf16_f32 v238, v124, v125
v_cvt_pk_bf16_f32 v239, v126, v127
buffer_store_dwordx4 v[232:235], v213, s[40:43], s52 offen sc1
buffer_store_dwordx4 v[236:239], v213, s[40:43], s52 offen offset:512 sc1
v_pk_mul_f32 v[136:137], v[96:97], v[96:97]
v_pk_mul_f32 v[138:139], v[104:105], v[104:105]
v_pk_fma_f32 v[136:137], v[98:99], v[98:99], v[136:137]
v_pk_fma_f32 v[138:139], v[106:107], v[106:107], v[138:139]
v_pk_fma_f32 v[136:137], v[100:101], v[100:101], v[136:137]
v_pk_fma_f32 v[138:139], v[108:109], v[108:109], v[138:139]
v_pk_fma_f32 v[136:137], v[102:103], v[102:103], v[136:137]
v_pk_fma_f32 v[138:139], v[110:111], v[110:111], v[138:139]
v_add_f32 v136, v136, v137
v_add_f32 v138, v138, v139
s_nop 1
v_permlane32_swap_b32 v136, v138
v_add_f32 v136, v136, v138
s_nop 1
v_max_f32_dpp v136, v136, v136 row_ror:8 row_mask:0xf bank_mask:0xf
s_nop 1
v_max_f32_dpp v136, v136, v136 row_ror:4 row_mask:0xf bank_mask:0xf
s_nop 1
v_max_f32_dpp v136, v136, v136 row_ror:2 row_mask:0xf bank_mask:0xf
s_nop 1
v_max_f32_dpp v136, v136, v136 row_ror:1 row_mask:0xf bank_mask:0xf
v_mov_b32 v128, v136
s_nop 1
v_permlane16_swap_b32 v136, v128
v_max_f32 v136, v136, v128
s_mov_b32 s74, 1
s_mov_b32 s75, 1
s_mov_b64 exec, s[74:75]
buffer_store_dword v136, v214, s[40:43], s53 offen sc1
s_mov_b64 exec, -1
s_waitcnt vmcnt(7)
s_cmp_lg_u32 s3, 0
s_cbranch_scc1 L_w0_3
v_readfirstlane_b32 s96, v79
s_nop 2
s_cmp_eq_u32 s96, 1
s_cbranch_scc1 L_w0_3
v_mov_b32 v1, 0
s_mov_b32 s76, 0
L_initpoll_4:
global_load_dword v79, v1, s[44:45] sc1
s_add_u32 s76, s76, 1
s_waitcnt vmcnt(0)
v_readfirstlane_b32 s96, v79
s_nop 2
s_cmp_eq_u32 s96, 1
s_cbranch_scc1 L_w0_3
s_cmp_lt_u32 s76, 0x40000
s_cbranch_scc1 L_initpoll_4
L_w0_3:
s_waitcnt vmcnt(0)
s_barrier
s_cmp_lg_u32 s3, 0
s_cbranch_scc1 L_w0_5
s_mov_b64 exec, 1
v_mov_b32 v1, 1
v_mov_b32 v2, s67
buffer_atomic_add v1, v2, s[40:43], 0 offen sc1
s_mov_b64 exec, -1
L_w0_5:
s_and_b32 s48, s46, 1
s_lshl_b32 s48, s48, 2
s_and_b32 s49, s47, 3
s_add_u32 s63, s48, s49
s_lshr_b32 s48, s46, 1
s_lshl_b32 s48, s48, 3
s_lshr_b32 s49, s47, 2
s_add_u32 s62, s48, s49
s_and_b32 s48, s46, 3
s_lshl_b32 s48, s48, 1
s_and_b32 s49, s47, 1
s_add_u32 s65, s48, s49
s_lshr_b32 s48, s46, 2
s_mul_i32 s48, s48, 11
s_lshr_b32 s49, s47, 1
s_add_u32 s64, s48, s49
s_cmp_lt_u32 s47, 22
s_cselect_b32 s22, s22, 0
s_lshl_b32 s48, s46, 2
s_lshr_b32 s49, s47, 3
s_add_u32 s88, s48, s49
s_and_b32 s89, s47, 7
s_mov_b32 s88, s62
s_mov_b32 s89, s63
s_lshr_b32 s50, s3, 1
s_lshl_b32 s50, s50, 15
s_and_b32 s49, s3, 1
s_lshl_b32 s49, s49, 6
s_add_u32 s50, s50, s49
s_lshl_b32 s48, s62, 16
s_lshl_b32 s49, s63, 7
s_add_u32 s48, s48, s49
s_add_u32 s66, s48, s50
s_lshl_b32 s48, s88, 16
s_lshl_b32 s49, s89, 7
s_add_u32 s48, s48, s49
s_add_u32 s78, s48, s50
s_lshl_b32 s48, s46, 2
s_lshr_b32 s49, s47, 3
s_add_u32 s56, s48, s49
s_and_b32 s57, s47, 7
v_and_b32 v1, 31, v0
v_lshrrev_b32 v2, 3, v1
v_mul_u32_u24 v2, 16640, v2
v_and_b32 v3, 7, v1
v_mul_u32_u24 v3, 2080, v3
v_add_u32 v2, v2, v3
v_mov_b32 v16, 0x3f803f80
v_mov_b32 v20, 0
v_mov_b32 v17, 0x3f803f80
v_mov_b32 v21, 0
v_mov_b32 v18, 0x3f803f80
v_mov_b32 v22, 0
v_mov_b32 v19, 0x3f803f80
v_mov_b32 v23, 0
ds_write_b128 v2, v[16:19] offset:2048
ds_write_b128 v2, v[20:23] offset:2064
v_and_b32 v1, 31, v0
v_lshrrev_b32 v2, 5, v0
v_lshlrev_b32 v2, 8, v2
v_lshl_add_u32 v2, v1, 4, v2
v_add_u32 v2, 1024, v2
v_add_u32 v3, 512, v2
v_mov_b32 v4, 2048
v_mov_b32 v5, 2064
v_cmp_eq_u32 vcc, 16, v1
s_nop 1
v_cndmask_b32 v4, v5, v4, vcc
v_cmp_gt_u32 vcc, 16, v1
s_nop 1
v_cndmask_b32 v121, v4, v2, vcc
v_cndmask_b32 v122, v4, v3, vcc
s_lshl_b32 s48, s64, 7
v_lshrrev_b32 v1, 3, v0
v_mul_u32_u24 v1, 2752, v1
v_and_b32 v2, 7, v0
v_bfe_u32 v3, v0, 4, 1
v_lshlrev_b32 v3, 2, v3
v_xor_b32 v2, v2, v3
v_lshlrev_b32 v2, 4, v2
v_add3_u32 v136, v1, v2, s48
v_add_u32 v137, 22016, v136
s_mul_i32 s85, s3, 1409024
s_lshl_b32 s48, s62, 7
v_lshrrev_b32 v1, 3, v0
v_mul_u32_u24 v1, 4096, v1
v_and_b32 v2, 7, v0
v_bfe_u32 v3, v0, 4, 1
v_lshlrev_b32 v3, 2, v3
v_xor_b32 v2, v2, v3
v_lshlrev_b32 v2, 4, v2
v_add3_u32 v138, v1, v2, s48
v_add_u32 v139, 31744, v138
s_mul_i32 s86, s3, 1441792
s_lshl_b32 s48, s89, 7
v_lshrrev_b32 v1, 3, v0
v_mul_u32_u24 v1, 1024, v1
v_and_b32 v2, 7, v0
v_bfe_u32 v3, v0, 4, 1
v_lshlrev_b32 v3, 2, v3
v_xor_b32 v2, v2, v3
v_lshlrev_b32 v2, 4, v2
v_add3_u32 v140, v1, v2, s48
v_add_u32 v141, 7168, v140
s_lshl_b32 s84, s3, 17
s_lshr_b32 s48, s3, 1
s_lshl_b32 s48, s48, 6
s_lshl_b32 s49, s64, 7
s_add_u32 s73, s48, s49
s_lshl_b32 s49, s62, 7
s_add_u32 s77, s48, s49
v_and_b32 v1, 31, v0
v_lshlrev_b32 v1, 10, v1
v_lshrrev_b32 v2, 5, v0
v_lshl_add_u32 v142, v2, 3, v1
s_lshl_b32 s48, s56, 17
s_lshl_b32 s49, s3, 12
s_add_u32 s58, s48, s49
s_add_u32 s58, s58, 0x300000
s_mul_i32 s59, s3, 4160
s_lshl_b32 s69, s56, 16
s_lshl_b32 s49, s57, 13
s_add_u32 s69, s69, s49
s_lshl_b32 s49, s3, 11
s_add_u32 s69, s69, s49
s_add_u32 s69, s69, 0x100000
s_lshl_b32 s70, s56, 8
s_add_u32 s70, s70, 0x48000
v_lshlrev_b32 v7, 2, v0
s_lshr_b32 s68, s56, 1
s_lshl_b32 s68, s68, 8
s_add_u32 s68, s68, 0
s_lshl_b32 s71, s57, 3
s_lshl_b32 s49, s3, 1
s_add_u32 s71, s71, s49
s_lshl_b32 s71, s71, 5
s_add_u32 s71, s71, s56
s_lshl_b32 s71, s71, 10
s_add_u32 s71, s71, 0x800000
s_add_u32 s72, s71, 32768
s_waitcnt lgkmcnt(0)
s_cmp_lg_u32 s3, 0
s_cbranch_scc1 L_w0_6
v_mov_b32 v2, s68
s_mov_b32 s76, 0
L_poll_7:
buffer_load_dword v1, v2, s[40:43], 0 offen sc1
s_add_u32 s76, s76, 1
s_waitcnt vmcnt(0)
v_readfirstlane_b32 s48, v1
s_nop 2
s_cmp_ge_u32 s48, 16
s_cbranch_scc1 L_w0_6
s_cmp_lt_u32 s76, 0x40000
s_cbranch_scc1 L_poll_7
L_w0_6:
s_barrier
buffer_load_dwordx4 v[8:11], v6, s[40:43], s69 offen sc1
buffer_load_dwordx4 v[12:15], v6, s[40:43], s69 offen offset:1024 sc1
buffer_load_dword v124, v7, s[40:43], s70 offen sc1
s_add_u32 m0, s59, 0
s_nop 0
buffer_load_dwordx4 v6, s[40:43], s58 offen sc1 lds
buffer_load_dwordx4 v6, s[40:43], s58 offen offset:1024 sc1 lds
s_add_u32 m0, s59, 32
s_nop 0
buffer_load_dwordx4 v6, s[40:43], s58 offen offset:2048 sc1 lds
buffer_load_dwordx4 v6, s[40:43], s58 offen offset:3072 sc1 lds
s_add_u32 s58, s58, 16384
s_waitcnt vmcnt(4)
v_lshlrev_b32 v44, 16, v8
v_and_b32 v45, s83, v8
v_lshlrev_b32 v46, 16, v9
v_and_b32 v47, s83, v9
v_lshlrev_b32 v48, 16, v10
v_and_b32 v49, s83, v10
v_lshlrev_b32 v50, 16, v11
v_and_b32 v51, s83, v11
v_pk_mul_f32 v[40:41], v[44:45], v[44:45]
v_pk_fma_f32 v[40:41], v[46:47], v[46:47], v[40:41]
v_pk_fma_f32 v[40:41], v[48:49], v[48:49], v[40:41]
v_pk_fma_f32 v[40:41], v[50:51], v[50:51], v[40:41]
v_add_f32 v40, v40, v41
v_lshlrev_b32 v44, 16, v12
v_and_b32 v45, s83, v12
v_lshlrev_b32 v46, 16, v13
v_and_b32 v47, s83, v13
v_lshlrev_b32 v48, 16, v14
v_and_b32 v49, s83, v14
v_lshlrev_b32 v50, 16, v15
v_and_b32 v51, s83, v15
v_pk_mul_f32 v[42:43], v[44:45], v[44:45]
v_pk_fma_f32 v[42:43], v[46:47], v[46:47], v[42:43]
v_pk_fma_f32 v[42:43], v[48:49], v[48:49], v[42:43]
v_pk_fma_f32 v[42:43], v[50:51], v[50:51], v[42:43]
v_add_f32 v42, v42, v43
s_nop 1
v_permlane32_swap_b32 v40, v42
v_add_f32 v40, v40, v42
v_max_f32_dpp v124, v124, v124 row_ror:8 row_mask:0xf bank_mask:0xf
s_nop 1
v_max_f32_dpp v124, v124, v124 row_ror:4 row_mask:0xf bank_mask:0xf
s_nop 1
v_max_f32_dpp v124, v124, v124 row_ror:2 row_mask:0xf bank_mask:0xf
s_nop 1
v_max_f32_dpp v124, v124, v124 row_ror:1 row_mask:0xf bank_mask:0xf
v_mov_b32 v1, v124
s_nop 1
v_permlane16_swap_b32 v124, v1
v_max_f32 v124, v124, v1
v_mov_b32 v1, v124
s_nop 1
v_permlane32_swap_b32 v124, v1
v_max_f32 v124, v124, v1
v_mul_f32 v40, v40, v124
v_mov_b32 v1, 0x45610000
v_cmp_nle_f32 vcc, v40, v1
s_nop 2
s_cmp_lg_u64 vcc, 0
s_cselect_b32 s48, 1, 0
v_mov_b32 v1, s48
s_lshl_b32 s49, s3, 2
s_add_u32 s49, s49, 156672
v_mov_b32 v2, s49
ds_write_b32 v2, v1
v_mov_b32 v7, 156672
s_waitcnt lgkmcnt(0)
s_waitcnt vmcnt(0)
s_barrier
ds_read_b128 v[2:5], v7
ds_read_b128 v[16:19], v6 offset:0
s_waitcnt lgkmcnt(0)
v_mfma_f32_32x32x16_bf16 v[40:55], v[16:19], v[8:11], 0
v_mfma_f32_32x32x16_bf16 v[56:71], v[16:19], v[12:15], 0
ds_read_b128 v[20:23], v6 offset:2080
ds_read_b128 v[24:27], v121 offset:0
ds_read_b128 v[28:31], v122 offset:0
s_nop 7
v_exp_f32 v40, v40
v_exp_f32 v41, v41
v_exp_f32 v42, v42
v_exp_f32 v43, v43
v_exp_f32 v44, v44
v_cvt_pk_bf16_f32 v72, v40, v41
v_cvt_pk_bf16_f32 v73, v42, v43
v_exp_f32 v45, v45
v_exp_f32 v46, v46
v_exp_f32 v47, v47
v_exp_f32 v48, v48
v_exp_f32 v49, v49
v_cvt_pk_bf16_f32 v74, v44, v45
v_cvt_pk_bf16_f32 v75, v46, v47
s_mul_i32 s87, s3, 16384
s_add_u32 m0, s87, 66560
v_exp_f32 v50, v50
v_exp_f32 v51, v51
v_cvt_pk_bf16_f32 v76, v48, v49
v_exp_f32 v52, v52
v_exp_f32 v53, v53
v_cvt_pk_bf16_f32 v77, v50, v51
v_exp_f32 v54, v54
v_exp_f32 v55, v55
v_cvt_pk_bf16_f32 v78, v52, v53
v_cvt_pk_bf16_f32 v79, v54, v55
s_waitcnt lgkmcnt(0)
v_or3_b32 v1, v2, v3, v4
v_or_b32 v1, v1, v5
s_nop 0
v_readfirstlane_b32 s48, v1
s_nop 2
s_cmp_lg_u32 s48, 0
s_cbranch_scc1 L_fallback
v_mfma_f32_32x32x16_bf16 v[40:55], v[20:23], v[8:11], 0
buffer_load_dwordx4 v140, s[16:19], s84 offen lds
buffer_load_dwordx4 v141, s[16:19], s84 offen offset:1024 lds
v_exp_f32 v56, v56
v_exp_f32 v57, v57
v_exp_f32 v58, v58
v_exp_f32 v59, v59
v_exp_f32 v60, v60
v_cvt_pk_bf16_f32 v80, v56, v57
v_cvt_pk_bf16_f32 v81, v58, v59
v_mfma_f32_32x32x16_bf16 v[88:103], v[24:27], v[72:75], 0
s_add_u32 s84, s84, 16384
s_add_u32 m0, s59, 16640
s_nop 0
buffer_load_dwordx4 v6, s[40:43], s58 offen sc1 lds
buffer_load_dwordx4 v6, s[40:43], s58 offen offset:1024 sc1 lds
s_add_u32 m0, s59, 16672
s_nop 0
buffer_load_dwordx4 v6, s[40:43], s58 offen offset:2048 sc1 lds
buffer_load_dwordx4 v6, s[40:43], s58 offen offset:3072 sc1 lds
s_add_u32 s58, s58, 16384
v_exp_f32 v61, v61
v_exp_f32 v62, v62
v_exp_f32 v63, v63
v_exp_f32 v64, v64
v_exp_f32 v65, v65
v_cvt_pk_bf16_f32 v82, v60, v61
v_cvt_pk_bf16_f32 v83, v62, v63
v_mfma_f32_32x32x16_bf16 v[88:103], v[28:31], v[76:79], v[88:103]
v_exp_f32 v66, v66
v_exp_f32 v67, v67
v_cvt_pk_bf16_f32 v84, v64, v65
v_exp_f32 v68, v68
v_exp_f32 v69, v69
v_cvt_pk_bf16_f32 v85, v66, v67
v_exp_f32 v70, v70
v_exp_f32 v71, v71
v_cvt_pk_bf16_f32 v86, v68, v69
v_cvt_pk_bf16_f32 v87, v70, v71
v_mfma_f32_32x32x16_bf16 v[56:71], v[20:23], v[12:15], 0
ds_read_b128 v[16:19], v6 offset:4160
ds_read_b128 v[32:35], v121 offset:2080
ds_read_b128 v[36:39], v122 offset:2080
v_exp_f32 v40, v40
v_exp_f32 v41, v41
v_exp_f32 v42, v42
v_exp_f32 v43, v43
v_exp_f32 v44, v44
v_cvt_pk_bf16_f32 v72, v40, v41
v_cvt_pk_bf16_f32 v73, v42, v43
v_mfma_f32_32x32x16_bf16 v[104:119], v[24:27], v[80:83], 0
v_exp_f32 v45, v45
v_exp_f32 v46, v46
v_exp_f32 v47, v47
v_exp_f32 v48, v48
v_exp_f32 v49, v49
v_cvt_pk_bf16_f32 v74, v44, v45
v_cvt_pk_bf16_f32 v75, v46, v47
v_mfma_f32_32x32x16_bf16 v[104:119], v[28:31], v[84:87], v[104:119]
s_add_u32 m0, s87, 68608
v_exp_f32 v50, v50
v_exp_f32 v51, v51
v_cvt_pk_bf16_f32 v76, v48, v49
v_exp_f32 v52, v52
v_exp_f32 v53, v53
v_cvt_pk_bf16_f32 v77, v50, v51
v_exp_f32 v54, v54
v_exp_f32 v55, v55
v_cvt_pk_bf16_f32 v78, v52, v53
v_cvt_pk_bf16_f32 v79, v54, v55
s_waitcnt lgkmcnt(0)
v_mfma_f32_32x32x16_bf16 v[40:55], v[16:19], v[8:11], 0
buffer_load_dwordx4 v140, s[16:19], s84 offen lds
buffer_load_dwordx4 v141, s[16:19], s84 offen offset:1024 lds
v_exp_f32 v56, v56
v_exp_f32 v57, v57
v_exp_f32 v58, v58
v_exp_f32 v59, v59
v_exp_f32 v60, v60
v_cvt_pk_bf16_f32 v80, v56, v57
v_cvt_pk_bf16_f32 v81, v58, v59
v_mfma_f32_32x32x16_bf16 v[88:103], v[32:35], v[72:75], v[88:103]
s_add_u32 s84, s84, 16384
s_add_u32 m0, s59, 33280
s_nop 0
buffer_load_dwordx4 v6, s[40:43], s58 offen sc1 lds
buffer_load_dwordx4 v6, s[40:43], s58 offen offset:1024 sc1 lds
s_add_u32 m0, s59, 33312
s_nop 0
buffer_load_dwordx4 v6, s[40:43], s58 offen offset:2048 sc1 lds
buffer_load_dwordx4 v6, s[40:43], s58 offen offset:3072 sc1 lds
s_add_u32 s58, s58, 16384
v_exp_f32 v61, v61
v_exp_f32 v62, v62
v_exp_f32 v63, v63
v_exp_f32 v64, v64
v_exp_f32 v65, v65
v_cvt_pk_bf16_f32 v82, v60, v61
v_cvt_pk_bf16_f32 v83, v62, v63
v_mfma_f32_32x32x16_bf16 v[88:103], v[36:39], v[76:79], v[88:103]
v_exp_f32 v66, v66
v_exp_f32 v67, v67
v_cvt_pk_bf16_f32 v84, v64, v65
v_exp_f32 v68, v68
v_exp_f32 v69, v69
v_cvt_pk_bf16_f32 v85, v66, v67
v_exp_f32 v70, v70
v_exp_f32 v71, v71
v_cvt_pk_bf16_f32 v86, v68, v69
v_cvt_pk_bf16_f32 v87, v70, v71
v_mfma_f32_32x32x16_bf16 v[56:71], v[16:19], v[12:15], 0
ds_read_b128 v[20:23], v6 offset:6240
ds_read_b128 v[24:27], v121 offset:4160
ds_read_b128 v[28:31], v122 offset:4160
v_exp_f32 v40, v40
v_exp_f32 v41, v41
v_exp_f32 v42, v42
v_exp_f32 v43, v43
v_exp_f32 v44, v44
v_cvt_pk_bf16_f32 v72, v40, v41
v_cvt_pk_bf16_f32 v73, v42, v43
v_mfma_f32_32x32x16_bf16 v[104:119], v[32:35], v[80:83], v[104:119]
v_exp_f32 v45, v45
v_exp_f32 v46, v46
v_exp_f32 v47, v47
v_exp_f32 v48, v48
v_exp_f32 v49, v49
v_cvt_pk_bf16_f32 v74, v44, v45
v_cvt_pk_bf16_f32 v75, v46, v47
v_mfma_f32_32x32x16_bf16 v[104:119], v[36:39], v[84:87], v[104:119]
s_add_u32 m0, s87, 70656
v_exp_f32 v50, v50
v_exp_f32 v51, v51
v_cvt_pk_bf16_f32 v76, v48, v49
v_exp_f32 v52, v52
v_exp_f32 v53, v53
v_cvt_pk_bf16_f32 v77, v50, v51
v_exp_f32 v54, v54
v_exp_f32 v55, v55
v_cvt_pk_bf16_f32 v78, v52, v53
v_cvt_pk_bf16_f32 v79, v54, v55
s_waitcnt lgkmcnt(0)
v_mfma_f32_32x32x16_bf16 v[40:55], v[20:23], v[8:11], 0
buffer_load_dwordx4 v140, s[16:19], s84 offen lds
buffer_load_dwordx4 v141, s[16:19], s84 offen offset:1024 lds
v_exp_f32 v56, v56
v_exp_f32 v57, v57
v_exp_f32 v58, v58
v_exp_f32 v59, v59
v_exp_f32 v60, v60
v_cvt_pk_bf16_f32 v80, v56, v57
v_cvt_pk_bf16_f32 v81, v58, v59
v_mfma_f32_32x32x16_bf16 v[88:103], v[24:27], v[72:75], v[88:103]
s_add_u32 s84, s84, 16384
v_exp_f32 v61, v61
v_exp_f32 v62, v62
v_exp_f32 v63, v63
v_exp_f32 v64, v64
v_exp_f32 v65, v65
v_cvt_pk_bf16_f32 v82, v60, v61
v_cvt_pk_bf16_f32 v83, v62, v63
v_mfma_f32_32x32x16_bf16 v[88:103], v[28:31], v[76:79], v[88:103]
v_exp_f32 v66, v66
v_exp_f32 v67, v67
v_cvt_pk_bf16_f32 v84, v64, v65
v_exp_f32 v68, v68
v_exp_f32 v69, v69
v_cvt_pk_bf16_f32 v85, v66, v67
v_exp_f32 v70, v70
v_exp_f32 v71, v71
v_cvt_pk_bf16_f32 v86, v68, v69
v_cvt_pk_bf16_f32 v87, v70, v71
v_mfma_f32_32x32x16_bf16 v[56:71], v[20:23], v[12:15], 0
ds_read_b128 v[16:19], v6 offset:8320
ds_read_b128 v[32:35], v121 offset:6240
ds_read_b128 v[36:39], v122 offset:6240
v_exp_f32 v40, v40
v_exp_f32 v41, v41
v_exp_f32 v42, v42
v_exp_f32 v43, v43
v_exp_f32 v44, v44
v_cvt_pk_bf16_f32 v72, v40, v41
v_cvt_pk_bf16_f32 v73, v42, v43
v_mfma_f32_32x32x16_bf16 v[104:119], v[24:27], v[80:83], v[104:119]
v_exp_f32 v45, v45
v_exp_f32 v46, v46
v_exp_f32 v47, v47
v_exp_f32 v48, v48
v_exp_f32 v49, v49
v_cvt_pk_bf16_f32 v74, v44, v45
v_cvt_pk_bf16_f32 v75, v46, v47
v_mfma_f32_32x32x16_bf16 v[104:119], v[28:31], v[84:87], v[104:119]
s_add_u32 m0, s87, 72704
v_exp_f32 v50, v50
v_exp_f32 v51, v51
v_cvt_pk_bf16_f32 v76, v48, v49
v_exp_f32 v52, v52
v_exp_f32 v53, v53
v_cvt_pk_bf16_f32 v77, v50, v51
v_exp_f32 v54, v54
v_exp_f32 v55, v55
v_cvt_pk_bf16_f32 v78, v52, v53
v_cvt_pk_bf16_f32 v79, v54, v55
s_waitcnt lgkmcnt(0)
v_mfma_f32_32x32x16_bf16 v[40:55], v[16:19], v[8:11], 0
buffer_load_dwordx4 v140, s[16:19], s84 offen lds
buffer_load_dwordx4 v141, s[16:19], s84 offen offset:1024 lds
v_exp_f32 v56, v56
v_exp_f32 v57, v57
v_exp_f32 v58, v58
v_exp_f32 v59, v59
v_exp_f32 v60, v60
v_cvt_pk_bf16_f32 v80, v56, v57
v_cvt_pk_bf16_f32 v81, v58, v59
v_mfma_f32_32x32x16_bf16 v[88:103], v[32:35], v[72:75], v[88:103]
s_add_u32 s84, s84, 16384
v_exp_f32 v61, v61
v_exp_f32 v62, v62
v_exp_f32 v63, v63
v_exp_f32 v64, v64
v_exp_f32 v65, v65
v_cvt_pk_bf16_f32 v82, v60, v61
v_cvt_pk_bf16_f32 v83, v62, v63
v_mfma_f32_32x32x16_bf16 v[88:103], v[36:39], v[76:79], v[88:103]
v_exp_f32 v66, v66
v_exp_f32 v67, v67
v_cvt_pk_bf16_f32 v84, v64, v65
v_exp_f32 v68, v68
v_exp_f32 v69, v69
v_cvt_pk_bf16_f32 v85, v66, v67
v_exp_f32 v70, v70
v_exp_f32 v71, v71
v_cvt_pk_bf16_f32 v86, v68, v69
v_cvt_pk_bf16_f32 v87, v70, v71
v_mfma_f32_32x32x16_bf16 v[56:71], v[16:19], v[12:15], 0
ds_read_b128 v[20:23], v6 offset:10400
ds_read_b128 v[24:27], v121 offset:8320
ds_read_b128 v[28:31], v122 offset:8320
v_exp_f32 v40, v40
v_exp_f32 v41, v41
v_exp_f32 v42, v42
v_exp_f32 v43, v43
v_exp_f32 v44, v44
v_cvt_pk_bf16_f32 v72, v40, v41
v_cvt_pk_bf16_f32 v73, v42, v43
v_mfma_f32_32x32x16_bf16 v[104:119], v[32:35], v[80:83], v[104:119]
v_exp_f32 v45, v45
v_exp_f32 v46, v46
v_exp_f32 v47, v47
v_exp_f32 v48, v48
v_exp_f32 v49, v49
v_cvt_pk_bf16_f32 v74, v44, v45
v_cvt_pk_bf16_f32 v75, v46, v47
v_mfma_f32_32x32x16_bf16 v[104:119], v[36:39], v[84:87], v[104:119]
s_add_u32 m0, s87, 74752
v_exp_f32 v50, v50
v_exp_f32 v51, v51
v_cvt_pk_bf16_f32 v76, v48, v49
v_exp_f32 v52, v52
v_exp_f32 v53, v53
v_cvt_pk_bf16_f32 v77, v50, v51
v_exp_f32 v54, v54
v_exp_f32 v55, v55
v_cvt_pk_bf16_f32 v78, v52, v53
v_cvt_pk_bf16_f32 v79, v54, v55
s_waitcnt lgkmcnt(0)
v_mfma_f32_32x32x16_bf16 v[40:55], v[20:23], v[8:11], 0
buffer_load_dwordx4 v140, s[16:19], s84 offen lds
buffer_load_dwordx4 v141, s[16:19], s84 offen offset:1024 lds
v_exp_f32 v56, v56
v_exp_f32 v57, v57
v_exp_f32 v58, v58
v_exp_f32 v59, v59
v_exp_f32 v60, v60
v_cvt_pk_bf16_f32 v80, v56, v57
v_cvt_pk_bf16_f32 v81, v58, v59
v_mfma_f32_32x32x16_bf16 v[88:103], v[24:27], v[72:75], v[88:103]
s_add_u32 s84, s84, 16384
v_exp_f32 v61, v61
v_exp_f32 v62, v62
v_exp_f32 v63, v63
v_exp_f32 v64, v64
v_exp_f32 v65, v65
v_cvt_pk_bf16_f32 v82, v60, v61
v_cvt_pk_bf16_f32 v83, v62, v63
v_mfma_f32_32x32x16_bf16 v[88:103], v[28:31], v[76:79], v[88:103]
v_exp_f32 v66, v66
v_exp_f32 v67, v67
v_cvt_pk_bf16_f32 v84, v64, v65
v_exp_f32 v68, v68
v_exp_f32 v69, v69
v_cvt_pk_bf16_f32 v85, v66, v67
v_exp_f32 v70, v70
v_exp_f32 v71, v71
v_cvt_pk_bf16_f32 v86, v68, v69
v_cvt_pk_bf16_f32 v87, v70, v71
v_mfma_f32_32x32x16_bf16 v[56:71], v[20:23], v[12:15], 0
ds_read_b128 v[16:19], v6 offset:12480
ds_read_b128 v[32:35], v121 offset:10400
ds_read_b128 v[36:39], v122 offset:10400
v_exp_f32 v40, v40
v_exp_f32 v41, v41
v_exp_f32 v42, v42
v_exp_f32 v43, v43
v_exp_f32 v44, v44
v_cvt_pk_bf16_f32 v72, v40, v41
v_cvt_pk_bf16_f32 v73, v42, v43
v_mfma_f32_32x32x16_bf16 v[104:119], v[24:27], v[80:83], v[104:119]
v_exp_f32 v45, v45
v_exp_f32 v46, v46
v_exp_f32 v47, v47
v_exp_f32 v48, v48
v_exp_f32 v49, v49
v_cvt_pk_bf16_f32 v74, v44, v45
v_cvt_pk_bf16_f32 v75, v46, v47
v_mfma_f32_32x32x16_bf16 v[104:119], v[28:31], v[84:87], v[104:119]
s_add_u32 m0, s87, 76800
v_exp_f32 v50, v50
v_exp_f32 v51, v51
v_cvt_pk_bf16_f32 v76, v48, v49
v_exp_f32 v52, v52
v_exp_f32 v53, v53
v_cvt_pk_bf16_f32 v77, v50, v51
v_exp_f32 v54, v54
v_exp_f32 v55, v55
v_cvt_pk_bf16_f32 v78, v52, v53
v_cvt_pk_bf16_f32 v79, v54, v55
s_waitcnt lgkmcnt(0)
v_mfma_f32_32x32x16_bf16 v[40:55], v[16:19], v[8:11], 0
buffer_load_dwordx4 v140, s[16:19], s84 offen lds
buffer_load_dwordx4 v141, s[16:19], s84 offen offset:1024 lds
v_exp_f32 v56, v56
v_exp_f32 v57, v57
v_exp_f32 v58, v58
v_exp_f32 v59, v59
v_exp_f32 v60, v60
v_cvt_pk_bf16_f32 v80, v56, v57
v_cvt_pk_bf16_f32 v81, v58, v59
v_mfma_f32_32x32x16_bf16 v[88:103], v[32:35], v[72:75], v[88:103]
s_add_u32 s84, s84, 16384
v_exp_f32 v61, v61
v_exp_f32 v62, v62
v_exp_f32 v63, v63
v_exp_f32 v64, v64
v_exp_f32 v65, v65
v_cvt_pk_bf16_f32 v82, v60, v61
v_cvt_pk_bf16_f32 v83, v62, v63
v_mfma_f32_32x32x16_bf16 v[88:103], v[36:39], v[76:79], v[88:103]
v_exp_f32 v66, v66
v_exp_f32 v67, v67
v_cvt_pk_bf16_f32 v84, v64, v65
v_exp_f32 v68, v68
v_exp_f32 v69, v69
v_cvt_pk_bf16_f32 v85, v66, v67
v_exp_f32 v70, v70
v_exp_f32 v71, v71
v_cvt_pk_bf16_f32 v86, v68, v69
v_cvt_pk_bf16_f32 v87, v70, v71
v_mfma_f32_32x32x16_bf16 v[56:71], v[16:19], v[12:15], 0
ds_read_b128 v[20:23], v6 offset:14560
ds_read_b128 v[24:27], v121 offset:12480
ds_read_b128 v[28:31], v122 offset:12480
v_exp_f32 v40, v40
v_exp_f32 v41, v41
v_exp_f32 v42, v42
v_exp_f32 v43, v43
v_exp_f32 v44, v44
v_cvt_pk_bf16_f32 v72, v40, v41
v_cvt_pk_bf16_f32 v73, v42, v43
v_mfma_f32_32x32x16_bf16 v[104:119], v[32:35], v[80:83], v[104:119]
v_exp_f32 v45, v45
v_exp_f32 v46, v46
v_exp_f32 v47, v47
v_exp_f32 v48, v48
v_exp_f32 v49, v49
v_cvt_pk_bf16_f32 v74, v44, v45
v_cvt_pk_bf16_f32 v75, v46, v47
v_mfma_f32_32x32x16_bf16 v[104:119], v[36:39], v[84:87], v[104:119]
s_add_u32 m0, s87, 78848
v_exp_f32 v50, v50
v_exp_f32 v51, v51
v_cvt_pk_bf16_f32 v76, v48, v49
v_exp_f32 v52, v52
v_exp_f32 v53, v53
v_cvt_pk_bf16_f32 v77, v50, v51
v_exp_f32 v54, v54
v_exp_f32 v55, v55
v_cvt_pk_bf16_f32 v78, v52, v53
v_cvt_pk_bf16_f32 v79, v54, v55
s_waitcnt lgkmcnt(0)
v_mfma_f32_32x32x16_bf16 v[40:55], v[20:23], v[8:11], 0
buffer_load_dwordx4 v140, s[16:19], s84 offen lds
buffer_load_dwordx4 v141, s[16:19], s84 offen offset:1024 lds
v_exp_f32 v56, v56
v_exp_f32 v57, v57
v_exp_f32 v58, v58
v_exp_f32 v59, v59
v_exp_f32 v60, v60
v_cvt_pk_bf16_f32 v80, v56, v57
v_cvt_pk_bf16_f32 v81, v58, v59
v_mfma_f32_32x32x16_bf16 v[88:103], v[24:27], v[72:75], v[88:103]
s_add_u32 s84, s84, 16384
v_exp_f32 v61, v61
v_exp_f32 v62, v62
v_exp_f32 v63, v63
v_exp_f32 v64, v64
v_exp_f32 v65, v65
v_cvt_pk_bf16_f32 v82, v60, v61
v_cvt_pk_bf16_f32 v83, v62, v63
v_mfma_f32_32x32x16_bf16 v[88:103], v[28:31], v[76:79], v[88:103]
v_exp_f32 v66, v66
v_exp_f32 v67, v67
v_cvt_pk_bf16_f32 v84, v64, v65
v_exp_f32 v68, v68
v_exp_f32 v69, v69
v_cvt_pk_bf16_f32 v85, v66, v67
v_exp_f32 v70, v70
v_exp_f32 v71, v71
v_cvt_pk_bf16_f32 v86, v68, v69
v_cvt_pk_bf16_f32 v87, v70, v71
s_waitcnt vmcnt(16)
s_barrier
v_mfma_f32_32x32x16_bf16 v[56:71], v[20:23], v[12:15], 0
ds_read_b128 v[16:19], v6 offset:16640
ds_read_b128 v[32:35], v121 offset:14560
ds_read_b128 v[36:39], v122 offset:14560
v_exp_f32 v40, v40
v_exp_f32 v41, v41
v_exp_f32 v42, v42
v_exp_f32 v43, v43
v_exp_f32 v44, v44
v_cvt_pk_bf16_f32 v72, v40, v41
v_cvt_pk_bf16_f32 v73, v42, v43
v_mfma_f32_32x32x16_bf16 v[104:119], v[24:27], v[80:83], v[104:119]
s_add_u32 m0, s59, 49920
s_nop 0
buffer_load_dwordx4 v6, s[40:43], s58 offen sc1 lds
buffer_load_dwordx4 v6, s[40:43], s58 offen offset:1024 sc1 lds
s_add_u32 m0, s59, 49952
s_nop 0
buffer_load_dwordx4 v6, s[40:43], s58 offen offset:2048 sc1 lds
buffer_load_dwordx4 v6, s[40:43], s58 offen offset:3072 sc1 lds
s_add_u32 s58, s58, 16384
v_exp_f32 v45, v45
v_exp_f32 v46, v46
v_exp_f32 v47, v47
v_exp_f32 v48, v48
v_exp_f32 v49, v49
v_cvt_pk_bf16_f32 v74, v44, v45
v_cvt_pk_bf16_f32 v75, v46, v47
v_mfma_f32_32x32x16_bf16 v[104:119], v[28:31], v[84:87], v[104:119]
s_add_u32 m0, s87, 80896
v_exp_f32 v50, v50
v_exp_f32 v51, v51
v_cvt_pk_bf16_f32 v76, v48, v49
v_exp_f32 v52, v52
v_exp_f32 v53, v53
v_cvt_pk_bf16_f32 v77, v50, v51
v_exp_f32 v54, v54
v_exp_f32 v55, v55
v_cvt_pk_bf16_f32 v78, v52, v53
v_cvt_pk_bf16_f32 v79, v54, v55
s_waitcnt lgkmcnt(0)
v_mfma_f32_32x32x16_bf16 v[40:55], v[16:19], v[8:11], 0
buffer_load_dwordx4 v140, s[16:19], s84 offen lds
buffer_load_dwordx4 v141, s[16:19], s84 offen offset:1024 lds
v_exp_f32 v56, v56
v_exp_f32 v57, v57
v_exp_f32 v58, v58
v_exp_f32 v59, v59
v_exp_f32 v60, v60
v_cvt_pk_bf16_f32 v80, v56, v57
v_cvt_pk_bf16_f32 v81, v58, v59
v_mfma_f32_32x32x16_bf16 v[88:103], v[32:35], v[72:75], v[88:103]
s_add_u32 s84, s84, 16384
v_exp_f32 v61, v61
v_exp_f32 v62, v62
v_exp_f32 v63, v63
v_exp_f32 v64, v64
v_exp_f32 v65, v65
v_cvt_pk_bf16_f32 v82, v60, v61
v_cvt_pk_bf16_f32 v83, v62, v63
v_mfma_f32_32x32x16_bf16 v[88:103], v[36:39], v[76:79], v[88:103]
v_exp_f32 v66, v66
v_exp_f32 v67, v67
v_cvt_pk_bf16_f32 v84, v64, v65
v_exp_f32 v68, v68
v_exp_f32 v69, v69
v_cvt_pk_bf16_f32 v85, v66, v67
v_exp_f32 v70, v70
v_exp_f32 v71, v71
v_cvt_pk_bf16_f32 v86, v68, v69
v_cvt_pk_bf16_f32 v87, v70, v71
v_mfma_f32_32x32x16_bf16 v[56:71], v[16:19], v[12:15], 0
ds_read_b128 v[20:23], v6 offset:18720
ds_read_b128 v[24:27], v121 offset:16640
ds_read_b128 v[28:31], v122 offset:16640
v_exp_f32 v40, v40
v_exp_f32 v41, v41
v_exp_f32 v42, v42
v_exp_f32 v43, v43
v_exp_f32 v44, v44
v_cvt_pk_bf16_f32 v72, v40, v41
v_cvt_pk_bf16_f32 v73, v42, v43
v_mfma_f32_32x32x16_bf16 v[104:119], v[32:35], v[80:83], v[104:119]
v_exp_f32 v45, v45
v_exp_f32 v46, v46
v_exp_f32 v47, v47
v_exp_f32 v48, v48
v_exp_f32 v49, v49
v_cvt_pk_bf16_f32 v74, v44, v45
v_cvt_pk_bf16_f32 v75, v46, v47
v_mfma_f32_32x32x16_bf16 v[104:119], v[36:39], v[84:87], v[104:119]
v_exp_f32 v50, v50
v_exp_f32 v51, v51
v_cvt_pk_bf16_f32 v76, v48, v49
v_exp_f32 v52, v52
v_exp_f32 v53, v53
v_cvt_pk_bf16_f32 v77, v50, v51
v_exp_f32 v54, v54
v_exp_f32 v55, v55
v_cvt_pk_bf16_f32 v78, v52, v53
v_cvt_pk_bf16_f32 v79, v54, v55
s_waitcnt lgkmcnt(0)
v_mfma_f32_32x32x16_bf16 v[40:55], v[20:23], v[8:11], 0
buffer_load_dwordx4 a[0:3], v136, s[20:23], s85 offen
buffer_load_dwordx4 a[4:7], v137, s[20:23], s85 offen
v_exp_f32 v56, v56
v_exp_f32 v57, v57
v_exp_f32 v58, v58
v_exp_f32 v59, v59
v_exp_f32 v60, v60
v_cvt_pk_bf16_f32 v80, v56, v57
v_cvt_pk_bf16_f32 v81, v58, v59
v_mfma_f32_32x32x16_bf16 v[88:103], v[24:27], v[72:75], v[88:103]
s_add_u32 s85, s85, 44032
v_exp_f32 v61, v61
v_exp_f32 v62, v62
v_exp_f32 v63, v63
v_exp_f32 v64, v64
v_exp_f32 v65, v65
v_cvt_pk_bf16_f32 v82, v60, v61
v_cvt_pk_bf16_f32 v83, v62, v63
v_mfma_f32_32x32x16_bf16 v[88:103], v[28:31], v[76:79], v[88:103]
v_exp_f32 v66, v66
v_exp_f32 v67, v67
v_cvt_pk_bf16_f32 v84, v64, v65
v_exp_f32 v68, v68
v_exp_f32 v69, v69
v_cvt_pk_bf16_f32 v85, v66, v67
v_exp_f32 v70, v70
v_exp_f32 v71, v71
v_cvt_pk_bf16_f32 v86, v68, v69
v_cvt_pk_bf16_f32 v87, v70, v71
v_mfma_f32_32x32x16_bf16 v[56:71], v[20:23], v[12:15], 0
ds_read_b128 v[16:19], v6 offset:20800
ds_read_b128 v[32:35], v121 offset:18720
ds_read_b128 v[36:39], v122 offset:18720
v_exp_f32 v40, v40
v_exp_f32 v41, v41
v_exp_f32 v42, v42
v_exp_f32 v43, v43
v_exp_f32 v44, v44
v_cvt_pk_bf16_f32 v72, v40, v41
v_cvt_pk_bf16_f32 v73, v42, v43
v_mfma_f32_32x32x16_bf16 v[104:119], v[24:27], v[80:83], v[104:119]
v_exp_f32 v45, v45
v_exp_f32 v46, v46
v_exp_f32 v47, v47
v_exp_f32 v48, v48
v_exp_f32 v49, v49
v_cvt_pk_bf16_f32 v74, v44, v45
v_cvt_pk_bf16_f32 v75, v46, v47
v_mfma_f32_32x32x16_bf16 v[104:119], v[28:31], v[84:87], v[104:119]
v_exp_f32 v50, v50
v_exp_f32 v51, v51
v_cvt_pk_bf16_f32 v76, v48, v49
v_exp_f32 v52, v52
v_exp_f32 v53, v53
v_cvt_pk_bf16_f32 v77, v50, v51
v_exp_f32 v54, v54
v_exp_f32 v55, v55
v_cvt_pk_bf16_f32 v78, v52, v53
v_cvt_pk_bf16_f32 v79, v54, v55
s_waitcnt lgkmcnt(0)
v_mfma_f32_32x32x16_bf16 v[40:55], v[16:19], v[8:11], 0
buffer_load_dwordx4 a[8:11], v136, s[20:23], s85 offen
buffer_load_dwordx4 a[12:15], v137, s[20:23], s85 offen
v_exp_f32 v56, v56
v_exp_f32 v57, v57
v_exp_f32 v58, v58
v_exp_f32 v59, v59
v_exp_f32 v60, v60
v_cvt_pk_bf16_f32 v80, v56, v57
v_cvt_pk_bf16_f32 v81, v58, v59
v_mfma_f32_32x32x16_bf16 v[88:103], v[32:35], v[72:75], v[88:103]
s_add_u32 s85, s85, 44032
v_exp_f32 v61, v61
v_exp_f32 v62, v62
v_exp_f32 v63, v63
v_exp_f32 v64, v64
v_exp_f32 v65, v65
v_cvt_pk_bf16_f32 v82, v60, v61
v_cvt_pk_bf16_f32 v83, v62, v63
v_mfma_f32_32x32x16_bf16 v[88:103], v[36:39], v[76:79], v[88:103]
v_exp_f32 v66, v66
v_exp_f32 v67, v67
v_cvt_pk_bf16_f32 v84, v64, v65
v_exp_f32 v68, v68
v_exp_f32 v69, v69
v_cvt_pk_bf16_f32 v85, v66, v67
v_exp_f32 v70, v70
v_exp_f32 v71, v71
v_cvt_pk_bf16_f32 v86, v68, v69
v_cvt_pk_bf16_f32 v87, v70, v71
v_mfma_f32_32x32x16_bf16 v[56:71], v[16:19], v[12:15], 0
ds_read_b128 v[20:23], v6 offset:22880
ds_read_b128 v[24:27], v121 offset:20800
ds_read_b128 v[28:31], v122 offset:20800
v_exp_f32 v40, v40
v_exp_f32 v41, v41
v_exp_f32 v42, v42
v_exp_f32 v43, v43
v_exp_f32 v44, v44
v_cvt_pk_bf16_f32 v72, v40, v41
v_cvt_pk_bf16_f32 v73, v42, v43
v_mfma_f32_32x32x16_bf16 v[104:119], v[32:35], v[80:83], v[104:119]
v_exp_f32 v45, v45
v_exp_f32 v46, v46
v_exp_f32 v47, v47
v_exp_f32 v48, v48
v_exp_f32 v49, v49
v_cvt_pk_bf16_f32 v74, v44, v45
v_cvt_pk_bf16_f32 v75, v46, v47
v_mfma_f32_32x32x16_bf16 v[104:119], v[36:39], v[84:87], v[104:119]
v_exp_f32 v50, v50
v_exp_f32 v51, v51
v_cvt_pk_bf16_f32 v76, v48, v49
v_exp_f32 v52, v52
v_exp_f32 v53, v53
v_cvt_pk_bf16_f32 v77, v50, v51
v_exp_f32 v54, v54
v_exp_f32 v55, v55
v_cvt_pk_bf16_f32 v78, v52, v53
v_cvt_pk_bf16_f32 v79, v54, v55
s_waitcnt lgkmcnt(0)
v_mfma_f32_32x32x16_bf16 v[40:55], v[20:23], v[8:11], 0
buffer_load_dwordx4 a[16:19], v136, s[20:23], s85 offen
buffer_load_dwordx4 a[20:23], v137, s[20:23], s85 offen
v_exp_f32 v56, v56
v_exp_f32 v57, v57
v_exp_f32 v58, v58
v_exp_f32 v59, v59
v_exp_f32 v60, v60
v_cvt_pk_bf16_f32 v80, v56, v57
v_cvt_pk_bf16_f32 v81, v58, v59
v_mfma_f32_32x32x16_bf16 v[88:103], v[24:27], v[72:75], v[88:103]
s_add_u32 s85, s85, 44032
v_exp_f32 v61, v61
v_exp_f32 v62, v62
v_exp_f32 v63, v63
v_exp_f32 v64, v64
v_exp_f32 v65, v65
v_cvt_pk_bf16_f32 v82, v60, v61
v_cvt_pk_bf16_f32 v83, v62, v63
v_mfma_f32_32x32x16_bf16 v[88:103], v[28:31], v[76:79], v[88:103]
v_exp_f32 v66, v66
v_exp_f32 v67, v67
v_cvt_pk_bf16_f32 v84, v64, v65
v_exp_f32 v68, v68
v_exp_f32 v69, v69
v_cvt_pk_bf16_f32 v85, v66, v67
v_exp_f32 v70, v70
v_exp_f32 v71, v71
v_cvt_pk_bf16_f32 v86, v68, v69
v_cvt_pk_bf16_f32 v87, v70, v71
v_mfma_f32_32x32x16_bf16 v[56:71], v[20:23], v[12:15], 0
ds_read_b128 v[16:19], v6 offset:24960
ds_read_b128 v[32:35], v121 offset:22880
ds_read_b128 v[36:39], v122 offset:22880
v_exp_f32 v40, v40
v_exp_f32 v41, v41
v_exp_f32 v42, v42
v_exp_f32 v43, v43
v_exp_f32 v44, v44
v_cvt_pk_bf16_f32 v72, v40, v41
v_cvt_pk_bf16_f32 v73, v42, v43
v_mfma_f32_32x32x16_bf16 v[104:119], v[24:27], v[80:83], v[104:119]
v_exp_f32 v45, v45
v_exp_f32 v46, v46
v_exp_f32 v47, v47
v_exp_f32 v48, v48
v_exp_f32 v49, v49
v_cvt_pk_bf16_f32 v74, v44, v45
v_cvt_pk_bf16_f32 v75, v46, v47
v_mfma_f32_32x32x16_bf16 v[104:119], v[28:31], v[84:87], v[104:119]
v_exp_f32 v50, v50
v_exp_f32 v51, v51
v_cvt_pk_bf16_f32 v76, v48, v49
v_exp_f32 v52, v52
v_exp_f32 v53, v53
v_cvt_pk_bf16_f32 v77, v50, v51
v_exp_f32 v54, v54
v_exp_f32 v55, v55
v_cvt_pk_bf16_f32 v78, v52, v53
v_cvt_pk_bf16_f32 v79, v54, v55
s_waitcnt lgkmcnt(0)
v_mfma_f32_32x32x16_bf16 v[40:55], v[16:19], v[8:11], 0
buffer_load_dwordx4 a[24:27], v136, s[20:23], s85 offen
buffer_load_dwordx4 a[28:31], v137, s[20:23], s85 offen
v_exp_f32 v56, v56
v_exp_f32 v57, v57
v_exp_f32 v58, v58
v_exp_f32 v59, v59
v_exp_f32 v60, v60
v_cvt_pk_bf16_f32 v80, v56, v57
v_cvt_pk_bf16_f32 v81, v58, v59
v_mfma_f32_32x32x16_bf16 v[88:103], v[32:35], v[72:75], v[88:103]
s_add_u32 s85, s85, 44032
v_exp_f32 v61, v61
v_exp_f32 v62, v62
v_exp_f32 v63, v63
v_exp_f32 v64, v64
v_exp_f32 v65, v65
v_cvt_pk_bf16_f32 v82, v60, v61
v_cvt_pk_bf16_f32 v83, v62, v63
v_mfma_f32_32x32x16_bf16 v[88:103], v[36:39], v[76:79], v[88:103]
v_exp_f32 v66, v66
v_exp_f32 v67, v67
v_cvt_pk_bf16_f32 v84, v64, v65
v_exp_f32 v68, v68
v_exp_f32 v69, v69
v_cvt_pk_bf16_f32 v85, v66, v67
v_exp_f32 v70, v70
v_exp_f32 v71, v71
v_cvt_pk_bf16_f32 v86, v68, v69
v_cvt_pk_bf16_f32 v87, v70, v71
v_mfma_f32_32x32x16_bf16 v[56:71], v[16:19], v[12:15], 0
ds_read_b128 v[20:23], v6 offset:27040
ds_read_b128 v[24:27], v121 offset:24960
ds_read_b128 v[28:31], v122 offset:24960
v_exp_f32 v40, v40
v_exp_f32 v41, v41
v_exp_f32 v42, v42
v_exp_f32 v43, v43
v_exp_f32 v44, v44
v_cvt_pk_bf16_f32 v72, v40, v41
v_cvt_pk_bf16_f32 v73, v42, v43
v_mfma_f32_32x32x16_bf16 v[104:119], v[32:35], v[80:83], v[104:119]
v_exp_f32 v45, v45
v_exp_f32 v46, v46
v_exp_f32 v47, v47
v_exp_f32 v48, v48
v_exp_f32 v49, v49
v_cvt_pk_bf16_f32 v74, v44, v45
v_cvt_pk_bf16_f32 v75, v46, v47
v_mfma_f32_32x32x16_bf16 v[104:119], v[36:39], v[84:87], v[104:119]
v_exp_f32 v50, v50
v_exp_f32 v51, v51
v_cvt_pk_bf16_f32 v76, v48, v49
v_exp_f32 v52, v52
v_exp_f32 v53, v53
v_cvt_pk_bf16_f32 v77, v50, v51
v_exp_f32 v54, v54
v_exp_f32 v55, v55
v_cvt_pk_bf16_f32 v78, v52, v53
v_cvt_pk_bf16_f32 v79, v54, v55
s_waitcnt lgkmcnt(0)
v_mfma_f32_32x32x16_bf16 v[40:55], v[20:23], v[8:11], 0
buffer_load_dwordx4 a[32:35], v136, s[20:23], s85 offen
buffer_load_dwordx4 a[36:39], v137, s[20:23], s85 offen
v_exp_f32 v56, v56
v_exp_f32 v57, v57
v_exp_f32 v58, v58
v_exp_f32 v59, v59
v_exp_f32 v60, v60
v_cvt_pk_bf16_f32 v80, v56, v57
v_cvt_pk_bf16_f32 v81, v58, v59
v_mfma_f32_32x32x16_bf16 v[88:103], v[24:27], v[72:75], v[88:103]
s_add_u32 s85, s85, 44032
v_exp_f32 v61, v61
v_exp_f32 v62, v62
v_exp_f32 v63, v63
v_exp_f32 v64, v64
v_exp_f32 v65, v65
v_cvt_pk_bf16_f32 v82, v60, v61
v_cvt_pk_bf16_f32 v83, v62, v63
v_mfma_f32_32x32x16_bf16 v[88:103], v[28:31], v[76:79], v[88:103]
v_exp_f32 v66, v66
v_exp_f32 v67, v67
v_cvt_pk_bf16_f32 v84, v64, v65
v_exp_f32 v68, v68
v_exp_f32 v69, v69
v_cvt_pk_bf16_f32 v85, v66, v67
v_exp_f32 v70, v70
v_exp_f32 v71, v71
v_cvt_pk_bf16_f32 v86, v68, v69
v_cvt_pk_bf16_f32 v87, v70, v71
v_mfma_f32_32x32x16_bf16 v[56:71], v[20:23], v[12:15], 0
ds_read_b128 v[16:19], v6 offset:29120
ds_read_b128 v[32:35], v121 offset:27040
ds_read_b128 v[36:39], v122 offset:27040
v_exp_f32 v40, v40
v_exp_f32 v41, v41
v_exp_f32 v42, v42
v_exp_f32 v43, v43
v_exp_f32 v44, v44
v_cvt_pk_bf16_f32 v72, v40, v41
v_cvt_pk_bf16_f32 v73, v42, v43
v_mfma_f32_32x32x16_bf16 v[104:119], v[24:27], v[80:83], v[104:119]
v_exp_f32 v45, v45
v_exp_f32 v46, v46
v_exp_f32 v47, v47
v_exp_f32 v48, v48
v_exp_f32 v49, v49
v_cvt_pk_bf16_f32 v74, v44, v45
v_cvt_pk_bf16_f32 v75, v46, v47
v_mfma_f32_32x32x16_bf16 v[104:119], v[28:31], v[84:87], v[104:119]
v_exp_f32 v50, v50
v_exp_f32 v51, v51
v_cvt_pk_bf16_f32 v76, v48, v49
v_exp_f32 v52, v52
v_exp_f32 v53, v53
v_cvt_pk_bf16_f32 v77, v50, v51
v_exp_f32 v54, v54
v_exp_f32 v55, v55
v_cvt_pk_bf16_f32 v78, v52, v53
v_cvt_pk_bf16_f32 v79, v54, v55
s_waitcnt lgkmcnt(0)
v_mfma_f32_32x32x16_bf16 v[40:55], v[16:19], v[8:11], 0
buffer_load_dwordx4 a[40:43], v136, s[20:23], s85 offen
buffer_load_dwordx4 a[44:47], v137, s[20:23], s85 offen
v_exp_f32 v56, v56
v_exp_f32 v57, v57
v_exp_f32 v58, v58
v_exp_f32 v59, v59
v_exp_f32 v60, v60
v_cvt_pk_bf16_f32 v80, v56, v57
v_cvt_pk_bf16_f32 v81, v58, v59
v_mfma_f32_32x32x16_bf16 v[88:103], v[32:35], v[72:75], v[88:103]
s_add_u32 s85, s85, 44032
v_exp_f32 v61, v61
v_exp_f32 v62, v62
v_exp_f32 v63, v63
v_exp_f32 v64, v64
v_exp_f32 v65, v65
v_cvt_pk_bf16_f32 v82, v60, v61
v_cvt_pk_bf16_f32 v83, v62, v63
v_mfma_f32_32x32x16_bf16 v[88:103], v[36:39], v[76:79], v[88:103]
v_exp_f32 v66, v66
v_exp_f32 v67, v67
v_cvt_pk_bf16_f32 v84, v64, v65
v_exp_f32 v68, v68
v_exp_f32 v69, v69
v_cvt_pk_bf16_f32 v85, v66, v67
v_exp_f32 v70, v70
v_exp_f32 v71, v71
v_cvt_pk_bf16_f32 v86, v68, v69
v_cvt_pk_bf16_f32 v87, v70, v71
v_mfma_f32_32x32x16_bf16 v[56:71], v[16:19], v[12:15], 0
ds_read_b128 v[20:23], v6 offset:31200
ds_read_b128 v[24:27], v121 offset:29120
ds_read_b128 v[28:31], v122 offset:29120
v_exp_f32 v40, v40
v_exp_f32 v41, v41
v_exp_f32 v42, v42
v_exp_f32 v43, v43
v_exp_f32 v44, v44
v_cvt_pk_bf16_f32 v72, v40, v41
v_cvt_pk_bf16_f32 v73, v42, v43
v_mfma_f32_32x32x16_bf16 v[104:119], v[32:35], v[80:83], v[104:119]
v_exp_f32 v45, v45
v_exp_f32 v46, v46
v_exp_f32 v47, v47
v_exp_f32 v48, v48
v_exp_f32 v49, v49
v_cvt_pk_bf16_f32 v74, v44, v45
v_cvt_pk_bf16_f32 v75, v46, v47
v_mfma_f32_32x32x16_bf16 v[104:119], v[36:39], v[84:87], v[104:119]
v_exp_f32 v50, v50
v_exp_f32 v51, v51
v_cvt_pk_bf16_f32 v76, v48, v49
v_exp_f32 v52, v52
v_exp_f32 v53, v53
v_cvt_pk_bf16_f32 v77, v50, v51
v_exp_f32 v54, v54
v_exp_f32 v55, v55
v_cvt_pk_bf16_f32 v78, v52, v53
v_cvt_pk_bf16_f32 v79, v54, v55
s_waitcnt lgkmcnt(0)
v_mfma_f32_32x32x16_bf16 v[40:55], v[20:23], v[8:11], 0
buffer_load_dwordx4 a[48:51], v136, s[20:23], s85 offen
buffer_load_dwordx4 a[52:55], v137, s[20:23], s85 offen
v_exp_f32 v56, v56
v_exp_f32 v57, v57
v_exp_f32 v58, v58
v_exp_f32 v59, v59
v_exp_f32 v60, v60
v_cvt_pk_bf16_f32 v80, v56, v57
v_cvt_pk_bf16_f32 v81, v58, v59
v_mfma_f32_32x32x16_bf16 v[88:103], v[24:27], v[72:75], v[88:103]
s_add_u32 s85, s85, 44032
v_exp_f32 v61, v61
v_exp_f32 v62, v62
v_exp_f32 v63, v63
v_exp_f32 v64, v64
v_exp_f32 v65, v65
v_cvt_pk_bf16_f32 v82, v60, v61
v_cvt_pk_bf16_f32 v83, v62, v63
v_mfma_f32_32x32x16_bf16 v[88:103], v[28:31], v[76:79], v[88:103]
v_exp_f32 v66, v66
v_exp_f32 v67, v67
v_cvt_pk_bf16_f32 v84, v64, v65
v_exp_f32 v68, v68
v_exp_f32 v69, v69
v_cvt_pk_bf16_f32 v85, v66, v67
v_exp_f32 v70, v70
v_exp_f32 v71, v71
v_cvt_pk_bf16_f32 v86, v68, v69
v_cvt_pk_bf16_f32 v87, v70, v71
s_waitcnt vmcnt(30)
s_barrier
v_mfma_f32_32x32x16_bf16 v[56:71], v[20:23], v[12:15], 0
ds_read_b128 v[16:19], v6 offset:33280
ds_read_b128 v[32:35], v121 offset:31200
ds_read_b128 v[36:39], v122 offset:31200
v_exp_f32 v40, v40
v_exp_f32 v41, v41
v_exp_f32 v42, v42
v_exp_f32 v43, v43
v_exp_f32 v44, v44
v_cvt_pk_bf16_f32 v72, v40, v41
v_cvt_pk_bf16_f32 v73, v42, v43
v_mfma_f32_32x32x16_bf16 v[104:119], v[24:27], v[80:83], v[104:119]
s_add_u32 m0, s59, 0
s_nop 0
buffer_load_dwordx4 v6, s[40:43], s58 offen sc1 lds
buffer_load_dwordx4 v6, s[40:43], s58 offen offset:1024 sc1 lds
s_add_u32 m0, s59, 32
s_nop 0
buffer_load_dwordx4 v6, s[40:43], s58 offen offset:2048 sc1 lds
buffer_load_dwordx4 v6, s[40:43], s58 offen offset:3072 sc1 lds
s_add_u32 s58, s58, 16384
v_exp_f32 v45, v45
v_exp_f32 v46, v46
v_exp_f32 v47, v47
v_exp_f32 v48, v48
v_exp_f32 v49, v49
v_cvt_pk_bf16_f32 v74, v44, v45
v_cvt_pk_bf16_f32 v75, v46, v47
v_mfma_f32_32x32x16_bf16 v[104:119], v[28:31], v[84:87], v[104:119]
v_exp_f32 v50, v50
v_exp_f32 v51, v51
v_cvt_pk_bf16_f32 v76, v48, v49
v_exp_f32 v52, v52
v_exp_f32 v53, v53
v_cvt_pk_bf16_f32 v77, v50, v51
v_exp_f32 v54, v54
v_exp_f32 v55, v55
v_cvt_pk_bf16_f32 v78, v52, v53
v_cvt_pk_bf16_f32 v79, v54, v55
s_waitcnt lgkmcnt(0)
v_mfma_f32_32x32x16_bf16 v[40:55], v[16:19], v[8:11], 0
buffer_load_dwordx4 a[56:59], v136, s[20:23], s85 offen
buffer_load_dwordx4 a[60:63], v137, s[20:23], s85 offen
v_exp_f32 v56, v56
v_exp_f32 v57, v57
v_exp_f32 v58, v58
v_exp_f32 v59, v59
v_exp_f32 v60, v60
v_cvt_pk_bf16_f32 v80, v56, v57
v_cvt_pk_bf16_f32 v81, v58, v59
v_mfma_f32_32x32x16_bf16 v[88:103], v[32:35], v[72:75], v[88:103]
s_add_u32 s85, s85, 44032
v_exp_f32 v61, v61
v_exp_f32 v62, v62
v_exp_f32 v63, v63
v_exp_f32 v64, v64
v_exp_f32 v65, v65
v_cvt_pk_bf16_f32 v82, v60, v61
v_cvt_pk_bf16_f32 v83, v62, v63
v_mfma_f32_32x32x16_bf16 v[88:103], v[36:39], v[76:79], v[88:103]
v_exp_f32 v66, v66
v_exp_f32 v67, v67
v_cvt_pk_bf16_f32 v84, v64, v65
v_exp_f32 v68, v68
v_exp_f32 v69, v69
v_cvt_pk_bf16_f32 v85, v66, v67
v_exp_f32 v70, v70
v_exp_f32 v71, v71
v_cvt_pk_bf16_f32 v86, v68, v69
v_cvt_pk_bf16_f32 v87, v70, v71
v_mfma_f32_32x32x16_bf16 v[56:71], v[16:19], v[12:15], 0
ds_read_b128 v[20:23], v6 offset:35360
ds_read_b128 v[24:27], v121 offset:33280
ds_read_b128 v[28:31], v122 offset:33280
v_exp_f32 v40, v40
v_exp_f32 v41, v41
v_exp_f32 v42, v42
v_exp_f32 v43, v43
v_exp_f32 v44, v44
v_cvt_pk_bf16_f32 v72, v40, v41
v_cvt_pk_bf16_f32 v73, v42, v43
v_mfma_f32_32x32x16_bf16 v[104:119], v[32:35], v[80:83], v[104:119]
v_exp_f32 v45, v45
v_exp_f32 v46, v46
v_exp_f32 v47, v47
v_exp_f32 v48, v48
v_exp_f32 v49, v49
v_cvt_pk_bf16_f32 v74, v44, v45
v_cvt_pk_bf16_f32 v75, v46, v47
v_mfma_f32_32x32x16_bf16 v[104:119], v[36:39], v[84:87], v[104:119]
v_exp_f32 v50, v50
v_exp_f32 v51, v51
v_cvt_pk_bf16_f32 v76, v48, v49
v_exp_f32 v52, v52
v_exp_f32 v53, v53
v_cvt_pk_bf16_f32 v77, v50, v51
v_exp_f32 v54, v54
v_exp_f32 v55, v55
v_cvt_pk_bf16_f32 v78, v52, v53
v_cvt_pk_bf16_f32 v79, v54, v55
s_waitcnt lgkmcnt(0)
v_mfma_f32_32x32x16_bf16 v[40:55], v[20:23], v[8:11], 0
buffer_load_dwordx4 a[64:67], v136, s[20:23], s85 offen
buffer_load_dwordx4 a[68:71], v137, s[20:23], s85 offen
v_exp_f32 v56, v56
v_exp_f32 v57, v57
v_exp_f32 v58, v58
v_exp_f32 v59, v59
v_exp_f32 v60, v60
v_cvt_pk_bf16_f32 v80, v56, v57
v_cvt_pk_bf16_f32 v81, v58, v59
v_mfma_f32_32x32x16_bf16 v[88:103], v[24:27], v[72:75], v[88:103]
s_add_u32 s85, s85, 44032
v_exp_f32 v61, v61
v_exp_f32 v62, v62
v_exp_f32 v63, v63
v_exp_f32 v64, v64
v_exp_f32 v65, v65
v_cvt_pk_bf16_f32 v82, v60, v61
v_cvt_pk_bf16_f32 v83, v62, v63
v_mfma_f32_32x32x16_bf16 v[88:103], v[28:31], v[76:79], v[88:103]
v_exp_f32 v66, v66
v_exp_f32 v67, v67
v_cvt_pk_bf16_f32 v84, v64, v65
v_exp_f32 v68, v68
v_exp_f32 v69, v69
v_cvt_pk_bf16_f32 v85, v66, v67
v_exp_f32 v70, v70
v_exp_f32 v71, v71
v_cvt_pk_bf16_f32 v86, v68, v69
v_cvt_pk_bf16_f32 v87, v70, v71
v_mfma_f32_32x32x16_bf16 v[56:71], v[20:23], v[12:15], 0
ds_read_b128 v[16:19], v6 offset:37440
ds_read_b128 v[32:35], v121 offset:35360
ds_read_b128 v[36:39], v122 offset:35360
v_exp_f32 v40, v40
v_exp_f32 v41, v41
v_exp_f32 v42, v42
v_exp_f32 v43, v43
v_exp_f32 v44, v44
v_cvt_pk_bf16_f32 v72, v40, v41
v_cvt_pk_bf16_f32 v73, v42, v43
v_mfma_f32_32x32x16_bf16 v[104:119], v[24:27], v[80:83], v[104:119]
v_exp_f32 v45, v45
v_exp_f32 v46, v46
v_exp_f32 v47, v47
v_exp_f32 v48, v48
v_exp_f32 v49, v49
v_cvt_pk_bf16_f32 v74, v44, v45
v_cvt_pk_bf16_f32 v75, v46, v47
v_mfma_f32_32x32x16_bf16 v[104:119], v[28:31], v[84:87], v[104:119]
v_exp_f32 v50, v50
v_exp_f32 v51, v51
v_cvt_pk_bf16_f32 v76, v48, v49
v_exp_f32 v52, v52
v_exp_f32 v53, v53
v_cvt_pk_bf16_f32 v77, v50, v51
v_exp_f32 v54, v54
v_exp_f32 v55, v55
v_cvt_pk_bf16_f32 v78, v52, v53
v_cvt_pk_bf16_f32 v79, v54, v55
s_waitcnt lgkmcnt(0)
v_mfma_f32_32x32x16_bf16 v[40:55], v[16:19], v[8:11], 0
buffer_load_dwordx4 a[72:75], v136, s[20:23], s85 offen
buffer_load_dwordx4 a[76:79], v137, s[20:23], s85 offen
v_exp_f32 v56, v56
v_exp_f32 v57, v57
v_exp_f32 v58, v58
v_exp_f32 v59, v59
v_exp_f32 v60, v60
v_cvt_pk_bf16_f32 v80, v56, v57
v_cvt_pk_bf16_f32 v81, v58, v59
v_mfma_f32_32x32x16_bf16 v[88:103], v[32:35], v[72:75], v[88:103]
s_add_u32 s85, s85, 44032
v_exp_f32 v61, v61
v_exp_f32 v62, v62
v_exp_f32 v63, v63
v_exp_f32 v64, v64
v_exp_f32 v65, v65
v_cvt_pk_bf16_f32 v82, v60, v61
v_cvt_pk_bf16_f32 v83, v62, v63
v_mfma_f32_32x32x16_bf16 v[88:103], v[36:39], v[76:79], v[88:103]
v_exp_f32 v66, v66
v_exp_f32 v67, v67
v_cvt_pk_bf16_f32 v84, v64, v65
v_exp_f32 v68, v68
v_exp_f32 v69, v69
v_cvt_pk_bf16_f32 v85, v66, v67
v_exp_f32 v70, v70
v_exp_f32 v71, v71
v_cvt_pk_bf16_f32 v86, v68, v69
v_cvt_pk_bf16_f32 v87, v70, v71
v_mfma_f32_32x32x16_bf16 v[56:71], v[16:19], v[12:15], 0
ds_read_b128 v[20:23], v6 offset:39520
ds_read_b128 v[24:27], v121 offset:37440
ds_read_b128 v[28:31], v122 offset:37440
v_exp_f32 v40, v40
v_exp_f32 v41, v41
v_exp_f32 v42, v42
v_exp_f32 v43, v43
v_exp_f32 v44, v44
v_cvt_pk_bf16_f32 v72, v40, v41
v_cvt_pk_bf16_f32 v73, v42, v43
v_mfma_f32_32x32x16_bf16 v[104:119], v[32:35], v[80:83], v[104:119]
v_exp_f32 v45, v45
v_exp_f32 v46, v46
v_exp_f32 v47, v47
v_exp_f32 v48, v48
v_exp_f32 v49, v49
v_cvt_pk_bf16_f32 v74, v44, v45
v_cvt_pk_bf16_f32 v75, v46, v47
v_mfma_f32_32x32x16_bf16 v[104:119], v[36:39], v[84:87], v[104:119]
v_exp_f32 v50, v50
v_exp_f32 v51, v51
v_cvt_pk_bf16_f32 v76, v48, v49
v_exp_f32 v52, v52
v_exp_f32 v53, v53
v_cvt_pk_bf16_f32 v77, v50, v51
v_exp_f32 v54, v54
v_exp_f32 v55, v55
v_cvt_pk_bf16_f32 v78, v52, v53
v_cvt_pk_bf16_f32 v79, v54, v55
s_waitcnt lgkmcnt(0)
v_mfma_f32_32x32x16_bf16 v[40:55], v[20:23], v[8:11], 0
buffer_load_dwordx4 a[80:83], v136, s[20:23], s85 offen
buffer_load_dwordx4 a[84:87], v137, s[20:23], s85 offen
v_exp_f32 v56, v56
v_exp_f32 v57, v57
v_exp_f32 v58, v58
v_exp_f32 v59, v59
v_exp_f32 v60, v60
v_cvt_pk_bf16_f32 v80, v56, v57
v_cvt_pk_bf16_f32 v81, v58, v59
v_mfma_f32_32x32x16_bf16 v[88:103], v[24:27], v[72:75], v[88:103]
s_add_u32 s85, s85, 44032
v_exp_f32 v61, v61
v_exp_f32 v62, v62
v_exp_f32 v63, v63
v_exp_f32 v64, v64
v_exp_f32 v65, v65
v_cvt_pk_bf16_f32 v82, v60, v61
v_cvt_pk_bf16_f32 v83, v62, v63
v_mfma_f32_32x32x16_bf16 v[88:103], v[28:31], v[76:79], v[88:103]
v_exp_f32 v66, v66
v_exp_f32 v67, v67
v_cvt_pk_bf16_f32 v84, v64, v65
v_exp_f32 v68, v68
v_exp_f32 v69, v69
v_cvt_pk_bf16_f32 v85, v66, v67
v_exp_f32 v70, v70
v_exp_f32 v71, v71
v_cvt_pk_bf16_f32 v86, v68, v69
v_cvt_pk_bf16_f32 v87, v70, v71
v_mfma_f32_32x32x16_bf16 v[56:71], v[20:23], v[12:15], 0
ds_read_b128 v[16:19], v6 offset:41600
ds_read_b128 v[32:35], v121 offset:39520
ds_read_b128 v[36:39], v122 offset:39520
v_exp_f32 v40, v40
v_exp_f32 v41, v41
v_exp_f32 v42, v42
v_exp_f32 v43, v43
v_exp_f32 v44, v44
v_cvt_pk_bf16_f32 v72, v40, v41
v_cvt_pk_bf16_f32 v73, v42, v43
v_mfma_f32_32x32x16_bf16 v[104:119], v[24:27], v[80:83], v[104:119]
v_exp_f32 v45, v45
v_exp_f32 v46, v46
v_exp_f32 v47, v47
v_exp_f32 v48, v48
v_exp_f32 v49, v49
v_cvt_pk_bf16_f32 v74, v44, v45
v_cvt_pk_bf16_f32 v75, v46, v47
v_mfma_f32_32x32x16_bf16 v[104:119], v[28:31], v[84:87], v[104:119]
v_exp_f32 v50, v50
v_exp_f32 v51, v51
v_cvt_pk_bf16_f32 v76, v48, v49
v_exp_f32 v52, v52
v_exp_f32 v53, v53
v_cvt_pk_bf16_f32 v77, v50, v51
v_exp_f32 v54, v54
v_exp_f32 v55, v55
v_cvt_pk_bf16_f32 v78, v52, v53
v_cvt_pk_bf16_f32 v79, v54, v55
s_waitcnt lgkmcnt(0)
v_mfma_f32_32x32x16_bf16 v[40:55], v[16:19], v[8:11], 0
buffer_load_dwordx4 a[88:91], v136, s[20:23], s85 offen
buffer_load_dwordx4 a[92:95], v137, s[20:23], s85 offen
v_exp_f32 v56, v56
v_exp_f32 v57, v57
v_exp_f32 v58, v58
v_exp_f32 v59, v59
v_exp_f32 v60, v60
v_cvt_pk_bf16_f32 v80, v56, v57
v_cvt_pk_bf16_f32 v81, v58, v59
v_mfma_f32_32x32x16_bf16 v[88:103], v[32:35], v[72:75], v[88:103]
s_add_u32 s85, s85, 44032
v_exp_f32 v61, v61
v_exp_f32 v62, v62
v_exp_f32 v63, v63
v_exp_f32 v64, v64
v_exp_f32 v65, v65
v_cvt_pk_bf16_f32 v82, v60, v61
v_cvt_pk_bf16_f32 v83, v62, v63
v_mfma_f32_32x32x16_bf16 v[88:103], v[36:39], v[76:79], v[88:103]
v_exp_f32 v66, v66
v_exp_f32 v67, v67
v_cvt_pk_bf16_f32 v84, v64, v65
v_exp_f32 v68, v68
v_exp_f32 v69, v69
v_cvt_pk_bf16_f32 v85, v66, v67
v_exp_f32 v70, v70
v_exp_f32 v71, v71
v_cvt_pk_bf16_f32 v86, v68, v69
v_cvt_pk_bf16_f32 v87, v70, v71
v_mfma_f32_32x32x16_bf16 v[56:71], v[16:19], v[12:15], 0
ds_read_b128 v[20:23], v6 offset:43680
ds_read_b128 v[24:27], v121 offset:41600
ds_read_b128 v[28:31], v122 offset:41600
v_exp_f32 v40, v40
v_exp_f32 v41, v41
v_exp_f32 v42, v42
v_exp_f32 v43, v43
v_exp_f32 v44, v44
v_cvt_pk_bf16_f32 v72, v40, v41
v_cvt_pk_bf16_f32 v73, v42, v43
v_mfma_f32_32x32x16_bf16 v[104:119], v[32:35], v[80:83], v[104:119]
v_exp_f32 v45, v45
v_exp_f32 v46, v46
v_exp_f32 v47, v47
v_exp_f32 v48, v48
v_exp_f32 v49, v49
v_cvt_pk_bf16_f32 v74, v44, v45
v_cvt_pk_bf16_f32 v75, v46, v47
v_mfma_f32_32x32x16_bf16 v[104:119], v[36:39], v[84:87], v[104:119]
v_exp_f32 v50, v50
v_exp_f32 v51, v51
v_cvt_pk_bf16_f32 v76, v48, v49
v_exp_f32 v52, v52
v_exp_f32 v53, v53
v_cvt_pk_bf16_f32 v77, v50, v51
v_exp_f32 v54, v54
v_exp_f32 v55, v55
v_cvt_pk_bf16_f32 v78, v52, v53
v_cvt_pk_bf16_f32 v79, v54, v55
s_waitcnt lgkmcnt(0)
v_mfma_f32_32x32x16_bf16 v[40:55], v[20:23], v[8:11], 0
buffer_load_dwordx4 a[96:99], v136, s[20:23], s85 offen
buffer_load_dwordx4 a[100:103], v137, s[20:23], s85 offen
v_exp_f32 v56, v56
v_exp_f32 v57, v57
v_exp_f32 v58, v58
v_exp_f32 v59, v59
v_exp_f32 v60, v60
v_cvt_pk_bf16_f32 v80, v56, v57
v_cvt_pk_bf16_f32 v81, v58, v59
v_mfma_f32_32x32x16_bf16 v[88:103], v[24:27], v[72:75], v[88:103]
s_add_u32 s85, s85, 44032
v_exp_f32 v61, v61
v_exp_f32 v62, v62
v_exp_f32 v63, v63
v_exp_f32 v64, v64
v_exp_f32 v65, v65
v_cvt_pk_bf16_f32 v82, v60, v61
v_cvt_pk_bf16_f32 v83, v62, v63
v_mfma_f32_32x32x16_bf16 v[88:103], v[28:31], v[76:79], v[88:103]
v_exp_f32 v66, v66
v_exp_f32 v67, v67
v_cvt_pk_bf16_f32 v84, v64, v65
v_exp_f32 v68, v68
v_exp_f32 v69, v69
v_cvt_pk_bf16_f32 v85, v66, v67
v_exp_f32 v70, v70
v_exp_f32 v71, v71
v_cvt_pk_bf16_f32 v86, v68, v69
v_cvt_pk_bf16_f32 v87, v70, v71
v_mfma_f32_32x32x16_bf16 v[56:71], v[20:23], v[12:15], 0
ds_read_b128 v[16:19], v6 offset:45760
ds_read_b128 v[32:35], v121 offset:43680
ds_read_b128 v[36:39], v122 offset:43680
v_exp_f32 v40, v40
v_exp_f32 v41, v41
v_exp_f32 v42, v42
v_exp_f32 v43, v43
v_exp_f32 v44, v44
v_cvt_pk_bf16_f32 v72, v40, v41
v_cvt_pk_bf16_f32 v73, v42, v43
v_mfma_f32_32x32x16_bf16 v[104:119], v[24:27], v[80:83], v[104:119]
v_exp_f32 v45, v45
v_exp_f32 v46, v46
v_exp_f32 v47, v47
v_exp_f32 v48, v48
v_exp_f32 v49, v49
v_cvt_pk_bf16_f32 v74, v44, v45
v_cvt_pk_bf16_f32 v75, v46, v47
v_mfma_f32_32x32x16_bf16 v[104:119], v[28:31], v[84:87], v[104:119]
v_exp_f32 v50, v50
v_exp_f32 v51, v51
v_cvt_pk_bf16_f32 v76, v48, v49
v_exp_f32 v52, v52
v_exp_f32 v53, v53
v_cvt_pk_bf16_f32 v77, v50, v51
v_exp_f32 v54, v54
v_exp_f32 v55, v55
v_cvt_pk_bf16_f32 v78, v52, v53
v_cvt_pk_bf16_f32 v79, v54, v55
s_waitcnt lgkmcnt(0)
v_mfma_f32_32x32x16_bf16 v[40:55], v[16:19], v[8:11], 0
buffer_load_dwordx4 a[104:107], v136, s[20:23], s85 offen
buffer_load_dwordx4 a[108:111], v137, s[20:23], s85 offen
v_exp_f32 v56, v56
v_exp_f32 v57, v57
v_exp_f32 v58, v58
v_exp_f32 v59, v59
v_exp_f32 v60, v60
v_cvt_pk_bf16_f32 v80, v56, v57
v_cvt_pk_bf16_f32 v81, v58, v59
v_mfma_f32_32x32x16_bf16 v[88:103], v[32:35], v[72:75], v[88:103]
s_add_u32 s85, s85, 44032
v_exp_f32 v61, v61
v_exp_f32 v62, v62
v_exp_f32 v63, v63
v_exp_f32 v64, v64
v_exp_f32 v65, v65
v_cvt_pk_bf16_f32 v82, v60, v61
v_cvt_pk_bf16_f32 v83, v62, v63
v_mfma_f32_32x32x16_bf16 v[88:103], v[36:39], v[76:79], v[88:103]
v_exp_f32 v66, v66
v_exp_f32 v67, v67
v_cvt_pk_bf16_f32 v84, v64, v65
v_exp_f32 v68, v68
v_exp_f32 v69, v69
v_cvt_pk_bf16_f32 v85, v66, v67
v_exp_f32 v70, v70
v_exp_f32 v71, v71
v_cvt_pk_bf16_f32 v86, v68, v69
v_cvt_pk_bf16_f32 v87, v70, v71
v_mfma_f32_32x32x16_bf16 v[56:71], v[16:19], v[12:15], 0
ds_read_b128 v[20:23], v6 offset:47840
ds_read_b128 v[24:27], v121 offset:45760
ds_read_b128 v[28:31], v122 offset:45760
v_exp_f32 v40, v40
v_exp_f32 v41, v41
v_exp_f32 v42, v42
v_exp_f32 v43, v43
v_exp_f32 v44, v44
v_cvt_pk_bf16_f32 v72, v40, v41
v_cvt_pk_bf16_f32 v73, v42, v43
v_mfma_f32_32x32x16_bf16 v[104:119], v[32:35], v[80:83], v[104:119]
v_exp_f32 v45, v45
v_exp_f32 v46, v46
v_exp_f32 v47, v47
v_exp_f32 v48, v48
v_exp_f32 v49, v49
v_cvt_pk_bf16_f32 v74, v44, v45
v_cvt_pk_bf16_f32 v75, v46, v47
v_mfma_f32_32x32x16_bf16 v[104:119], v[36:39], v[84:87], v[104:119]
v_exp_f32 v50, v50
v_exp_f32 v51, v51
v_cvt_pk_bf16_f32 v76, v48, v49
v_exp_f32 v52, v52
v_exp_f32 v53, v53
v_cvt_pk_bf16_f32 v77, v50, v51
v_exp_f32 v54, v54
v_exp_f32 v55, v55
v_cvt_pk_bf16_f32 v78, v52, v53
v_cvt_pk_bf16_f32 v79, v54, v55
s_waitcnt lgkmcnt(0)
v_mfma_f32_32x32x16_bf16 v[40:55], v[20:23], v[8:11], 0
buffer_load_dwordx4 a[112:115], v136, s[20:23], s85 offen
buffer_load_dwordx4 a[116:119], v137, s[20:23], s85 offen
v_exp_f32 v56, v56
v_exp_f32 v57, v57
v_exp_f32 v58, v58
v_exp_f32 v59, v59
v_exp_f32 v60, v60
v_cvt_pk_bf16_f32 v80, v56, v57
v_cvt_pk_bf16_f32 v81, v58, v59
v_mfma_f32_32x32x16_bf16 v[88:103], v[24:27], v[72:75], v[88:103]
s_add_u32 s85, s85, 44032
v_exp_f32 v61, v61
v_exp_f32 v62, v62
v_exp_f32 v63, v63
v_exp_f32 v64, v64
v_exp_f32 v65, v65
v_cvt_pk_bf16_f32 v82, v60, v61
v_cvt_pk_bf16_f32 v83, v62, v63
v_mfma_f32_32x32x16_bf16 v[88:103], v[28:31], v[76:79], v[88:103]
v_exp_f32 v66, v66
v_exp_f32 v67, v67
v_cvt_pk_bf16_f32 v84, v64, v65
v_exp_f32 v68, v68
v_exp_f32 v69, v69
v_cvt_pk_bf16_f32 v85, v66, v67
v_exp_f32 v70, v70
v_exp_f32 v71, v71
v_cvt_pk_bf16_f32 v86, v68, v69
v_cvt_pk_bf16_f32 v87, v70, v71
s_waitcnt vmcnt(36)
s_barrier
v_mfma_f32_32x32x16_bf16 v[56:71], v[20:23], v[12:15], 0
ds_read_b128 v[16:19], v6 offset:49920
ds_read_b128 v[32:35], v121 offset:47840
ds_read_b128 v[36:39], v122 offset:47840
v_exp_f32 v40, v40
v_exp_f32 v41, v41
v_exp_f32 v42, v42
v_exp_f32 v43, v43
v_exp_f32 v44, v44
v_cvt_pk_bf16_f32 v72, v40, v41
v_cvt_pk_bf16_f32 v73, v42, v43
v_mfma_f32_32x32x16_bf16 v[104:119], v[24:27], v[80:83], v[104:119]
s_add_u32 m0, s59, 16640
s_nop 0
buffer_load_dwordx4 v6, s[40:43], s58 offen sc1 lds
buffer_load_dwordx4 v6, s[40:43], s58 offen offset:1024 sc1 lds
s_add_u32 m0, s59, 16672
s_nop 0
buffer_load_dwordx4 v6, s[40:43], s58 offen offset:2048 sc1 lds
buffer_load_dwordx4 v6, s[40:43], s58 offen offset:3072 sc1 lds
s_add_u32 s58, s58, 16384
v_exp_f32 v45, v45
v_exp_f32 v46, v46
v_exp_f32 v47, v47
v_exp_f32 v48, v48
v_exp_f32 v49, v49
v_cvt_pk_bf16_f32 v74, v44, v45
v_cvt_pk_bf16_f32 v75, v46, v47
v_mfma_f32_32x32x16_bf16 v[104:119], v[28:31], v[84:87], v[104:119]
v_exp_f32 v50, v50
v_exp_f32 v51, v51
v_cvt_pk_bf16_f32 v76, v48, v49
v_exp_f32 v52, v52
v_exp_f32 v53, v53
v_cvt_pk_bf16_f32 v77, v50, v51
v_exp_f32 v54, v54
v_exp_f32 v55, v55
v_cvt_pk_bf16_f32 v78, v52, v53
v_cvt_pk_bf16_f32 v79, v54, v55
s_waitcnt lgkmcnt(0)
v_mfma_f32_32x32x16_bf16 v[40:55], v[16:19], v[8:11], 0
buffer_load_dwordx4 a[120:123], v136, s[20:23], s85 offen
buffer_load_dwordx4 a[124:127], v137, s[20:23], s85 offen
v_exp_f32 v56, v56
v_exp_f32 v57, v57
v_exp_f32 v58, v58
v_exp_f32 v59, v59
v_exp_f32 v60, v60
v_cvt_pk_bf16_f32 v80, v56, v57
v_cvt_pk_bf16_f32 v81, v58, v59
v_mfma_f32_32x32x16_bf16 v[88:103], v[32:35], v[72:75], v[88:103]
s_add_u32 s85, s85, 44032
v_exp_f32 v61, v61
v_exp_f32 v62, v62
v_exp_f32 v63, v63
v_exp_f32 v64, v64
v_exp_f32 v65, v65
v_cvt_pk_bf16_f32 v82, v60, v61
v_cvt_pk_bf16_f32 v83, v62, v63
v_mfma_f32_32x32x16_bf16 v[88:103], v[36:39], v[76:79], v[88:103]
v_exp_f32 v66, v66
v_exp_f32 v67, v67
v_cvt_pk_bf16_f32 v84, v64, v65
v_exp_f32 v68, v68
v_exp_f32 v69, v69
v_cvt_pk_bf16_f32 v85, v66, v67
v_exp_f32 v70, v70
v_exp_f32 v71, v71
v_cvt_pk_bf16_f32 v86, v68, v69
v_cvt_pk_bf16_f32 v87, v70, v71
v_mfma_f32_32x32x16_bf16 v[56:71], v[16:19], v[12:15], 0
ds_read_b128 v[20:23], v6 offset:52000
ds_read_b128 v[24:27], v121 offset:49920
ds_read_b128 v[28:31], v122 offset:49920
v_exp_f32 v40, v40
v_exp_f32 v41, v41
v_exp_f32 v42, v42
v_exp_f32 v43, v43
v_exp_f32 v44, v44
v_cvt_pk_bf16_f32 v72, v40, v41
v_cvt_pk_bf16_f32 v73, v42, v43
v_mfma_f32_32x32x16_bf16 v[104:119], v[32:35], v[80:83], v[104:119]
v_exp_f32 v45, v45
v_exp_f32 v46, v46
v_exp_f32 v47, v47
v_exp_f32 v48, v48
v_exp_f32 v49, v49
v_cvt_pk_bf16_f32 v74, v44, v45
v_cvt_pk_bf16_f32 v75, v46, v47
v_mfma_f32_32x32x16_bf16 v[104:119], v[36:39], v[84:87], v[104:119]
v_exp_f32 v50, v50
v_exp_f32 v51, v51
v_cvt_pk_bf16_f32 v76, v48, v49
v_exp_f32 v52, v52
v_exp_f32 v53, v53
v_cvt_pk_bf16_f32 v77, v50, v51
v_exp_f32 v54, v54
v_exp_f32 v55, v55
v_cvt_pk_bf16_f32 v78, v52, v53
v_cvt_pk_bf16_f32 v79, v54, v55
s_waitcnt lgkmcnt(0)
v_mfma_f32_32x32x16_bf16 v[40:55], v[20:23], v[8:11], 0
buffer_load_dwordx4 a[128:131], v136, s[20:23], s85 offen
buffer_load_dwordx4 a[132:135], v137, s[20:23], s85 offen
v_exp_f32 v56, v56
v_exp_f32 v57, v57
v_exp_f32 v58, v58
v_exp_f32 v59, v59
v_exp_f32 v60, v60
v_cvt_pk_bf16_f32 v80, v56, v57
v_cvt_pk_bf16_f32 v81, v58, v59
v_mfma_f32_32x32x16_bf16 v[88:103], v[24:27], v[72:75], v[88:103]
s_add_u32 s85, s85, 44032
v_exp_f32 v61, v61
v_exp_f32 v62, v62
v_exp_f32 v63, v63
v_exp_f32 v64, v64
v_exp_f32 v65, v65
v_cvt_pk_bf16_f32 v82, v60, v61
v_cvt_pk_bf16_f32 v83, v62, v63
v_mfma_f32_32x32x16_bf16 v[88:103], v[28:31], v[76:79], v[88:103]
v_exp_f32 v66, v66
v_exp_f32 v67, v67
v_cvt_pk_bf16_f32 v84, v64, v65
v_exp_f32 v68, v68
v_exp_f32 v69, v69
v_cvt_pk_bf16_f32 v85, v66, v67
v_exp_f32 v70, v70
v_exp_f32 v71, v71
v_cvt_pk_bf16_f32 v86, v68, v69
v_cvt_pk_bf16_f32 v87, v70, v71
v_mfma_f32_32x32x16_bf16 v[56:71], v[20:23], v[12:15], 0
ds_read_b128 v[16:19], v6 offset:54080
ds_read_b128 v[32:35], v121 offset:52000
ds_read_b128 v[36:39], v122 offset:52000
v_exp_f32 v40, v40
v_exp_f32 v41, v41
v_exp_f32 v42, v42
v_exp_f32 v43, v43
v_exp_f32 v44, v44
v_cvt_pk_bf16_f32 v72, v40, v41
v_cvt_pk_bf16_f32 v73, v42, v43
v_mfma_f32_32x32x16_bf16 v[104:119], v[24:27], v[80:83], v[104:119]
v_exp_f32 v45, v45
v_exp_f32 v46, v46
v_exp_f32 v47, v47
v_exp_f32 v48, v48
v_exp_f32 v49, v49
v_cvt_pk_bf16_f32 v74, v44, v45
v_cvt_pk_bf16_f32 v75, v46, v47
v_mfma_f32_32x32x16_bf16 v[104:119], v[28:31], v[84:87], v[104:119]
v_exp_f32 v50, v50
v_exp_f32 v51, v51
v_cvt_pk_bf16_f32 v76, v48, v49
v_exp_f32 v52, v52
v_exp_f32 v53, v53
v_cvt_pk_bf16_f32 v77, v50, v51
v_exp_f32 v54, v54
v_exp_f32 v55, v55
v_cvt_pk_bf16_f32 v78, v52, v53
v_cvt_pk_bf16_f32 v79, v54, v55
s_waitcnt lgkmcnt(0)
v_mfma_f32_32x32x16_bf16 v[40:55], v[16:19], v[8:11], 0
buffer_load_dwordx4 a[136:139], v136, s[20:23], s85 offen
buffer_load_dwordx4 a[140:143], v137, s[20:23], s85 offen
v_exp_f32 v56, v56
v_exp_f32 v57, v57
v_exp_f32 v58, v58
v_exp_f32 v59, v59
v_exp_f32 v60, v60
v_cvt_pk_bf16_f32 v80, v56, v57
v_cvt_pk_bf16_f32 v81, v58, v59
v_mfma_f32_32x32x16_bf16 v[88:103], v[32:35], v[72:75], v[88:103]
s_add_u32 s85, s85, 44032
v_exp_f32 v61, v61
v_exp_f32 v62, v62
v_exp_f32 v63, v63
v_exp_f32 v64, v64
v_exp_f32 v65, v65
v_cvt_pk_bf16_f32 v82, v60, v61
v_cvt_pk_bf16_f32 v83, v62, v63
v_mfma_f32_32x32x16_bf16 v[88:103], v[36:39], v[76:79], v[88:103]
v_exp_f32 v66, v66
v_exp_f32 v67, v67
v_cvt_pk_bf16_f32 v84, v64, v65
v_exp_f32 v68, v68
v_exp_f32 v69, v69
v_cvt_pk_bf16_f32 v85, v66, v67
v_exp_f32 v70, v70
v_exp_f32 v71, v71
v_cvt_pk_bf16_f32 v86, v68, v69
v_cvt_pk_bf16_f32 v87, v70, v71
v_mfma_f32_32x32x16_bf16 v[56:71], v[16:19], v[12:15], 0
ds_read_b128 v[20:23], v6 offset:56160
ds_read_b128 v[24:27], v121 offset:54080
ds_read_b128 v[28:31], v122 offset:54080
v_exp_f32 v40, v40
v_exp_f32 v41, v41
v_exp_f32 v42, v42
v_exp_f32 v43, v43
v_exp_f32 v44, v44
v_cvt_pk_bf16_f32 v72, v40, v41
v_cvt_pk_bf16_f32 v73, v42, v43
v_mfma_f32_32x32x16_bf16 v[104:119], v[32:35], v[80:83], v[104:119]
v_exp_f32 v45, v45
v_exp_f32 v46, v46
v_exp_f32 v47, v47
v_exp_f32 v48, v48
v_exp_f32 v49, v49
v_cvt_pk_bf16_f32 v74, v44, v45
v_cvt_pk_bf16_f32 v75, v46, v47
v_mfma_f32_32x32x16_bf16 v[104:119], v[36:39], v[84:87], v[104:119]
v_exp_f32 v50, v50
v_exp_f32 v51, v51
v_cvt_pk_bf16_f32 v76, v48, v49
v_exp_f32 v52, v52
v_exp_f32 v53, v53
v_cvt_pk_bf16_f32 v77, v50, v51
v_exp_f32 v54, v54
v_exp_f32 v55, v55
v_cvt_pk_bf16_f32 v78, v52, v53
v_cvt_pk_bf16_f32 v79, v54, v55
s_waitcnt lgkmcnt(0)
v_mfma_f32_32x32x16_bf16 v[40:55], v[20:23], v[8:11], 0
buffer_load_dwordx4 a[144:147], v136, s[20:23], s85 offen
buffer_load_dwordx4 a[148:151], v137, s[20:23], s85 offen
v_exp_f32 v56, v56
v_exp_f32 v57, v57
v_exp_f32 v58, v58
v_exp_f32 v59, v59
v_exp_f32 v60, v60
v_cvt_pk_bf16_f32 v80, v56, v57
v_cvt_pk_bf16_f32 v81, v58, v59
v_mfma_f32_32x32x16_bf16 v[88:103], v[24:27], v[72:75], v[88:103]
s_add_u32 s85, s85, 44032
v_exp_f32 v61, v61
v_exp_f32 v62, v62
v_exp_f32 v63, v63
v_exp_f32 v64, v64
v_exp_f32 v65, v65
v_cvt_pk_bf16_f32 v82, v60, v61
v_cvt_pk_bf16_f32 v83, v62, v63
v_mfma_f32_32x32x16_bf16 v[88:103], v[28:31], v[76:79], v[88:103]
v_exp_f32 v66, v66
v_exp_f32 v67, v67
v_cvt_pk_bf16_f32 v84, v64, v65
v_exp_f32 v68, v68
v_exp_f32 v69, v69
v_cvt_pk_bf16_f32 v85, v66, v67
v_exp_f32 v70, v70
v_exp_f32 v71, v71
v_cvt_pk_bf16_f32 v86, v68, v69
v_cvt_pk_bf16_f32 v87, v70, v71
v_mfma_f32_32x32x16_bf16 v[56:71], v[20:23], v[12:15], 0
ds_read_b128 v[16:19], v6 offset:58240
ds_read_b128 v[32:35], v121 offset:56160
ds_read_b128 v[36:39], v122 offset:56160
v_exp_f32 v40, v40
v_exp_f32 v41, v41
v_exp_f32 v42, v42
v_exp_f32 v43, v43
v_exp_f32 v44, v44
v_cvt_pk_bf16_f32 v72, v40, v41
v_cvt_pk_bf16_f32 v73, v42, v43
v_mfma_f32_32x32x16_bf16 v[104:119], v[24:27], v[80:83], v[104:119]
v_exp_f32 v45, v45
v_exp_f32 v46, v46
v_exp_f32 v47, v47
v_exp_f32 v48, v48
v_exp_f32 v49, v49
v_cvt_pk_bf16_f32 v74, v44, v45
v_cvt_pk_bf16_f32 v75, v46, v47
v_mfma_f32_32x32x16_bf16 v[104:119], v[28:31], v[84:87], v[104:119]
v_exp_f32 v50, v50
v_exp_f32 v51, v51
v_cvt_pk_bf16_f32 v76, v48, v49
v_exp_f32 v52, v52
v_exp_f32 v53, v53
v_cvt_pk_bf16_f32 v77, v50, v51
v_exp_f32 v54, v54
v_exp_f32 v55, v55
v_cvt_pk_bf16_f32 v78, v52, v53
v_cvt_pk_bf16_f32 v79, v54, v55
s_waitcnt lgkmcnt(0)
v_mfma_f32_32x32x16_bf16 v[40:55], v[16:19], v[8:11], 0
buffer_load_dwordx4 a[152:155], v136, s[20:23], s85 offen
buffer_load_dwordx4 a[156:159], v137, s[20:23], s85 offen
v_exp_f32 v56, v56
v_exp_f32 v57, v57
v_exp_f32 v58, v58
v_exp_f32 v59, v59
v_exp_f32 v60, v60
v_cvt_pk_bf16_f32 v80, v56, v57
v_cvt_pk_bf16_f32 v81, v58, v59
v_mfma_f32_32x32x16_bf16 v[88:103], v[32:35], v[72:75], v[88:103]
s_add_u32 s85, s85, 44032
v_exp_f32 v61, v61
v_exp_f32 v62, v62
v_exp_f32 v63, v63
v_exp_f32 v64, v64
v_exp_f32 v65, v65
v_cvt_pk_bf16_f32 v82, v60, v61
v_cvt_pk_bf16_f32 v83, v62, v63
v_mfma_f32_32x32x16_bf16 v[88:103], v[36:39], v[76:79], v[88:103]
v_exp_f32 v66, v66
v_exp_f32 v67, v67
v_cvt_pk_bf16_f32 v84, v64, v65
v_exp_f32 v68, v68
v_exp_f32 v69, v69
v_cvt_pk_bf16_f32 v85, v66, v67
v_exp_f32 v70, v70
v_exp_f32 v71, v71
v_cvt_pk_bf16_f32 v86, v68, v69
v_cvt_pk_bf16_f32 v87, v70, v71
v_mfma_f32_32x32x16_bf16 v[56:71], v[16:19], v[12:15], 0
ds_read_b128 v[20:23], v6 offset:60320
ds_read_b128 v[24:27], v121 offset:58240
ds_read_b128 v[28:31], v122 offset:58240
v_exp_f32 v40, v40
v_exp_f32 v41, v41
v_exp_f32 v42, v42
v_exp_f32 v43, v43
v_exp_f32 v44, v44
v_cvt_pk_bf16_f32 v72, v40, v41
v_cvt_pk_bf16_f32 v73, v42, v43
v_mfma_f32_32x32x16_bf16 v[104:119], v[32:35], v[80:83], v[104:119]
v_exp_f32 v45, v45
v_exp_f32 v46, v46
v_exp_f32 v47, v47
v_exp_f32 v48, v48
v_exp_f32 v49, v49
v_cvt_pk_bf16_f32 v74, v44, v45
v_cvt_pk_bf16_f32 v75, v46, v47
v_mfma_f32_32x32x16_bf16 v[104:119], v[36:39], v[84:87], v[104:119]
v_exp_f32 v50, v50
v_exp_f32 v51, v51
v_cvt_pk_bf16_f32 v76, v48, v49
v_exp_f32 v52, v52
v_exp_f32 v53, v53
v_cvt_pk_bf16_f32 v77, v50, v51
v_exp_f32 v54, v54
v_exp_f32 v55, v55
v_cvt_pk_bf16_f32 v78, v52, v53
v_cvt_pk_bf16_f32 v79, v54, v55
s_waitcnt lgkmcnt(0)
v_mfma_f32_32x32x16_bf16 v[40:55], v[20:23], v[8:11], 0
buffer_load_dwordx4 a[160:163], v136, s[20:23], s85 offen
buffer_load_dwordx4 a[164:167], v137, s[20:23], s85 offen
v_exp_f32 v56, v56
v_exp_f32 v57, v57
v_exp_f32 v58, v58
v_exp_f32 v59, v59
v_exp_f32 v60, v60
v_cvt_pk_bf16_f32 v80, v56, v57
v_cvt_pk_bf16_f32 v81, v58, v59
v_mfma_f32_32x32x16_bf16 v[88:103], v[24:27], v[72:75], v[88:103]
s_add_u32 s85, s85, 44032
v_exp_f32 v61, v61
v_exp_f32 v62, v62
v_exp_f32 v63, v63
v_exp_f32 v64, v64
v_exp_f32 v65, v65
v_cvt_pk_bf16_f32 v82, v60, v61
v_cvt_pk_bf16_f32 v83, v62, v63
v_mfma_f32_32x32x16_bf16 v[88:103], v[28:31], v[76:79], v[88:103]
v_exp_f32 v66, v66
v_exp_f32 v67, v67
v_cvt_pk_bf16_f32 v84, v64, v65
v_exp_f32 v68, v68
v_exp_f32 v69, v69
v_cvt_pk_bf16_f32 v85, v66, v67
v_exp_f32 v70, v70
v_exp_f32 v71, v71
v_cvt_pk_bf16_f32 v86, v68, v69
v_cvt_pk_bf16_f32 v87, v70, v71
v_mfma_f32_32x32x16_bf16 v[56:71], v[20:23], v[12:15], 0
ds_read_b128 v[16:19], v6 offset:62400
ds_read_b128 v[32:35], v121 offset:60320
ds_read_b128 v[36:39], v122 offset:60320
v_exp_f32 v40, v40
v_exp_f32 v41, v41
v_exp_f32 v42, v42
v_exp_f32 v43, v43
v_exp_f32 v44, v44
v_cvt_pk_bf16_f32 v72, v40, v41
v_cvt_pk_bf16_f32 v73, v42, v43
v_mfma_f32_32x32x16_bf16 v[104:119], v[24:27], v[80:83], v[104:119]
v_exp_f32 v45, v45
v_exp_f32 v46, v46
v_exp_f32 v47, v47
v_exp_f32 v48, v48
v_exp_f32 v49, v49
v_cvt_pk_bf16_f32 v74, v44, v45
v_cvt_pk_bf16_f32 v75, v46, v47
v_mfma_f32_32x32x16_bf16 v[104:119], v[28:31], v[84:87], v[104:119]
v_exp_f32 v50, v50
v_exp_f32 v51, v51
v_cvt_pk_bf16_f32 v76, v48, v49
v_exp_f32 v52, v52
v_exp_f32 v53, v53
v_cvt_pk_bf16_f32 v77, v50, v51
v_exp_f32 v54, v54
v_exp_f32 v55, v55
v_cvt_pk_bf16_f32 v78, v52, v53
v_cvt_pk_bf16_f32 v79, v54, v55
s_waitcnt lgkmcnt(0)
v_mfma_f32_32x32x16_bf16 v[40:55], v[16:19], v[8:11], 0
buffer_load_dwordx4 a[168:171], v136, s[20:23], s85 offen
buffer_load_dwordx4 a[172:175], v137, s[20:23], s85 offen
v_exp_f32 v56, v56
v_exp_f32 v57, v57
v_exp_f32 v58, v58
v_exp_f32 v59, v59
v_exp_f32 v60, v60
v_cvt_pk_bf16_f32 v80, v56, v57
v_cvt_pk_bf16_f32 v81, v58, v59
v_mfma_f32_32x32x16_bf16 v[88:103], v[32:35], v[72:75], v[88:103]
s_add_u32 s85, s85, 44032
v_exp_f32 v61, v61
v_exp_f32 v62, v62
v_exp_f32 v63, v63
v_exp_f32 v64, v64
v_exp_f32 v65, v65
v_cvt_pk_bf16_f32 v82, v60, v61
v_cvt_pk_bf16_f32 v83, v62, v63
v_mfma_f32_32x32x16_bf16 v[88:103], v[36:39], v[76:79], v[88:103]
v_exp_f32 v66, v66
v_exp_f32 v67, v67
v_cvt_pk_bf16_f32 v84, v64, v65
v_exp_f32 v68, v68
v_exp_f32 v69, v69
v_cvt_pk_bf16_f32 v85, v66, v67
v_exp_f32 v70, v70
v_exp_f32 v71, v71
v_cvt_pk_bf16_f32 v86, v68, v69
v_cvt_pk_bf16_f32 v87, v70, v71
v_mfma_f32_32x32x16_bf16 v[56:71], v[16:19], v[12:15], 0
ds_read_b128 v[20:23], v6 offset:64480
ds_read_b128 v[24:27], v121 offset:62400
ds_read_b128 v[28:31], v122 offset:62400
v_exp_f32 v40, v40
v_exp_f32 v41, v41
v_exp_f32 v42, v42
v_exp_f32 v43, v43
v_exp_f32 v44, v44
v_cvt_pk_bf16_f32 v72, v40, v41
v_cvt_pk_bf16_f32 v73, v42, v43
v_mfma_f32_32x32x16_bf16 v[104:119], v[32:35], v[80:83], v[104:119]
v_exp_f32 v45, v45
v_exp_f32 v46, v46
v_exp_f32 v47, v47
v_exp_f32 v48, v48
v_exp_f32 v49, v49
v_cvt_pk_bf16_f32 v74, v44, v45
v_cvt_pk_bf16_f32 v75, v46, v47
v_mfma_f32_32x32x16_bf16 v[104:119], v[36:39], v[84:87], v[104:119]
v_exp_f32 v50, v50
v_exp_f32 v51, v51
v_cvt_pk_bf16_f32 v76, v48, v49
v_exp_f32 v52, v52
v_exp_f32 v53, v53
v_cvt_pk_bf16_f32 v77, v50, v51
v_exp_f32 v54, v54
v_exp_f32 v55, v55
v_cvt_pk_bf16_f32 v78, v52, v53
v_cvt_pk_bf16_f32 v79, v54, v55
s_waitcnt lgkmcnt(0)
v_mfma_f32_32x32x16_bf16 v[40:55], v[20:23], v[8:11], 0
buffer_load_dwordx4 a[176:179], v136, s[20:23], s85 offen
buffer_load_dwordx4 a[180:183], v137, s[20:23], s85 offen
v_exp_f32 v56, v56
v_exp_f32 v57, v57
v_exp_f32 v58, v58
v_exp_f32 v59, v59
v_exp_f32 v60, v60
v_cvt_pk_bf16_f32 v80, v56, v57
v_cvt_pk_bf16_f32 v81, v58, v59
v_mfma_f32_32x32x16_bf16 v[88:103], v[24:27], v[72:75], v[88:103]
s_add_u32 s85, s85, 44032
v_exp_f32 v61, v61
v_exp_f32 v62, v62
v_exp_f32 v63, v63
v_exp_f32 v64, v64
v_exp_f32 v65, v65
v_cvt_pk_bf16_f32 v82, v60, v61
v_cvt_pk_bf16_f32 v83, v62, v63
v_mfma_f32_32x32x16_bf16 v[88:103], v[28:31], v[76:79], v[88:103]
v_exp_f32 v66, v66
v_exp_f32 v67, v67
v_cvt_pk_bf16_f32 v84, v64, v65
v_exp_f32 v68, v68
v_exp_f32 v69, v69
v_cvt_pk_bf16_f32 v85, v66, v67
v_exp_f32 v70, v70
v_exp_f32 v71, v71
v_cvt_pk_bf16_f32 v86, v68, v69
v_cvt_pk_bf16_f32 v87, v70, v71
s_waitcnt vmcnt(36)
s_barrier
v_mfma_f32_32x32x16_bf16 v[56:71], v[20:23], v[12:15], 0
ds_read_b128 v[16:19], v6 offset:0
ds_read_b128 v[32:35], v121 offset:64480
ds_read_b128 v[36:39], v122 offset:64480
v_exp_f32 v40, v40
v_exp_f32 v41, v41
v_exp_f32 v42, v42
v_exp_f32 v43, v43
v_exp_f32 v44, v44
v_cvt_pk_bf16_f32 v72, v40, v41
v_cvt_pk_bf16_f32 v73, v42, v43
v_mfma_f32_32x32x16_bf16 v[104:119], v[24:27], v[80:83], v[104:119]
s_add_u32 m0, s59, 33280
s_nop 0
buffer_load_dwordx4 v6, s[40:43], s58 offen sc1 lds
buffer_load_dwordx4 v6, s[40:43], s58 offen offset:1024 sc1 lds
s_add_u32 m0, s59, 33312
s_nop 0
buffer_load_dwordx4 v6, s[40:43], s58 offen offset:2048 sc1 lds
buffer_load_dwordx4 v6, s[40:43], s58 offen offset:3072 sc1 lds
s_add_u32 s58, s58, 16384
v_exp_f32 v45, v45
v_exp_f32 v46, v46
v_exp_f32 v47, v47
v_exp_f32 v48, v48
v_exp_f32 v49, v49
v_cvt_pk_bf16_f32 v74, v44, v45
v_cvt_pk_bf16_f32 v75, v46, v47
v_mfma_f32_32x32x16_bf16 v[104:119], v[28:31], v[84:87], v[104:119]
v_exp_f32 v50, v50
v_exp_f32 v51, v51
v_cvt_pk_bf16_f32 v76, v48, v49
v_exp_f32 v52, v52
v_exp_f32 v53, v53
v_cvt_pk_bf16_f32 v77, v50, v51
v_exp_f32 v54, v54
v_exp_f32 v55, v55
v_cvt_pk_bf16_f32 v78, v52, v53
v_cvt_pk_bf16_f32 v79, v54, v55
s_waitcnt lgkmcnt(0)
v_mfma_f32_32x32x16_bf16 v[40:55], v[16:19], v[8:11], 0
buffer_load_dwordx4 a[184:187], v136, s[20:23], s85 offen
buffer_load_dwordx4 a[188:191], v137, s[20:23], s85 offen
v_exp_f32 v56, v56
v_exp_f32 v57, v57
v_exp_f32 v58, v58
v_exp_f32 v59, v59
v_exp_f32 v60, v60
v_cvt_pk_bf16_f32 v80, v56, v57
v_cvt_pk_bf16_f32 v81, v58, v59
v_mfma_f32_32x32x16_bf16 v[88:103], v[32:35], v[72:75], v[88:103]
s_add_u32 s85, s85, 44032
v_exp_f32 v61, v61
v_exp_f32 v62, v62
v_exp_f32 v63, v63
v_exp_f32 v64, v64
v_exp_f32 v65, v65
v_cvt_pk_bf16_f32 v82, v60, v61
v_cvt_pk_bf16_f32 v83, v62, v63
v_mfma_f32_32x32x16_bf16 v[88:103], v[36:39], v[76:79], v[88:103]
v_exp_f32 v66, v66
v_exp_f32 v67, v67
v_cvt_pk_bf16_f32 v84, v64, v65
v_exp_f32 v68, v68
v_exp_f32 v69, v69
v_cvt_pk_bf16_f32 v85, v66, v67
v_exp_f32 v70, v70
v_exp_f32 v71, v71
v_cvt_pk_bf16_f32 v86, v68, v69
v_cvt_pk_bf16_f32 v87, v70, v71
v_mfma_f32_32x32x16_bf16 v[56:71], v[16:19], v[12:15], 0
ds_read_b128 v[20:23], v6 offset:2080
ds_read_b128 v[24:27], v121 offset:0
ds_read_b128 v[28:31], v122 offset:0
v_exp_f32 v40, v40
v_exp_f32 v41, v41
v_exp_f32 v42, v42
v_exp_f32 v43, v43
v_exp_f32 v44, v44
v_cvt_pk_bf16_f32 v72, v40, v41
v_cvt_pk_bf16_f32 v73, v42, v43
v_mfma_f32_32x32x16_bf16 v[104:119], v[32:35], v[80:83], v[104:119]
v_exp_f32 v45, v45
v_exp_f32 v46, v46
v_exp_f32 v47, v47
v_exp_f32 v48, v48
v_exp_f32 v49, v49
v_cvt_pk_bf16_f32 v74, v44, v45
v_cvt_pk_bf16_f32 v75, v46, v47
v_mfma_f32_32x32x16_bf16 v[104:119], v[36:39], v[84:87], v[104:119]
v_exp_f32 v50, v50
v_exp_f32 v51, v51
v_cvt_pk_bf16_f32 v76, v48, v49
v_exp_f32 v52, v52
v_exp_f32 v53, v53
v_cvt_pk_bf16_f32 v77, v50, v51
v_exp_f32 v54, v54
v_exp_f32 v55, v55
v_cvt_pk_bf16_f32 v78, v52, v53
v_cvt_pk_bf16_f32 v79, v54, v55
s_waitcnt lgkmcnt(0)
v_mfma_f32_32x32x16_bf16 v[40:55], v[20:23], v[8:11], 0
buffer_load_dwordx4 a[192:195], v136, s[20:23], s85 offen
buffer_load_dwordx4 a[196:199], v137, s[20:23], s85 offen
v_exp_f32 v56, v56
v_exp_f32 v57, v57
v_exp_f32 v58, v58
v_exp_f32 v59, v59
v_exp_f32 v60, v60
v_cvt_pk_bf16_f32 v80, v56, v57
v_cvt_pk_bf16_f32 v81, v58, v59
v_mfma_f32_32x32x16_bf16 v[88:103], v[24:27], v[72:75], v[88:103]
s_add_u32 s85, s85, 44032
v_exp_f32 v61, v61
v_exp_f32 v62, v62
v_exp_f32 v63, v63
v_exp_f32 v64, v64
v_exp_f32 v65, v65
v_cvt_pk_bf16_f32 v82, v60, v61
v_cvt_pk_bf16_f32 v83, v62, v63
v_mfma_f32_32x32x16_bf16 v[88:103], v[28:31], v[76:79], v[88:103]
v_exp_f32 v66, v66
v_exp_f32 v67, v67
v_cvt_pk_bf16_f32 v84, v64, v65
v_exp_f32 v68, v68
v_exp_f32 v69, v69
v_cvt_pk_bf16_f32 v85, v66, v67
v_exp_f32 v70, v70
v_exp_f32 v71, v71
v_cvt_pk_bf16_f32 v86, v68, v69
v_cvt_pk_bf16_f32 v87, v70, v71
v_mfma_f32_32x32x16_bf16 v[56:71], v[20:23], v[12:15], 0
ds_read_b128 v[16:19], v6 offset:4160
ds_read_b128 v[32:35], v121 offset:2080
ds_read_b128 v[36:39], v122 offset:2080
v_exp_f32 v40, v40
v_exp_f32 v41, v41
v_exp_f32 v42, v42
v_exp_f32 v43, v43
v_exp_f32 v44, v44
v_cvt_pk_bf16_f32 v72, v40, v41
v_cvt_pk_bf16_f32 v73, v42, v43
v_mfma_f32_32x32x16_bf16 v[104:119], v[24:27], v[80:83], v[104:119]
v_exp_f32 v45, v45
v_exp_f32 v46, v46
v_exp_f32 v47, v47
v_exp_f32 v48, v48
v_exp_f32 v49, v49
v_cvt_pk_bf16_f32 v74, v44, v45
v_cvt_pk_bf16_f32 v75, v46, v47
v_mfma_f32_32x32x16_bf16 v[104:119], v[28:31], v[84:87], v[104:119]
v_exp_f32 v50, v50
v_exp_f32 v51, v51
v_cvt_pk_bf16_f32 v76, v48, v49
v_exp_f32 v52, v52
v_exp_f32 v53, v53
v_cvt_pk_bf16_f32 v77, v50, v51
v_exp_f32 v54, v54
v_exp_f32 v55, v55
v_cvt_pk_bf16_f32 v78, v52, v53
v_cvt_pk_bf16_f32 v79, v54, v55
s_waitcnt lgkmcnt(0)
v_mfma_f32_32x32x16_bf16 v[40:55], v[16:19], v[8:11], 0
buffer_load_dwordx4 a[200:203], v136, s[20:23], s85 offen
buffer_load_dwordx4 a[204:207], v137, s[20:23], s85 offen
v_exp_f32 v56, v56
v_exp_f32 v57, v57
v_exp_f32 v58, v58
v_exp_f32 v59, v59
v_exp_f32 v60, v60
v_cvt_pk_bf16_f32 v80, v56, v57
v_cvt_pk_bf16_f32 v81, v58, v59
v_mfma_f32_32x32x16_bf16 v[88:103], v[32:35], v[72:75], v[88:103]
s_add_u32 s85, s85, 44032
v_exp_f32 v61, v61
v_exp_f32 v62, v62
v_exp_f32 v63, v63
v_exp_f32 v64, v64
v_exp_f32 v65, v65
v_cvt_pk_bf16_f32 v82, v60, v61
v_cvt_pk_bf16_f32 v83, v62, v63
v_mfma_f32_32x32x16_bf16 v[88:103], v[36:39], v[76:79], v[88:103]
v_exp_f32 v66, v66
v_exp_f32 v67, v67
v_cvt_pk_bf16_f32 v84, v64, v65
v_exp_f32 v68, v68
v_exp_f32 v69, v69
v_cvt_pk_bf16_f32 v85, v66, v67
v_exp_f32 v70, v70
v_exp_f32 v71, v71
v_cvt_pk_bf16_f32 v86, v68, v69
v_cvt_pk_bf16_f32 v87, v70, v71
v_mfma_f32_32x32x16_bf16 v[56:71], v[16:19], v[12:15], 0
ds_read_b128 v[20:23], v6 offset:6240
ds_read_b128 v[24:27], v121 offset:4160
ds_read_b128 v[28:31], v122 offset:4160
v_exp_f32 v40, v40
v_exp_f32 v41, v41
v_exp_f32 v42, v42
v_exp_f32 v43, v43
v_exp_f32 v44, v44
v_cvt_pk_bf16_f32 v72, v40, v41
v_cvt_pk_bf16_f32 v73, v42, v43
v_mfma_f32_32x32x16_bf16 v[104:119], v[32:35], v[80:83], v[104:119]
v_exp_f32 v45, v45
v_exp_f32 v46, v46
v_exp_f32 v47, v47
v_exp_f32 v48, v48
v_exp_f32 v49, v49
v_cvt_pk_bf16_f32 v74, v44, v45
v_cvt_pk_bf16_f32 v75, v46, v47
v_mfma_f32_32x32x16_bf16 v[104:119], v[36:39], v[84:87], v[104:119]
v_exp_f32 v50, v50
v_exp_f32 v51, v51
v_cvt_pk_bf16_f32 v76, v48, v49
v_exp_f32 v52, v52
v_exp_f32 v53, v53
v_cvt_pk_bf16_f32 v77, v50, v51
v_exp_f32 v54, v54
v_exp_f32 v55, v55
v_cvt_pk_bf16_f32 v78, v52, v53
v_cvt_pk_bf16_f32 v79, v54, v55
s_waitcnt lgkmcnt(0)
v_mfma_f32_32x32x16_bf16 v[40:55], v[20:23], v[8:11], 0
buffer_load_dwordx4 a[208:211], v136, s[20:23], s85 offen
buffer_load_dwordx4 a[212:215], v137, s[20:23], s85 offen
v_exp_f32 v56, v56
v_exp_f32 v57, v57
v_exp_f32 v58, v58
v_exp_f32 v59, v59
v_exp_f32 v60, v60
v_cvt_pk_bf16_f32 v80, v56, v57
v_cvt_pk_bf16_f32 v81, v58, v59
v_mfma_f32_32x32x16_bf16 v[88:103], v[24:27], v[72:75], v[88:103]
s_add_u32 s85, s85, 44032
v_exp_f32 v61, v61
v_exp_f32 v62, v62
v_exp_f32 v63, v63
v_exp_f32 v64, v64
v_exp_f32 v65, v65
v_cvt_pk_bf16_f32 v82, v60, v61
v_cvt_pk_bf16_f32 v83, v62, v63
v_mfma_f32_32x32x16_bf16 v[88:103], v[28:31], v[76:79], v[88:103]
v_exp_f32 v66, v66
v_exp_f32 v67, v67
v_cvt_pk_bf16_f32 v84, v64, v65
v_exp_f32 v68, v68
v_exp_f32 v69, v69
v_cvt_pk_bf16_f32 v85, v66, v67
v_exp_f32 v70, v70
v_exp_f32 v71, v71
v_cvt_pk_bf16_f32 v86, v68, v69
v_cvt_pk_bf16_f32 v87, v70, v71
v_mfma_f32_32x32x16_bf16 v[56:71], v[20:23], v[12:15], 0
ds_read_b128 v[16:19], v6 offset:8320
ds_read_b128 v[32:35], v121 offset:6240
ds_read_b128 v[36:39], v122 offset:6240
v_exp_f32 v40, v40
v_exp_f32 v41, v41
v_exp_f32 v42, v42
v_exp_f32 v43, v43
v_exp_f32 v44, v44
v_cvt_pk_bf16_f32 v72, v40, v41
v_cvt_pk_bf16_f32 v73, v42, v43
v_mfma_f32_32x32x16_bf16 v[104:119], v[24:27], v[80:83], v[104:119]
v_exp_f32 v45, v45
v_exp_f32 v46, v46
v_exp_f32 v47, v47
v_exp_f32 v48, v48
v_exp_f32 v49, v49
v_cvt_pk_bf16_f32 v74, v44, v45
v_cvt_pk_bf16_f32 v75, v46, v47
v_mfma_f32_32x32x16_bf16 v[104:119], v[28:31], v[84:87], v[104:119]
v_exp_f32 v50, v50
v_exp_f32 v51, v51
v_cvt_pk_bf16_f32 v76, v48, v49
v_exp_f32 v52, v52
v_exp_f32 v53, v53
v_cvt_pk_bf16_f32 v77, v50, v51
v_exp_f32 v54, v54
v_exp_f32 v55, v55
v_cvt_pk_bf16_f32 v78, v52, v53
v_cvt_pk_bf16_f32 v79, v54, v55
s_waitcnt lgkmcnt(0)
v_mfma_f32_32x32x16_bf16 v[40:55], v[16:19], v[8:11], 0
buffer_load_dwordx4 a[216:219], v136, s[20:23], s85 offen
buffer_load_dwordx4 a[220:223], v137, s[20:23], s85 offen
v_exp_f32 v56, v56
v_exp_f32 v57, v57
v_exp_f32 v58, v58
v_exp_f32 v59, v59
v_exp_f32 v60, v60
v_cvt_pk_bf16_f32 v80, v56, v57
v_cvt_pk_bf16_f32 v81, v58, v59
v_mfma_f32_32x32x16_bf16 v[88:103], v[32:35], v[72:75], v[88:103]
s_add_u32 s85, s85, 44032
v_exp_f32 v61, v61
v_exp_f32 v62, v62
v_exp_f32 v63, v63
v_exp_f32 v64, v64
v_exp_f32 v65, v65
v_cvt_pk_bf16_f32 v82, v60, v61
v_cvt_pk_bf16_f32 v83, v62, v63
v_mfma_f32_32x32x16_bf16 v[88:103], v[36:39], v[76:79], v[88:103]
v_exp_f32 v66, v66
v_exp_f32 v67, v67
v_cvt_pk_bf16_f32 v84, v64, v65
v_exp_f32 v68, v68
v_exp_f32 v69, v69
v_cvt_pk_bf16_f32 v85, v66, v67
v_exp_f32 v70, v70
v_exp_f32 v71, v71
v_cvt_pk_bf16_f32 v86, v68, v69
v_cvt_pk_bf16_f32 v87, v70, v71
v_mfma_f32_32x32x16_bf16 v[56:71], v[16:19], v[12:15], 0
ds_read_b128 v[20:23], v6 offset:10400
ds_read_b128 v[24:27], v121 offset:8320
ds_read_b128 v[28:31], v122 offset:8320
v_exp_f32 v40, v40
v_exp_f32 v41, v41
v_exp_f32 v42, v42
v_exp_f32 v43, v43
v_exp_f32 v44, v44
v_cvt_pk_bf16_f32 v72, v40, v41
v_cvt_pk_bf16_f32 v73, v42, v43
v_mfma_f32_32x32x16_bf16 v[104:119], v[32:35], v[80:83], v[104:119]
v_exp_f32 v45, v45
v_exp_f32 v46, v46
v_exp_f32 v47, v47
v_exp_f32 v48, v48
v_exp_f32 v49, v49
v_cvt_pk_bf16_f32 v74, v44, v45
v_cvt_pk_bf16_f32 v75, v46, v47
v_mfma_f32_32x32x16_bf16 v[104:119], v[36:39], v[84:87], v[104:119]
v_exp_f32 v50, v50
v_exp_f32 v51, v51
v_cvt_pk_bf16_f32 v76, v48, v49
v_exp_f32 v52, v52
v_exp_f32 v53, v53
v_cvt_pk_bf16_f32 v77, v50, v51
v_exp_f32 v54, v54
v_exp_f32 v55, v55
v_cvt_pk_bf16_f32 v78, v52, v53
v_cvt_pk_bf16_f32 v79, v54, v55
s_waitcnt lgkmcnt(0)
v_mfma_f32_32x32x16_bf16 v[40:55], v[20:23], v[8:11], 0
buffer_load_dwordx4 a[224:227], v136, s[20:23], s85 offen
buffer_load_dwordx4 a[228:231], v137, s[20:23], s85 offen
v_exp_f32 v56, v56
v_exp_f32 v57, v57
v_exp_f32 v58, v58
v_exp_f32 v59, v59
v_exp_f32 v60, v60
v_cvt_pk_bf16_f32 v80, v56, v57
v_cvt_pk_bf16_f32 v81, v58, v59
v_mfma_f32_32x32x16_bf16 v[88:103], v[24:27], v[72:75], v[88:103]
s_add_u32 s85, s85, 44032
v_exp_f32 v61, v61
v_exp_f32 v62, v62
v_exp_f32 v63, v63
v_exp_f32 v64, v64
v_exp_f32 v65, v65
v_cvt_pk_bf16_f32 v82, v60, v61
v_cvt_pk_bf16_f32 v83, v62, v63
v_mfma_f32_32x32x16_bf16 v[88:103], v[28:31], v[76:79], v[88:103]
v_exp_f32 v66, v66
v_exp_f32 v67, v67
v_cvt_pk_bf16_f32 v84, v64, v65
v_exp_f32 v68, v68
v_exp_f32 v69, v69
v_cvt_pk_bf16_f32 v85, v66, v67
v_exp_f32 v70, v70
v_exp_f32 v71, v71
v_cvt_pk_bf16_f32 v86, v68, v69
v_cvt_pk_bf16_f32 v87, v70, v71
v_mfma_f32_32x32x16_bf16 v[56:71], v[20:23], v[12:15], 0
ds_read_b128 v[16:19], v6 offset:12480
ds_read_b128 v[32:35], v121 offset:10400
ds_read_b128 v[36:39], v122 offset:10400
v_exp_f32 v40, v40
v_exp_f32 v41, v41
v_exp_f32 v42, v42
v_exp_f32 v43, v43
v_exp_f32 v44, v44
v_cvt_pk_bf16_f32 v72, v40, v41
v_cvt_pk_bf16_f32 v73, v42, v43
v_mfma_f32_32x32x16_bf16 v[104:119], v[24:27], v[80:83], v[104:119]
v_exp_f32 v45, v45
v_exp_f32 v46, v46
v_exp_f32 v47, v47
v_exp_f32 v48, v48
v_exp_f32 v49, v49
v_cvt_pk_bf16_f32 v74, v44, v45
v_cvt_pk_bf16_f32 v75, v46, v47
v_mfma_f32_32x32x16_bf16 v[104:119], v[28:31], v[84:87], v[104:119]
v_exp_f32 v50, v50
v_exp_f32 v51, v51
v_cvt_pk_bf16_f32 v76, v48, v49
v_exp_f32 v52, v52
v_exp_f32 v53, v53
v_cvt_pk_bf16_f32 v77, v50, v51
v_exp_f32 v54, v54
v_exp_f32 v55, v55
v_cvt_pk_bf16_f32 v78, v52, v53
v_cvt_pk_bf16_f32 v79, v54, v55
s_waitcnt lgkmcnt(0)
v_mfma_f32_32x32x16_bf16 v[40:55], v[16:19], v[8:11], 0
buffer_load_dwordx4 a[232:235], v136, s[20:23], s85 offen
buffer_load_dwordx4 a[236:239], v137, s[20:23], s85 offen
v_exp_f32 v56, v56
v_exp_f32 v57, v57
v_exp_f32 v58, v58
v_exp_f32 v59, v59
v_exp_f32 v60, v60
v_cvt_pk_bf16_f32 v80, v56, v57
v_cvt_pk_bf16_f32 v81, v58, v59
v_mfma_f32_32x32x16_bf16 v[88:103], v[32:35], v[72:75], v[88:103]
s_add_u32 s85, s85, 44032
v_exp_f32 v61, v61
v_exp_f32 v62, v62
v_exp_f32 v63, v63
v_exp_f32 v64, v64
v_exp_f32 v65, v65
v_cvt_pk_bf16_f32 v82, v60, v61
v_cvt_pk_bf16_f32 v83, v62, v63
v_mfma_f32_32x32x16_bf16 v[88:103], v[36:39], v[76:79], v[88:103]
v_exp_f32 v66, v66
v_exp_f32 v67, v67
v_cvt_pk_bf16_f32 v84, v64, v65
v_exp_f32 v68, v68
v_exp_f32 v69, v69
v_cvt_pk_bf16_f32 v85, v66, v67
v_exp_f32 v70, v70
v_exp_f32 v71, v71
v_cvt_pk_bf16_f32 v86, v68, v69
v_cvt_pk_bf16_f32 v87, v70, v71
v_mfma_f32_32x32x16_bf16 v[56:71], v[16:19], v[12:15], 0
ds_read_b128 v[20:23], v6 offset:14560
ds_read_b128 v[24:27], v121 offset:12480
ds_read_b128 v[28:31], v122 offset:12480
v_exp_f32 v40, v40
v_exp_f32 v41, v41
v_exp_f32 v42, v42
v_exp_f32 v43, v43
v_exp_f32 v44, v44
v_cvt_pk_bf16_f32 v72, v40, v41
v_cvt_pk_bf16_f32 v73, v42, v43
v_mfma_f32_32x32x16_bf16 v[104:119], v[32:35], v[80:83], v[104:119]
v_exp_f32 v45, v45
v_exp_f32 v46, v46
v_exp_f32 v47, v47
v_exp_f32 v48, v48
v_exp_f32 v49, v49
v_cvt_pk_bf16_f32 v74, v44, v45
v_cvt_pk_bf16_f32 v75, v46, v47
v_mfma_f32_32x32x16_bf16 v[104:119], v[36:39], v[84:87], v[104:119]
v_exp_f32 v50, v50
v_exp_f32 v51, v51
v_cvt_pk_bf16_f32 v76, v48, v49
v_exp_f32 v52, v52
v_exp_f32 v53, v53
v_cvt_pk_bf16_f32 v77, v50, v51
v_exp_f32 v54, v54
v_exp_f32 v55, v55
v_cvt_pk_bf16_f32 v78, v52, v53
v_cvt_pk_bf16_f32 v79, v54, v55
s_waitcnt lgkmcnt(0)
v_mfma_f32_32x32x16_bf16 v[40:55], v[20:23], v[8:11], 0
buffer_load_dwordx4 a[240:243], v136, s[20:23], s85 offen
buffer_load_dwordx4 a[244:247], v137, s[20:23], s85 offen
v_exp_f32 v56, v56
v_exp_f32 v57, v57
v_exp_f32 v58, v58
v_exp_f32 v59, v59
v_exp_f32 v60, v60
v_cvt_pk_bf16_f32 v80, v56, v57
v_cvt_pk_bf16_f32 v81, v58, v59
v_mfma_f32_32x32x16_bf16 v[88:103], v[24:27], v[72:75], v[88:103]
s_add_u32 s85, s85, 44032
v_exp_f32 v61, v61
v_exp_f32 v62, v62
v_exp_f32 v63, v63
v_exp_f32 v64, v64
v_exp_f32 v65, v65
v_cvt_pk_bf16_f32 v82, v60, v61
v_cvt_pk_bf16_f32 v83, v62, v63
v_mfma_f32_32x32x16_bf16 v[88:103], v[28:31], v[76:79], v[88:103]
v_exp_f32 v66, v66
v_exp_f32 v67, v67
v_cvt_pk_bf16_f32 v84, v64, v65
v_exp_f32 v68, v68
v_exp_f32 v69, v69
v_cvt_pk_bf16_f32 v85, v66, v67
v_exp_f32 v70, v70
v_exp_f32 v71, v71
v_cvt_pk_bf16_f32 v86, v68, v69
v_cvt_pk_bf16_f32 v87, v70, v71
s_waitcnt vmcnt(36)
s_barrier
v_mfma_f32_32x32x16_bf16 v[56:71], v[20:23], v[12:15], 0
ds_read_b128 v[16:19], v6 offset:16640
ds_read_b128 v[32:35], v121 offset:14560
ds_read_b128 v[36:39], v122 offset:14560
v_exp_f32 v40, v40
v_exp_f32 v41, v41
v_exp_f32 v42, v42
v_exp_f32 v43, v43
v_exp_f32 v44, v44
v_cvt_pk_bf16_f32 v72, v40, v41
v_cvt_pk_bf16_f32 v73, v42, v43
v_mfma_f32_32x32x16_bf16 v[104:119], v[24:27], v[80:83], v[104:119]
s_add_u32 m0, s59, 49920
s_nop 0
buffer_load_dwordx4 v6, s[40:43], s58 offen sc1 lds
buffer_load_dwordx4 v6, s[40:43], s58 offen offset:1024 sc1 lds
s_add_u32 m0, s59, 49952
s_nop 0
buffer_load_dwordx4 v6, s[40:43], s58 offen offset:2048 sc1 lds
buffer_load_dwordx4 v6, s[40:43], s58 offen offset:3072 sc1 lds
s_add_u32 s58, s58, 16384
v_exp_f32 v45, v45
v_exp_f32 v46, v46
v_exp_f32 v47, v47
v_exp_f32 v48, v48
v_exp_f32 v49, v49
v_cvt_pk_bf16_f32 v74, v44, v45
v_cvt_pk_bf16_f32 v75, v46, v47
v_mfma_f32_32x32x16_bf16 v[104:119], v[28:31], v[84:87], v[104:119]
v_exp_f32 v50, v50
v_exp_f32 v51, v51
v_cvt_pk_bf16_f32 v76, v48, v49
v_exp_f32 v52, v52
v_exp_f32 v53, v53
v_cvt_pk_bf16_f32 v77, v50, v51
v_exp_f32 v54, v54
v_exp_f32 v55, v55
v_cvt_pk_bf16_f32 v78, v52, v53
v_cvt_pk_bf16_f32 v79, v54, v55
s_waitcnt lgkmcnt(0)
v_mfma_f32_32x32x16_bf16 v[40:55], v[16:19], v[8:11], 0
buffer_load_dwordx4 a[248:251], v136, s[20:23], s85 offen
buffer_load_dwordx4 a[252:255], v137, s[20:23], s85 offen
v_exp_f32 v56, v56
v_exp_f32 v57, v57
v_exp_f32 v58, v58
v_exp_f32 v59, v59
v_exp_f32 v60, v60
v_cvt_pk_bf16_f32 v80, v56, v57
v_cvt_pk_bf16_f32 v81, v58, v59
v_mfma_f32_32x32x16_bf16 v[88:103], v[32:35], v[72:75], v[88:103]
s_add_u32 s85, s85, 44032
v_exp_f32 v61, v61
v_exp_f32 v62, v62
v_exp_f32 v63, v63
v_exp_f32 v64, v64
v_exp_f32 v65, v65
v_cvt_pk_bf16_f32 v82, v60, v61
v_cvt_pk_bf16_f32 v83, v62, v63
v_mfma_f32_32x32x16_bf16 v[88:103], v[36:39], v[76:79], v[88:103]
v_exp_f32 v66, v66
v_exp_f32 v67, v67
v_cvt_pk_bf16_f32 v84, v64, v65
v_exp_f32 v68, v68
v_exp_f32 v69, v69
v_cvt_pk_bf16_f32 v85, v66, v67
v_exp_f32 v70, v70
v_exp_f32 v71, v71
v_cvt_pk_bf16_f32 v86, v68, v69
v_cvt_pk_bf16_f32 v87, v70, v71
v_mfma_f32_32x32x16_bf16 v[56:71], v[16:19], v[12:15], 0
ds_read_b128 v[20:23], v6 offset:18720
ds_read_b128 v[24:27], v121 offset:16640
ds_read_b128 v[28:31], v122 offset:16640
v_exp_f32 v40, v40
v_exp_f32 v41, v41
v_exp_f32 v42, v42
v_exp_f32 v43, v43
v_exp_f32 v44, v44
v_cvt_pk_bf16_f32 v72, v40, v41
v_cvt_pk_bf16_f32 v73, v42, v43
v_mfma_f32_32x32x16_bf16 v[104:119], v[32:35], v[80:83], v[104:119]
v_exp_f32 v45, v45
v_exp_f32 v46, v46
v_exp_f32 v47, v47
v_exp_f32 v48, v48
v_exp_f32 v49, v49
v_cvt_pk_bf16_f32 v74, v44, v45
v_cvt_pk_bf16_f32 v75, v46, v47
v_mfma_f32_32x32x16_bf16 v[104:119], v[36:39], v[84:87], v[104:119]
v_exp_f32 v50, v50
v_exp_f32 v51, v51
v_cvt_pk_bf16_f32 v76, v48, v49
v_exp_f32 v52, v52
v_exp_f32 v53, v53
v_cvt_pk_bf16_f32 v77, v50, v51
v_exp_f32 v54, v54
v_exp_f32 v55, v55
v_cvt_pk_bf16_f32 v78, v52, v53
v_cvt_pk_bf16_f32 v79, v54, v55
s_waitcnt lgkmcnt(0)
v_mfma_f32_32x32x16_bf16 v[40:55], v[20:23], v[8:11], 0
buffer_load_dwordx4 v[152:155], v138, s[24:27], s86 offen
buffer_load_dwordx4 v[156:159], v139, s[24:27], s86 offen offset:1024
v_exp_f32 v56, v56
v_exp_f32 v57, v57
v_exp_f32 v58, v58
v_exp_f32 v59, v59
v_exp_f32 v60, v60
v_cvt_pk_bf16_f32 v80, v56, v57
v_cvt_pk_bf16_f32 v81, v58, v59
v_mfma_f32_32x32x16_bf16 v[88:103], v[24:27], v[72:75], v[88:103]
s_add_u32 s86, s86, 65536
v_exp_f32 v61, v61
v_exp_f32 v62, v62
v_exp_f32 v63, v63
v_exp_f32 v64, v64
v_exp_f32 v65, v65
v_cvt_pk_bf16_f32 v82, v60, v61
v_cvt_pk_bf16_f32 v83, v62, v63
v_mfma_f32_32x32x16_bf16 v[88:103], v[28:31], v[76:79], v[88:103]
v_exp_f32 v66, v66
v_exp_f32 v67, v67
v_cvt_pk_bf16_f32 v84, v64, v65
v_exp_f32 v68, v68
v_exp_f32 v69, v69
v_cvt_pk_bf16_f32 v85, v66, v67
v_exp_f32 v70, v70
v_exp_f32 v71, v71
v_cvt_pk_bf16_f32 v86, v68, v69
v_cvt_pk_bf16_f32 v87, v70, v71
v_mfma_f32_32x32x16_bf16 v[56:71], v[20:23], v[12:15], 0
ds_read_b128 v[16:19], v6 offset:20800
ds_read_b128 v[32:35], v121 offset:18720
ds_read_b128 v[36:39], v122 offset:18720
v_exp_f32 v40, v40
v_exp_f32 v41, v41
v_exp_f32 v42, v42
v_exp_f32 v43, v43
v_exp_f32 v44, v44
v_cvt_pk_bf16_f32 v72, v40, v41
v_cvt_pk_bf16_f32 v73, v42, v43
v_mfma_f32_32x32x16_bf16 v[104:119], v[24:27], v[80:83], v[104:119]
v_exp_f32 v45, v45
v_exp_f32 v46, v46
v_exp_f32 v47, v47
v_exp_f32 v48, v48
v_exp_f32 v49, v49
v_cvt_pk_bf16_f32 v74, v44, v45
v_cvt_pk_bf16_f32 v75, v46, v47
v_mfma_f32_32x32x16_bf16 v[104:119], v[28:31], v[84:87], v[104:119]
v_exp_f32 v50, v50
v_exp_f32 v51, v51
v_cvt_pk_bf16_f32 v76, v48, v49
v_exp_f32 v52, v52
v_exp_f32 v53, v53
v_cvt_pk_bf16_f32 v77, v50, v51
v_exp_f32 v54, v54
v_exp_f32 v55, v55
v_cvt_pk_bf16_f32 v78, v52, v53
v_cvt_pk_bf16_f32 v79, v54, v55
s_waitcnt lgkmcnt(0)
v_mfma_f32_32x32x16_bf16 v[40:55], v[16:19], v[8:11], 0
buffer_load_dwordx4 v[160:163], v138, s[24:27], s86 offen
buffer_load_dwordx4 v[164:167], v139, s[24:27], s86 offen offset:1024
v_exp_f32 v56, v56
v_exp_f32 v57, v57
v_exp_f32 v58, v58
v_exp_f32 v59, v59
v_exp_f32 v60, v60
v_cvt_pk_bf16_f32 v80, v56, v57
v_cvt_pk_bf16_f32 v81, v58, v59
v_mfma_f32_32x32x16_bf16 v[88:103], v[32:35], v[72:75], v[88:103]
s_add_u32 s86, s86, 65536
v_exp_f32 v61, v61
v_exp_f32 v62, v62
v_exp_f32 v63, v63
v_exp_f32 v64, v64
v_exp_f32 v65, v65
v_cvt_pk_bf16_f32 v82, v60, v61
v_cvt_pk_bf16_f32 v83, v62, v63
v_mfma_f32_32x32x16_bf16 v[88:103], v[36:39], v[76:79], v[88:103]
v_exp_f32 v66, v66
v_exp_f32 v67, v67
v_cvt_pk_bf16_f32 v84, v64, v65
v_exp_f32 v68, v68
v_exp_f32 v69, v69
v_cvt_pk_bf16_f32 v85, v66, v67
v_exp_f32 v70, v70
v_exp_f32 v71, v71
v_cvt_pk_bf16_f32 v86, v68, v69
v_cvt_pk_bf16_f32 v87, v70, v71
v_mfma_f32_32x32x16_bf16 v[56:71], v[16:19], v[12:15], 0
ds_read_b128 v[20:23], v6 offset:22880
ds_read_b128 v[24:27], v121 offset:20800
ds_read_b128 v[28:31], v122 offset:20800
v_exp_f32 v40, v40
v_exp_f32 v41, v41
v_exp_f32 v42, v42
v_exp_f32 v43, v43
v_exp_f32 v44, v44
v_cvt_pk_bf16_f32 v72, v40, v41
v_cvt_pk_bf16_f32 v73, v42, v43
v_mfma_f32_32x32x16_bf16 v[104:119], v[32:35], v[80:83], v[104:119]
v_exp_f32 v45, v45
v_exp_f32 v46, v46
v_exp_f32 v47, v47
v_exp_f32 v48, v48
v_exp_f32 v49, v49
v_cvt_pk_bf16_f32 v74, v44, v45
v_cvt_pk_bf16_f32 v75, v46, v47
v_mfma_f32_32x32x16_bf16 v[104:119], v[36:39], v[84:87], v[104:119]
v_exp_f32 v50, v50
v_exp_f32 v51, v51
v_cvt_pk_bf16_f32 v76, v48, v49
v_exp_f32 v52, v52
v_exp_f32 v53, v53
v_cvt_pk_bf16_f32 v77, v50, v51
v_exp_f32 v54, v54
v_exp_f32 v55, v55
v_cvt_pk_bf16_f32 v78, v52, v53
v_cvt_pk_bf16_f32 v79, v54, v55
s_waitcnt lgkmcnt(0)
v_mfma_f32_32x32x16_bf16 v[40:55], v[20:23], v[8:11], 0
buffer_load_dwordx4 v[168:171], v138, s[24:27], s86 offen
buffer_load_dwordx4 v[172:175], v139, s[24:27], s86 offen offset:1024
v_exp_f32 v56, v56
v_exp_f32 v57, v57
v_exp_f32 v58, v58
v_exp_f32 v59, v59
v_exp_f32 v60, v60
v_cvt_pk_bf16_f32 v80, v56, v57
v_cvt_pk_bf16_f32 v81, v58, v59
v_mfma_f32_32x32x16_bf16 v[88:103], v[24:27], v[72:75], v[88:103]
s_add_u32 s86, s86, 65536
v_exp_f32 v61, v61
v_exp_f32 v62, v62
v_exp_f32 v63, v63
v_exp_f32 v64, v64
v_exp_f32 v65, v65
v_cvt_pk_bf16_f32 v82, v60, v61
v_cvt_pk_bf16_f32 v83, v62, v63
v_mfma_f32_32x32x16_bf16 v[88:103], v[28:31], v[76:79], v[88:103]
v_exp_f32 v66, v66
v_exp_f32 v67, v67
v_cvt_pk_bf16_f32 v84, v64, v65
v_exp_f32 v68, v68
v_exp_f32 v69, v69
v_cvt_pk_bf16_f32 v85, v66, v67
v_exp_f32 v70, v70
v_exp_f32 v71, v71
v_cvt_pk_bf16_f32 v86, v68, v69
v_cvt_pk_bf16_f32 v87, v70, v71
v_mfma_f32_32x32x16_bf16 v[56:71], v[20:23], v[12:15], 0
ds_read_b128 v[16:19], v6 offset:24960
ds_read_b128 v[32:35], v121 offset:22880
ds_read_b128 v[36:39], v122 offset:22880
v_exp_f32 v40, v40
v_exp_f32 v41, v41
v_exp_f32 v42, v42
v_exp_f32 v43, v43
v_exp_f32 v44, v44
v_cvt_pk_bf16_f32 v72, v40, v41
v_cvt_pk_bf16_f32 v73, v42, v43
v_mfma_f32_32x32x16_bf16 v[104:119], v[24:27], v[80:83], v[104:119]
v_exp_f32 v45, v45
v_exp_f32 v46, v46
v_exp_f32 v47, v47
v_exp_f32 v48, v48
v_exp_f32 v49, v49
v_cvt_pk_bf16_f32 v74, v44, v45
v_cvt_pk_bf16_f32 v75, v46, v47
v_mfma_f32_32x32x16_bf16 v[104:119], v[28:31], v[84:87], v[104:119]
v_exp_f32 v50, v50
v_exp_f32 v51, v51
v_cvt_pk_bf16_f32 v76, v48, v49
v_exp_f32 v52, v52
v_exp_f32 v53, v53
v_cvt_pk_bf16_f32 v77, v50, v51
v_exp_f32 v54, v54
v_exp_f32 v55, v55
v_cvt_pk_bf16_f32 v78, v52, v53
v_cvt_pk_bf16_f32 v79, v54, v55
s_waitcnt lgkmcnt(0)
v_mfma_f32_32x32x16_bf16 v[40:55], v[16:19], v[8:11], 0
buffer_load_dwordx4 v[176:179], v138, s[24:27], s86 offen
buffer_load_dwordx4 v[180:183], v139, s[24:27], s86 offen offset:1024
v_exp_f32 v56, v56
v_exp_f32 v57, v57
v_exp_f32 v58, v58
v_exp_f32 v59, v59
v_exp_f32 v60, v60
v_cvt_pk_bf16_f32 v80, v56, v57
v_cvt_pk_bf16_f32 v81, v58, v59
v_mfma_f32_32x32x16_bf16 v[88:103], v[32:35], v[72:75], v[88:103]
s_add_u32 s86, s86, 65536
v_exp_f32 v61, v61
v_exp_f32 v62, v62
v_exp_f32 v63, v63
v_exp_f32 v64, v64
v_exp_f32 v65, v65
v_cvt_pk_bf16_f32 v82, v60, v61
v_cvt_pk_bf16_f32 v83, v62, v63
v_mfma_f32_32x32x16_bf16 v[88:103], v[36:39], v[76:79], v[88:103]
v_exp_f32 v66, v66
v_exp_f32 v67, v67
v_cvt_pk_bf16_f32 v84, v64, v65
v_exp_f32 v68, v68
v_exp_f32 v69, v69
v_cvt_pk_bf16_f32 v85, v66, v67
v_exp_f32 v70, v70
v_exp_f32 v71, v71
v_cvt_pk_bf16_f32 v86, v68, v69
v_cvt_pk_bf16_f32 v87, v70, v71
v_mfma_f32_32x32x16_bf16 v[56:71], v[16:19], v[12:15], 0
ds_read_b128 v[20:23], v6 offset:27040
ds_read_b128 v[24:27], v121 offset:24960
ds_read_b128 v[28:31], v122 offset:24960
v_exp_f32 v40, v40
v_exp_f32 v41, v41
v_exp_f32 v42, v42
v_exp_f32 v43, v43
v_exp_f32 v44, v44
v_cvt_pk_bf16_f32 v72, v40, v41
v_cvt_pk_bf16_f32 v73, v42, v43
v_mfma_f32_32x32x16_bf16 v[104:119], v[32:35], v[80:83], v[104:119]
v_exp_f32 v45, v45
v_exp_f32 v46, v46
v_exp_f32 v47, v47
v_exp_f32 v48, v48
v_exp_f32 v49, v49
v_cvt_pk_bf16_f32 v74, v44, v45
v_cvt_pk_bf16_f32 v75, v46, v47
v_mfma_f32_32x32x16_bf16 v[104:119], v[36:39], v[84:87], v[104:119]
v_exp_f32 v50, v50
v_exp_f32 v51, v51
v_cvt_pk_bf16_f32 v76, v48, v49
v_exp_f32 v52, v52
v_exp_f32 v53, v53
v_cvt_pk_bf16_f32 v77, v50, v51
v_exp_f32 v54, v54
v_exp_f32 v55, v55
v_cvt_pk_bf16_f32 v78, v52, v53
v_cvt_pk_bf16_f32 v79, v54, v55
s_waitcnt lgkmcnt(0)
v_mfma_f32_32x32x16_bf16 v[40:55], v[20:23], v[8:11], 0
buffer_load_dwordx4 v[184:187], v138, s[24:27], s86 offen
buffer_load_dwordx4 v[188:191], v139, s[24:27], s86 offen offset:1024
v_exp_f32 v56, v56
v_exp_f32 v57, v57
v_exp_f32 v58, v58
v_exp_f32 v59, v59
v_exp_f32 v60, v60
v_cvt_pk_bf16_f32 v80, v56, v57
v_cvt_pk_bf16_f32 v81, v58, v59
v_mfma_f32_32x32x16_bf16 v[88:103], v[24:27], v[72:75], v[88:103]
s_add_u32 s86, s86, 65536
v_exp_f32 v61, v61
v_exp_f32 v62, v62
v_exp_f32 v63, v63
v_exp_f32 v64, v64
v_exp_f32 v65, v65
v_cvt_pk_bf16_f32 v82, v60, v61
v_cvt_pk_bf16_f32 v83, v62, v63
v_mfma_f32_32x32x16_bf16 v[88:103], v[28:31], v[76:79], v[88:103]
v_exp_f32 v66, v66
v_exp_f32 v67, v67
v_cvt_pk_bf16_f32 v84, v64, v65
v_exp_f32 v68, v68
v_exp_f32 v69, v69
v_cvt_pk_bf16_f32 v85, v66, v67
v_exp_f32 v70, v70
v_exp_f32 v71, v71
v_cvt_pk_bf16_f32 v86, v68, v69
v_cvt_pk_bf16_f32 v87, v70, v71
v_mfma_f32_32x32x16_bf16 v[56:71], v[20:23], v[12:15], 0
ds_read_b128 v[16:19], v6 offset:29120
ds_read_b128 v[32:35], v121 offset:27040
ds_read_b128 v[36:39], v122 offset:27040
v_exp_f32 v40, v40
v_exp_f32 v41, v41
v_exp_f32 v42, v42
v_exp_f32 v43, v43
v_exp_f32 v44, v44
v_cvt_pk_bf16_f32 v72, v40, v41
v_cvt_pk_bf16_f32 v73, v42, v43
v_mfma_f32_32x32x16_bf16 v[104:119], v[24:27], v[80:83], v[104:119]
v_exp_f32 v45, v45
v_exp_f32 v46, v46
v_exp_f32 v47, v47
v_exp_f32 v48, v48
v_exp_f32 v49, v49
v_cvt_pk_bf16_f32 v74, v44, v45
v_cvt_pk_bf16_f32 v75, v46, v47
v_mfma_f32_32x32x16_bf16 v[104:119], v[28:31], v[84:87], v[104:119]
v_exp_f32 v50, v50
v_exp_f32 v51, v51
v_cvt_pk_bf16_f32 v76, v48, v49
v_exp_f32 v52, v52
v_exp_f32 v53, v53
v_cvt_pk_bf16_f32 v77, v50, v51
v_exp_f32 v54, v54
v_exp_f32 v55, v55
v_cvt_pk_bf16_f32 v78, v52, v53
v_cvt_pk_bf16_f32 v79, v54, v55
s_waitcnt lgkmcnt(0)
v_mfma_f32_32x32x16_bf16 v[40:55], v[16:19], v[8:11], 0
buffer_load_dwordx4 v[192:195], v138, s[24:27], s86 offen
buffer_load_dwordx4 v[196:199], v139, s[24:27], s86 offen offset:1024
v_exp_f32 v56, v56
v_exp_f32 v57, v57
v_exp_f32 v58, v58
v_exp_f32 v59, v59
v_exp_f32 v60, v60
v_cvt_pk_bf16_f32 v80, v56, v57
v_cvt_pk_bf16_f32 v81, v58, v59
v_mfma_f32_32x32x16_bf16 v[88:103], v[32:35], v[72:75], v[88:103]
s_add_u32 s86, s86, 65536
v_exp_f32 v61, v61
v_exp_f32 v62, v62
v_exp_f32 v63, v63
v_exp_f32 v64, v64
v_exp_f32 v65, v65
v_cvt_pk_bf16_f32 v82, v60, v61
v_cvt_pk_bf16_f32 v83, v62, v63
v_mfma_f32_32x32x16_bf16 v[88:103], v[36:39], v[76:79], v[88:103]
v_exp_f32 v66, v66
v_exp_f32 v67, v67
v_cvt_pk_bf16_f32 v84, v64, v65
v_exp_f32 v68, v68
v_exp_f32 v69, v69
v_cvt_pk_bf16_f32 v85, v66, v67
v_exp_f32 v70, v70
v_exp_f32 v71, v71
v_cvt_pk_bf16_f32 v86, v68, v69
v_cvt_pk_bf16_f32 v87, v70, v71
v_mfma_f32_32x32x16_bf16 v[56:71], v[16:19], v[12:15], 0
ds_read_b128 v[20:23], v6 offset:31200
ds_read_b128 v[24:27], v121 offset:29120
ds_read_b128 v[28:31], v122 offset:29120
v_exp_f32 v40, v40
v_exp_f32 v41, v41
v_exp_f32 v42, v42
v_exp_f32 v43, v43
v_exp_f32 v44, v44
v_cvt_pk_bf16_f32 v72, v40, v41
v_cvt_pk_bf16_f32 v73, v42, v43
v_mfma_f32_32x32x16_bf16 v[104:119], v[32:35], v[80:83], v[104:119]
v_exp_f32 v45, v45
v_exp_f32 v46, v46
v_exp_f32 v47, v47
v_exp_f32 v48, v48
v_exp_f32 v49, v49
v_cvt_pk_bf16_f32 v74, v44, v45
v_cvt_pk_bf16_f32 v75, v46, v47
v_mfma_f32_32x32x16_bf16 v[104:119], v[36:39], v[84:87], v[104:119]
v_exp_f32 v50, v50
v_exp_f32 v51, v51
v_cvt_pk_bf16_f32 v76, v48, v49
v_exp_f32 v52, v52
v_exp_f32 v53, v53
v_cvt_pk_bf16_f32 v77, v50, v51
v_exp_f32 v54, v54
v_exp_f32 v55, v55
v_cvt_pk_bf16_f32 v78, v52, v53
v_cvt_pk_bf16_f32 v79, v54, v55
s_waitcnt lgkmcnt(0)
v_mfma_f32_32x32x16_bf16 v[40:55], v[20:23], v[8:11], 0
buffer_load_dwordx4 v[200:203], v138, s[24:27], s86 offen
buffer_load_dwordx4 v[204:207], v139, s[24:27], s86 offen offset:1024
v_exp_f32 v56, v56
v_exp_f32 v57, v57
v_exp_f32 v58, v58
v_exp_f32 v59, v59
v_exp_f32 v60, v60
v_cvt_pk_bf16_f32 v80, v56, v57
v_cvt_pk_bf16_f32 v81, v58, v59
v_mfma_f32_32x32x16_bf16 v[88:103], v[24:27], v[72:75], v[88:103]
s_add_u32 s86, s86, 65536
v_exp_f32 v61, v61
v_exp_f32 v62, v62
v_exp_f32 v63, v63
v_exp_f32 v64, v64
v_exp_f32 v65, v65
v_cvt_pk_bf16_f32 v82, v60, v61
v_cvt_pk_bf16_f32 v83, v62, v63
v_mfma_f32_32x32x16_bf16 v[88:103], v[28:31], v[76:79], v[88:103]
v_exp_f32 v66, v66
v_exp_f32 v67, v67
v_cvt_pk_bf16_f32 v84, v64, v65
v_exp_f32 v68, v68
v_exp_f32 v69, v69
v_cvt_pk_bf16_f32 v85, v66, v67
v_exp_f32 v70, v70
v_exp_f32 v71, v71
v_cvt_pk_bf16_f32 v86, v68, v69
v_cvt_pk_bf16_f32 v87, v70, v71
s_waitcnt vmcnt(36)
s_barrier
v_mfma_f32_32x32x16_bf16 v[56:71], v[20:23], v[12:15], 0
ds_read_b128 v[16:19], v6 offset:33280
ds_read_b128 v[32:35], v121 offset:31200
ds_read_b128 v[36:39], v122 offset:31200
v_exp_f32 v40, v40
v_exp_f32 v41, v41
v_exp_f32 v42, v42
v_exp_f32 v43, v43
v_exp_f32 v44, v44
v_cvt_pk_bf16_f32 v72, v40, v41
v_cvt_pk_bf16_f32 v73, v42, v43
v_mfma_f32_32x32x16_bf16 v[104:119], v[24:27], v[80:83], v[104:119]
v_exp_f32 v45, v45
v_exp_f32 v46, v46
v_exp_f32 v47, v47
v_exp_f32 v48, v48
v_exp_f32 v49, v49
v_cvt_pk_bf16_f32 v74, v44, v45
v_cvt_pk_bf16_f32 v75, v46, v47
v_mfma_f32_32x32x16_bf16 v[104:119], v[28:31], v[84:87], v[104:119]
v_exp_f32 v50, v50
v_exp_f32 v51, v51
v_cvt_pk_bf16_f32 v76, v48, v49
v_exp_f32 v52, v52
v_exp_f32 v53, v53
v_cvt_pk_bf16_f32 v77, v50, v51
v_exp_f32 v54, v54
v_exp_f32 v55, v55
v_cvt_pk_bf16_f32 v78, v52, v53
v_cvt_pk_bf16_f32 v79, v54, v55
s_waitcnt lgkmcnt(0)
v_mfma_f32_32x32x16_bf16 v[40:55], v[16:19], v[8:11], 0
buffer_load_dwordx4 v[208:211], v138, s[24:27], s86 offen
buffer_load_dwordx4 v[212:215], v139, s[24:27], s86 offen offset:1024
v_exp_f32 v56, v56
v_exp_f32 v57, v57
v_exp_f32 v58, v58
v_exp_f32 v59, v59
v_exp_f32 v60, v60
v_cvt_pk_bf16_f32 v80, v56, v57
v_cvt_pk_bf16_f32 v81, v58, v59
v_mfma_f32_32x32x16_bf16 v[88:103], v[32:35], v[72:75], v[88:103]
s_add_u32 s86, s86, 65536
v_exp_f32 v61, v61
v_exp_f32 v62, v62
v_exp_f32 v63, v63
v_exp_f32 v64, v64
v_exp_f32 v65, v65
v_cvt_pk_bf16_f32 v82, v60, v61
v_cvt_pk_bf16_f32 v83, v62, v63
v_mfma_f32_32x32x16_bf16 v[88:103], v[36:39], v[76:79], v[88:103]
v_exp_f32 v66, v66
v_exp_f32 v67, v67
v_cvt_pk_bf16_f32 v84, v64, v65
v_exp_f32 v68, v68
v_exp_f32 v69, v69
v_cvt_pk_bf16_f32 v85, v66, v67
v_exp_f32 v70, v70
v_exp_f32 v71, v71
v_cvt_pk_bf16_f32 v86, v68, v69
v_cvt_pk_bf16_f32 v87, v70, v71
v_mfma_f32_32x32x16_bf16 v[56:71], v[16:19], v[12:15], 0
ds_read_b128 v[20:23], v6 offset:35360
ds_read_b128 v[24:27], v121 offset:33280
ds_read_b128 v[28:31], v122 offset:33280
v_exp_f32 v40, v40
v_exp_f32 v41, v41
v_exp_f32 v42, v42
v_exp_f32 v43, v43
v_exp_f32 v44, v44
v_cvt_pk_bf16_f32 v72, v40, v41
v_cvt_pk_bf16_f32 v73, v42, v43
v_mfma_f32_32x32x16_bf16 v[104:119], v[32:35], v[80:83], v[104:119]
v_exp_f32 v45, v45
v_exp_f32 v46, v46
v_exp_f32 v47, v47
v_exp_f32 v48, v48
v_exp_f32 v49, v49
v_cvt_pk_bf16_f32 v74, v44, v45
v_cvt_pk_bf16_f32 v75, v46, v47
v_mfma_f32_32x32x16_bf16 v[104:119], v[36:39], v[84:87], v[104:119]
v_exp_f32 v50, v50
v_exp_f32 v51, v51
v_cvt_pk_bf16_f32 v76, v48, v49
v_exp_f32 v52, v52
v_exp_f32 v53, v53
v_cvt_pk_bf16_f32 v77, v50, v51
v_exp_f32 v54, v54
v_exp_f32 v55, v55
v_cvt_pk_bf16_f32 v78, v52, v53
v_cvt_pk_bf16_f32 v79, v54, v55
s_waitcnt lgkmcnt(0)
v_mfma_f32_32x32x16_bf16 v[40:55], v[20:23], v[8:11], 0
buffer_load_dwordx4 v[216:219], v138, s[24:27], s86 offen
buffer_load_dwordx4 v[220:223], v139, s[24:27], s86 offen offset:1024
v_exp_f32 v56, v56
v_exp_f32 v57, v57
v_exp_f32 v58, v58
v_exp_f32 v59, v59
v_exp_f32 v60, v60
v_cvt_pk_bf16_f32 v80, v56, v57
v_cvt_pk_bf16_f32 v81, v58, v59
v_mfma_f32_32x32x16_bf16 v[88:103], v[24:27], v[72:75], v[88:103]
s_add_u32 s86, s86, 65536
v_exp_f32 v61, v61
v_exp_f32 v62, v62
v_exp_f32 v63, v63
v_exp_f32 v64, v64
v_exp_f32 v65, v65
v_cvt_pk_bf16_f32 v82, v60, v61
v_cvt_pk_bf16_f32 v83, v62, v63
v_mfma_f32_32x32x16_bf16 v[88:103], v[28:31], v[76:79], v[88:103]
v_exp_f32 v66, v66
v_exp_f32 v67, v67
v_cvt_pk_bf16_f32 v84, v64, v65
v_exp_f32 v68, v68
v_exp_f32 v69, v69
v_cvt_pk_bf16_f32 v85, v66, v67
v_exp_f32 v70, v70
v_exp_f32 v71, v71
v_cvt_pk_bf16_f32 v86, v68, v69
v_cvt_pk_bf16_f32 v87, v70, v71
v_mfma_f32_32x32x16_bf16 v[56:71], v[20:23], v[12:15], 0
ds_read_b128 v[16:19], v6 offset:37440
ds_read_b128 v[32:35], v121 offset:35360
ds_read_b128 v[36:39], v122 offset:35360
v_exp_f32 v40, v40
v_exp_f32 v41, v41
v_exp_f32 v42, v42
v_exp_f32 v43, v43
v_exp_f32 v44, v44
v_cvt_pk_bf16_f32 v72, v40, v41
v_cvt_pk_bf16_f32 v73, v42, v43
v_mfma_f32_32x32x16_bf16 v[104:119], v[24:27], v[80:83], v[104:119]
v_exp_f32 v45, v45
v_exp_f32 v46, v46
v_exp_f32 v47, v47
v_exp_f32 v48, v48
v_exp_f32 v49, v49
v_cvt_pk_bf16_f32 v74, v44, v45
v_cvt_pk_bf16_f32 v75, v46, v47
v_mfma_f32_32x32x16_bf16 v[104:119], v[28:31], v[84:87], v[104:119]
v_exp_f32 v50, v50
v_exp_f32 v51, v51
v_cvt_pk_bf16_f32 v76, v48, v49
v_exp_f32 v52, v52
v_exp_f32 v53, v53
v_cvt_pk_bf16_f32 v77, v50, v51
v_exp_f32 v54, v54
v_exp_f32 v55, v55
v_cvt_pk_bf16_f32 v78, v52, v53
v_cvt_pk_bf16_f32 v79, v54, v55
s_waitcnt lgkmcnt(0)
v_mfma_f32_32x32x16_bf16 v[40:55], v[16:19], v[8:11], 0
buffer_load_dwordx4 v[224:227], v138, s[24:27], s86 offen
buffer_load_dwordx4 v[228:231], v139, s[24:27], s86 offen offset:1024
v_exp_f32 v56, v56
v_exp_f32 v57, v57
v_exp_f32 v58, v58
v_exp_f32 v59, v59
v_exp_f32 v60, v60
v_cvt_pk_bf16_f32 v80, v56, v57
v_cvt_pk_bf16_f32 v81, v58, v59
v_mfma_f32_32x32x16_bf16 v[88:103], v[32:35], v[72:75], v[88:103]
s_add_u32 s86, s86, 65536
v_exp_f32 v61, v61
v_exp_f32 v62, v62
v_exp_f32 v63, v63
v_exp_f32 v64, v64
v_exp_f32 v65, v65
v_cvt_pk_bf16_f32 v82, v60, v61
v_cvt_pk_bf16_f32 v83, v62, v63
v_mfma_f32_32x32x16_bf16 v[88:103], v[36:39], v[76:79], v[88:103]
v_exp_f32 v66, v66
v_exp_f32 v67, v67
v_cvt_pk_bf16_f32 v84, v64, v65
v_exp_f32 v68, v68
v_exp_f32 v69, v69
v_cvt_pk_bf16_f32 v85, v66, v67
v_exp_f32 v70, v70
v_exp_f32 v71, v71
v_cvt_pk_bf16_f32 v86, v68, v69
v_cvt_pk_bf16_f32 v87, v70, v71
v_mfma_f32_32x32x16_bf16 v[56:71], v[16:19], v[12:15], 0
ds_read_b128 v[20:23], v6 offset:39520
ds_read_b128 v[24:27], v121 offset:37440
ds_read_b128 v[28:31], v122 offset:37440
v_exp_f32 v40, v40
v_exp_f32 v41, v41
v_exp_f32 v42, v42
v_exp_f32 v43, v43
v_exp_f32 v44, v44
v_cvt_pk_bf16_f32 v72, v40, v41
v_cvt_pk_bf16_f32 v73, v42, v43
v_mfma_f32_32x32x16_bf16 v[104:119], v[32:35], v[80:83], v[104:119]
v_exp_f32 v45, v45
v_exp_f32 v46, v46
v_exp_f32 v47, v47
v_exp_f32 v48, v48
v_exp_f32 v49, v49
v_cvt_pk_bf16_f32 v74, v44, v45
v_cvt_pk_bf16_f32 v75, v46, v47
v_mfma_f32_32x32x16_bf16 v[104:119], v[36:39], v[84:87], v[104:119]
v_exp_f32 v50, v50
v_exp_f32 v51, v51
v_cvt_pk_bf16_f32 v76, v48, v49
v_exp_f32 v52, v52
v_exp_f32 v53, v53
v_cvt_pk_bf16_f32 v77, v50, v51
v_exp_f32 v54, v54
v_exp_f32 v55, v55
v_cvt_pk_bf16_f32 v78, v52, v53
v_cvt_pk_bf16_f32 v79, v54, v55
s_waitcnt lgkmcnt(0)
v_mfma_f32_32x32x16_bf16 v[40:55], v[20:23], v[8:11], 0
buffer_load_dwordx4 v[232:235], v138, s[24:27], s86 offen
buffer_load_dwordx4 v[236:239], v139, s[24:27], s86 offen offset:1024
v_exp_f32 v56, v56
v_exp_f32 v57, v57
v_exp_f32 v58, v58
v_exp_f32 v59, v59
v_exp_f32 v60, v60
v_cvt_pk_bf16_f32 v80, v56, v57
v_cvt_pk_bf16_f32 v81, v58, v59
v_mfma_f32_32x32x16_bf16 v[88:103], v[24:27], v[72:75], v[88:103]
s_add_u32 s86, s86, 65536
v_exp_f32 v61, v61
v_exp_f32 v62, v62
v_exp_f32 v63, v63
v_exp_f32 v64, v64
v_exp_f32 v65, v65
v_cvt_pk_bf16_f32 v82, v60, v61
v_cvt_pk_bf16_f32 v83, v62, v63
v_mfma_f32_32x32x16_bf16 v[88:103], v[28:31], v[76:79], v[88:103]
v_exp_f32 v66, v66
v_exp_f32 v67, v67
v_cvt_pk_bf16_f32 v84, v64, v65
v_exp_f32 v68, v68
v_exp_f32 v69, v69
v_cvt_pk_bf16_f32 v85, v66, v67
v_exp_f32 v70, v70
v_exp_f32 v71, v71
v_cvt_pk_bf16_f32 v86, v68, v69
v_cvt_pk_bf16_f32 v87, v70, v71
v_mfma_f32_32x32x16_bf16 v[56:71], v[20:23], v[12:15], 0
ds_read_b128 v[16:19], v6 offset:41600
ds_read_b128 v[32:35], v121 offset:39520
ds_read_b128 v[36:39], v122 offset:39520
v_exp_f32 v40, v40
v_exp_f32 v41, v41
v_exp_f32 v42, v42
v_exp_f32 v43, v43
v_exp_f32 v44, v44
v_cvt_pk_bf16_f32 v72, v40, v41
v_cvt_pk_bf16_f32 v73, v42, v43
v_mfma_f32_32x32x16_bf16 v[104:119], v[24:27], v[80:83], v[104:119]
v_exp_f32 v45, v45
v_exp_f32 v46, v46
v_exp_f32 v47, v47
v_exp_f32 v48, v48
v_exp_f32 v49, v49
v_cvt_pk_bf16_f32 v74, v44, v45
v_cvt_pk_bf16_f32 v75, v46, v47
v_mfma_f32_32x32x16_bf16 v[104:119], v[28:31], v[84:87], v[104:119]
v_exp_f32 v50, v50
v_exp_f32 v51, v51
v_cvt_pk_bf16_f32 v76, v48, v49
v_exp_f32 v52, v52
v_exp_f32 v53, v53
v_cvt_pk_bf16_f32 v77, v50, v51
v_exp_f32 v54, v54
v_exp_f32 v55, v55
v_cvt_pk_bf16_f32 v78, v52, v53
v_cvt_pk_bf16_f32 v79, v54, v55
s_waitcnt lgkmcnt(0)
v_mfma_f32_32x32x16_bf16 v[40:55], v[16:19], v[8:11], 0
buffer_load_dwordx4 v[240:243], v138, s[24:27], s86 offen
buffer_load_dwordx4 v[244:247], v139, s[24:27], s86 offen offset:1024
v_exp_f32 v56, v56
v_exp_f32 v57, v57
v_exp_f32 v58, v58
v_exp_f32 v59, v59
v_exp_f32 v60, v60
v_cvt_pk_bf16_f32 v80, v56, v57
v_cvt_pk_bf16_f32 v81, v58, v59
v_mfma_f32_32x32x16_bf16 v[88:103], v[32:35], v[72:75], v[88:103]
s_add_u32 s86, s86, 65536
v_exp_f32 v61, v61
v_exp_f32 v62, v62
v_exp_f32 v63, v63
v_exp_f32 v64, v64
v_exp_f32 v65, v65
v_cvt_pk_bf16_f32 v82, v60, v61
v_cvt_pk_bf16_f32 v83, v62, v63
v_mfma_f32_32x32x16_bf16 v[88:103], v[36:39], v[76:79], v[88:103]
v_exp_f32 v66, v66
v_exp_f32 v67, v67
v_cvt_pk_bf16_f32 v84, v64, v65
v_exp_f32 v68, v68
v_exp_f32 v69, v69
v_cvt_pk_bf16_f32 v85, v66, v67
v_exp_f32 v70, v70
v_exp_f32 v71, v71
v_cvt_pk_bf16_f32 v86, v68, v69
v_cvt_pk_bf16_f32 v87, v70, v71
v_mfma_f32_32x32x16_bf16 v[56:71], v[16:19], v[12:15], 0
ds_read_b128 v[20:23], v6 offset:43680
ds_read_b128 v[24:27], v121 offset:41600
ds_read_b128 v[28:31], v122 offset:41600
v_exp_f32 v40, v40
v_exp_f32 v41, v41
v_exp_f32 v42, v42
v_exp_f32 v43, v43
v_exp_f32 v44, v44
v_cvt_pk_bf16_f32 v72, v40, v41
v_cvt_pk_bf16_f32 v73, v42, v43
v_mfma_f32_32x32x16_bf16 v[104:119], v[32:35], v[80:83], v[104:119]
v_exp_f32 v45, v45
v_exp_f32 v46, v46
v_exp_f32 v47, v47
v_exp_f32 v48, v48
v_exp_f32 v49, v49
v_cvt_pk_bf16_f32 v74, v44, v45
v_cvt_pk_bf16_f32 v75, v46, v47
v_mfma_f32_32x32x16_bf16 v[104:119], v[36:39], v[84:87], v[104:119]
v_exp_f32 v50, v50
v_exp_f32 v51, v51
v_cvt_pk_bf16_f32 v76, v48, v49
v_exp_f32 v52, v52
v_exp_f32 v53, v53
v_cvt_pk_bf16_f32 v77, v50, v51
v_exp_f32 v54, v54
v_exp_f32 v55, v55
v_cvt_pk_bf16_f32 v78, v52, v53
v_cvt_pk_bf16_f32 v79, v54, v55
s_waitcnt lgkmcnt(0)
v_mfma_f32_32x32x16_bf16 v[40:55], v[20:23], v[8:11], 0
buffer_load_dwordx4 v[248:251], v138, s[24:27], s86 offen
buffer_load_dwordx4 v[252:255], v139, s[24:27], s86 offen offset:1024
v_exp_f32 v56, v56
v_exp_f32 v57, v57
v_exp_f32 v58, v58
v_exp_f32 v59, v59
v_exp_f32 v60, v60
v_cvt_pk_bf16_f32 v80, v56, v57
v_cvt_pk_bf16_f32 v81, v58, v59
v_mfma_f32_32x32x16_bf16 v[88:103], v[24:27], v[72:75], v[88:103]
s_add_u32 s86, s86, 65536
v_exp_f32 v61, v61
v_exp_f32 v62, v62
v_exp_f32 v63, v63
v_exp_f32 v64, v64
v_exp_f32 v65, v65
v_cvt_pk_bf16_f32 v82, v60, v61
v_cvt_pk_bf16_f32 v83, v62, v63
v_mfma_f32_32x32x16_bf16 v[88:103], v[28:31], v[76:79], v[88:103]
v_exp_f32 v66, v66
v_exp_f32 v67, v67
v_cvt_pk_bf16_f32 v84, v64, v65
v_exp_f32 v68, v68
v_exp_f32 v69, v69
v_cvt_pk_bf16_f32 v85, v66, v67
v_exp_f32 v70, v70
v_exp_f32 v71, v71
v_cvt_pk_bf16_f32 v86, v68, v69
v_cvt_pk_bf16_f32 v87, v70, v71
v_mfma_f32_32x32x16_bf16 v[56:71], v[20:23], v[12:15], 0
ds_read_b128 v[16:19], v6 offset:45760
ds_read_b128 v[32:35], v121 offset:43680
ds_read_b128 v[36:39], v122 offset:43680
v_exp_f32 v40, v40
v_exp_f32 v41, v41
v_exp_f32 v42, v42
v_exp_f32 v43, v43
v_exp_f32 v44, v44
v_cvt_pk_bf16_f32 v72, v40, v41
v_cvt_pk_bf16_f32 v73, v42, v43
v_mfma_f32_32x32x16_bf16 v[104:119], v[24:27], v[80:83], v[104:119]
v_exp_f32 v45, v45
v_exp_f32 v46, v46
v_exp_f32 v47, v47
v_exp_f32 v48, v48
v_exp_f32 v49, v49
v_cvt_pk_bf16_f32 v74, v44, v45
v_cvt_pk_bf16_f32 v75, v46, v47
v_mfma_f32_32x32x16_bf16 v[104:119], v[28:31], v[84:87], v[104:119]
s_mul_i32 s87, s3, 6144
s_add_u32 m0, s87, 132096
v_exp_f32 v50, v50
v_exp_f32 v51, v51
v_cvt_pk_bf16_f32 v76, v48, v49
v_exp_f32 v52, v52
v_exp_f32 v53, v53
v_cvt_pk_bf16_f32 v77, v50, v51
v_exp_f32 v54, v54
v_exp_f32 v55, v55
v_cvt_pk_bf16_f32 v78, v52, v53
v_cvt_pk_bf16_f32 v79, v54, v55
s_waitcnt lgkmcnt(0)
v_mfma_f32_32x32x16_bf16 v[40:55], v[16:19], v[8:11], 0
buffer_load_dwordx4 v138, s[24:27], s86 offen lds
buffer_load_dwordx4 v139, s[24:27], s86 offen offset:1024 lds
v_exp_f32 v56, v56
v_exp_f32 v57, v57
v_exp_f32 v58, v58
v_exp_f32 v59, v59
v_exp_f32 v60, v60
v_cvt_pk_bf16_f32 v80, v56, v57
v_cvt_pk_bf16_f32 v81, v58, v59
v_mfma_f32_32x32x16_bf16 v[88:103], v[32:35], v[72:75], v[88:103]
s_add_u32 s86, s86, 65536
v_exp_f32 v61, v61
v_exp_f32 v62, v62
v_exp_f32 v63, v63
v_exp_f32 v64, v64
v_exp_f32 v65, v65
v_cvt_pk_bf16_f32 v82, v60, v61
v_cvt_pk_bf16_f32 v83, v62, v63
v_mfma_f32_32x32x16_bf16 v[88:103], v[36:39], v[76:79], v[88:103]
v_exp_f32 v66, v66
v_exp_f32 v67, v67
v_cvt_pk_bf16_f32 v84, v64, v65
v_exp_f32 v68, v68
v_exp_f32 v69, v69
v_cvt_pk_bf16_f32 v85, v66, v67
v_exp_f32 v70, v70
v_exp_f32 v71, v71
v_cvt_pk_bf16_f32 v86, v68, v69
v_cvt_pk_bf16_f32 v87, v70, v71
v_mfma_f32_32x32x16_bf16 v[56:71], v[16:19], v[12:15], 0
ds_read_b128 v[20:23], v6 offset:47840
ds_read_b128 v[24:27], v121 offset:45760
ds_read_b128 v[28:31], v122 offset:45760
v_exp_f32 v40, v40
v_exp_f32 v41, v41
v_exp_f32 v42, v42
v_exp_f32 v43, v43
v_exp_f32 v44, v44
v_cvt_pk_bf16_f32 v72, v40, v41
v_cvt_pk_bf16_f32 v73, v42, v43
v_mfma_f32_32x32x16_bf16 v[104:119], v[32:35], v[80:83], v[104:119]
v_exp_f32 v45, v45
v_exp_f32 v46, v46
v_exp_f32 v47, v47
v_exp_f32 v48, v48
v_exp_f32 v49, v49
v_cvt_pk_bf16_f32 v74, v44, v45
v_cvt_pk_bf16_f32 v75, v46, v47
v_mfma_f32_32x32x16_bf16 v[104:119], v[36:39], v[84:87], v[104:119]
s_add_u32 m0, s87, 134144
v_exp_f32 v50, v50
v_exp_f32 v51, v51
v_cvt_pk_bf16_f32 v76, v48, v49
v_exp_f32 v52, v52
v_exp_f32 v53, v53
v_cvt_pk_bf16_f32 v77, v50, v51
v_exp_f32 v54, v54
v_exp_f32 v55, v55
v_cvt_pk_bf16_f32 v78, v52, v53
v_cvt_pk_bf16_f32 v79, v54, v55
s_waitcnt lgkmcnt(0)
v_mfma_f32_32x32x16_bf16 v[40:55], v[20:23], v[8:11], 0
buffer_load_dwordx4 v138, s[24:27], s86 offen lds
buffer_load_dwordx4 v139, s[24:27], s86 offen offset:1024 lds
v_exp_f32 v56, v56
v_exp_f32 v57, v57
v_exp_f32 v58, v58
v_exp_f32 v59, v59
v_exp_f32 v60, v60
v_cvt_pk_bf16_f32 v80, v56, v57
v_cvt_pk_bf16_f32 v81, v58, v59
v_mfma_f32_32x32x16_bf16 v[88:103], v[24:27], v[72:75], v[88:103]
s_add_u32 s86, s86, 65536
v_exp_f32 v61, v61
v_exp_f32 v62, v62
v_exp_f32 v63, v63
v_exp_f32 v64, v64
v_exp_f32 v65, v65
v_cvt_pk_bf16_f32 v82, v60, v61
v_cvt_pk_bf16_f32 v83, v62, v63
v_mfma_f32_32x32x16_bf16 v[88:103], v[28:31], v[76:79], v[88:103]
v_exp_f32 v66, v66
v_exp_f32 v67, v67
v_cvt_pk_bf16_f32 v84, v64, v65
v_exp_f32 v68, v68
v_exp_f32 v69, v69
v_cvt_pk_bf16_f32 v85, v66, v67
v_exp_f32 v70, v70
v_exp_f32 v71, v71
v_cvt_pk_bf16_f32 v86, v68, v69
v_cvt_pk_bf16_f32 v87, v70, v71
s_waitcnt vmcnt(32)
s_barrier
v_mfma_f32_32x32x16_bf16 v[56:71], v[20:23], v[12:15], 0
ds_read_b128 v[16:19], v6 offset:49920
ds_read_b128 v[32:35], v121 offset:47840
ds_read_b128 v[36:39], v122 offset:47840
v_exp_f32 v40, v40
v_exp_f32 v41, v41
v_exp_f32 v42, v42
v_exp_f32 v43, v43
v_exp_f32 v44, v44
v_cvt_pk_bf16_f32 v72, v40, v41
v_cvt_pk_bf16_f32 v73, v42, v43
v_mfma_f32_32x32x16_bf16 v[104:119], v[24:27], v[80:83], v[104:119]
v_exp_f32 v45, v45
v_exp_f32 v46, v46
v_exp_f32 v47, v47
v_exp_f32 v48, v48
v_exp_f32 v49, v49
v_cvt_pk_bf16_f32 v74, v44, v45
v_cvt_pk_bf16_f32 v75, v46, v47
v_mfma_f32_32x32x16_bf16 v[104:119], v[28:31], v[84:87], v[104:119]
s_add_u32 m0, s87, 136192
v_exp_f32 v50, v50
v_exp_f32 v51, v51
v_cvt_pk_bf16_f32 v76, v48, v49
v_exp_f32 v52, v52
v_exp_f32 v53, v53
v_cvt_pk_bf16_f32 v77, v50, v51
v_exp_f32 v54, v54
v_exp_f32 v55, v55
v_cvt_pk_bf16_f32 v78, v52, v53
v_cvt_pk_bf16_f32 v79, v54, v55
s_waitcnt lgkmcnt(0)
v_mfma_f32_32x32x16_bf16 v[40:55], v[16:19], v[8:11], 0
buffer_load_dwordx4 v138, s[24:27], s86 offen lds
buffer_load_dwordx4 v139, s[24:27], s86 offen offset:1024 lds
v_exp_f32 v56, v56
v_exp_f32 v57, v57
v_exp_f32 v58, v58
v_exp_f32 v59, v59
v_exp_f32 v60, v60
v_cvt_pk_bf16_f32 v80, v56, v57
v_cvt_pk_bf16_f32 v81, v58, v59
v_mfma_f32_32x32x16_bf16 v[88:103], v[32:35], v[72:75], v[88:103]
s_add_u32 s86, s86, 65536
v_exp_f32 v61, v61
v_exp_f32 v62, v62
v_exp_f32 v63, v63
v_exp_f32 v64, v64
v_exp_f32 v65, v65
v_cvt_pk_bf16_f32 v82, v60, v61
v_cvt_pk_bf16_f32 v83, v62, v63
v_mfma_f32_32x32x16_bf16 v[88:103], v[36:39], v[76:79], v[88:103]
v_exp_f32 v66, v66
v_exp_f32 v67, v67
v_cvt_pk_bf16_f32 v84, v64, v65
v_exp_f32 v68, v68
v_exp_f32 v69, v69
v_cvt_pk_bf16_f32 v85, v66, v67
v_exp_f32 v70, v70
v_exp_f32 v71, v71
v_cvt_pk_bf16_f32 v86, v68, v69
v_cvt_pk_bf16_f32 v87, v70, v71
v_mfma_f32_32x32x16_bf16 v[56:71], v[16:19], v[12:15], 0
ds_read_b128 v[20:23], v6 offset:52000
ds_read_b128 v[24:27], v121 offset:49920
ds_read_b128 v[28:31], v122 offset:49920
v_exp_f32 v40, v40
v_exp_f32 v41, v41
v_exp_f32 v42, v42
v_exp_f32 v43, v43
v_exp_f32 v44, v44
v_cvt_pk_bf16_f32 v72, v40, v41
v_cvt_pk_bf16_f32 v73, v42, v43
v_mfma_f32_32x32x16_bf16 v[104:119], v[32:35], v[80:83], v[104:119]
v_exp_f32 v45, v45
v_exp_f32 v46, v46
v_exp_f32 v47, v47
v_exp_f32 v48, v48
v_exp_f32 v49, v49
v_cvt_pk_bf16_f32 v74, v44, v45
v_cvt_pk_bf16_f32 v75, v46, v47
v_mfma_f32_32x32x16_bf16 v[104:119], v[36:39], v[84:87], v[104:119]
s_lshl_b32 s87, s3, 12
s_add_u32 m0, s87, 0
v_exp_f32 v50, v50
v_exp_f32 v51, v51
v_cvt_pk_bf16_f32 v76, v48, v49
v_exp_f32 v52, v52
v_exp_f32 v53, v53
v_cvt_pk_bf16_f32 v77, v50, v51
v_exp_f32 v54, v54
v_exp_f32 v55, v55
v_cvt_pk_bf16_f32 v78, v52, v53
v_cvt_pk_bf16_f32 v79, v54, v55
s_waitcnt lgkmcnt(0)
v_mfma_f32_32x32x16_bf16 v[40:55], v[20:23], v[8:11], 0
buffer_load_dwordx4 v138, s[24:27], s86 offen lds
buffer_load_dwordx4 v139, s[24:27], s86 offen offset:1024 lds
v_exp_f32 v56, v56
v_exp_f32 v57, v57
v_exp_f32 v58, v58
v_exp_f32 v59, v59
v_exp_f32 v60, v60
v_cvt_pk_bf16_f32 v80, v56, v57
v_cvt_pk_bf16_f32 v81, v58, v59
v_mfma_f32_32x32x16_bf16 v[88:103], v[24:27], v[72:75], v[88:103]
s_add_u32 s86, s86, 65536
v_exp_f32 v61, v61
v_exp_f32 v62, v62
v_exp_f32 v63, v63
v_exp_f32 v64, v64
v_exp_f32 v65, v65
v_cvt_pk_bf16_f32 v82, v60, v61
v_cvt_pk_bf16_f32 v83, v62, v63
v_mfma_f32_32x32x16_bf16 v[88:103], v[28:31], v[76:79], v[88:103]
v_exp_f32 v66, v66
v_exp_f32 v67, v67
v_cvt_pk_bf16_f32 v84, v64, v65
v_exp_f32 v68, v68
v_exp_f32 v69, v69
v_cvt_pk_bf16_f32 v85, v66, v67
v_exp_f32 v70, v70
v_exp_f32 v71, v71
v_cvt_pk_bf16_f32 v86, v68, v69
v_cvt_pk_bf16_f32 v87, v70, v71
v_mfma_f32_32x32x16_bf16 v[56:71], v[20:23], v[12:15], 0
ds_read_b128 v[16:19], v6 offset:54080
ds_read_b128 v[32:35], v121 offset:52000
ds_read_b128 v[36:39], v122 offset:52000
v_exp_f32 v40, v40
v_exp_f32 v41, v41
v_exp_f32 v42, v42
v_exp_f32 v43, v43
v_exp_f32 v44, v44
v_cvt_pk_bf16_f32 v72, v40, v41
v_cvt_pk_bf16_f32 v73, v42, v43
v_mfma_f32_32x32x16_bf16 v[104:119], v[24:27], v[80:83], v[104:119]
v_exp_f32 v45, v45
v_exp_f32 v46, v46
v_exp_f32 v47, v47
v_exp_f32 v48, v48
v_exp_f32 v49, v49
v_cvt_pk_bf16_f32 v74, v44, v45
v_cvt_pk_bf16_f32 v75, v46, v47
v_mfma_f32_32x32x16_bf16 v[104:119], v[28:31], v[84:87], v[104:119]
s_add_u32 m0, s87, 2048
v_exp_f32 v50, v50
v_exp_f32 v51, v51
v_cvt_pk_bf16_f32 v76, v48, v49
v_exp_f32 v52, v52
v_exp_f32 v53, v53
v_cvt_pk_bf16_f32 v77, v50, v51
v_exp_f32 v54, v54
v_exp_f32 v55, v55
v_cvt_pk_bf16_f32 v78, v52, v53
v_cvt_pk_bf16_f32 v79, v54, v55
s_waitcnt lgkmcnt(0)
v_mfma_f32_32x32x16_bf16 v[40:55], v[16:19], v[8:11], 0
buffer_load_dwordx4 v138, s[24:27], s86 offen lds
buffer_load_dwordx4 v139, s[24:27], s86 offen offset:1024 lds
v_exp_f32 v56, v56
v_exp_f32 v57, v57
v_exp_f32 v58, v58
v_exp_f32 v59, v59
v_exp_f32 v60, v60
v_cvt_pk_bf16_f32 v80, v56, v57
v_cvt_pk_bf16_f32 v81, v58, v59
v_mfma_f32_32x32x16_bf16 v[88:103], v[32:35], v[72:75], v[88:103]
s_add_u32 s86, s86, 65536
v_exp_f32 v61, v61
v_exp_f32 v62, v62
v_exp_f32 v63, v63
v_exp_f32 v64, v64
v_exp_f32 v65, v65
v_cvt_pk_bf16_f32 v82, v60, v61
v_cvt_pk_bf16_f32 v83, v62, v63
v_mfma_f32_32x32x16_bf16 v[88:103], v[36:39], v[76:79], v[88:103]
v_exp_f32 v66, v66
v_exp_f32 v67, v67
v_cvt_pk_bf16_f32 v84, v64, v65
v_exp_f32 v68, v68
v_exp_f32 v69, v69
v_cvt_pk_bf16_f32 v85, v66, v67
v_exp_f32 v70, v70
v_exp_f32 v71, v71
v_cvt_pk_bf16_f32 v86, v68, v69
v_cvt_pk_bf16_f32 v87, v70, v71
v_mfma_f32_32x32x16_bf16 v[56:71], v[16:19], v[12:15], 0
ds_read_b128 v[20:23], v6 offset:56160
ds_read_b128 v[24:27], v121 offset:54080
ds_read_b128 v[28:31], v122 offset:54080
v_exp_f32 v40, v40
v_exp_f32 v41, v41
v_exp_f32 v42, v42
v_exp_f32 v43, v43
v_exp_f32 v44, v44
v_cvt_pk_bf16_f32 v72, v40, v41
v_cvt_pk_bf16_f32 v73, v42, v43
v_mfma_f32_32x32x16_bf16 v[104:119], v[32:35], v[80:83], v[104:119]
v_exp_f32 v45, v45
v_exp_f32 v46, v46
v_exp_f32 v47, v47
v_exp_f32 v48, v48
v_exp_f32 v49, v49
v_cvt_pk_bf16_f32 v74, v44, v45
v_cvt_pk_bf16_f32 v75, v46, v47
v_mfma_f32_32x32x16_bf16 v[104:119], v[36:39], v[84:87], v[104:119]
s_add_u32 m0, s87, 16640
v_exp_f32 v50, v50
v_exp_f32 v51, v51
v_cvt_pk_bf16_f32 v76, v48, v49
v_exp_f32 v52, v52
v_exp_f32 v53, v53
v_cvt_pk_bf16_f32 v77, v50, v51
v_exp_f32 v54, v54
v_exp_f32 v55, v55
v_cvt_pk_bf16_f32 v78, v52, v53
v_cvt_pk_bf16_f32 v79, v54, v55
s_waitcnt lgkmcnt(0)
v_mfma_f32_32x32x16_bf16 v[40:55], v[20:23], v[8:11], 0
buffer_load_dwordx4 v138, s[24:27], s86 offen lds
buffer_load_dwordx4 v139, s[24:27], s86 offen offset:1024 lds
v_exp_f32 v56, v56
v_exp_f32 v57, v57
v_exp_f32 v58, v58
v_exp_f32 v59, v59
v_exp_f32 v60, v60
v_cvt_pk_bf16_f32 v80, v56, v57
v_cvt_pk_bf16_f32 v81, v58, v59
v_mfma_f32_32x32x16_bf16 v[88:103], v[24:27], v[72:75], v[88:103]
s_add_u32 s86, s86, 65536
v_exp_f32 v61, v61
v_exp_f32 v62, v62
v_exp_f32 v63, v63
v_exp_f32 v64, v64
v_exp_f32 v65, v65
v_cvt_pk_bf16_f32 v82, v60, v61
v_cvt_pk_bf16_f32 v83, v62, v63
v_mfma_f32_32x32x16_bf16 v[88:103], v[28:31], v[76:79], v[88:103]
v_exp_f32 v66, v66
v_exp_f32 v67, v67
v_cvt_pk_bf16_f32 v84, v64, v65
v_exp_f32 v68, v68
v_exp_f32 v69, v69
v_cvt_pk_bf16_f32 v85, v66, v67
v_exp_f32 v70, v70
v_exp_f32 v71, v71
v_cvt_pk_bf16_f32 v86, v68, v69
v_cvt_pk_bf16_f32 v87, v70, v71
v_mfma_f32_32x32x16_bf16 v[56:71], v[20:23], v[12:15], 0
ds_read_b128 v[16:19], v6 offset:58240
ds_read_b128 v[32:35], v121 offset:56160
ds_read_b128 v[36:39], v122 offset:56160
v_exp_f32 v40, v40
v_exp_f32 v41, v41
v_exp_f32 v42, v42
v_exp_f32 v43, v43
v_exp_f32 v44, v44
v_cvt_pk_bf16_f32 v72, v40, v41
v_cvt_pk_bf16_f32 v73, v42, v43
v_mfma_f32_32x32x16_bf16 v[104:119], v[24:27], v[80:83], v[104:119]
v_exp_f32 v45, v45
v_exp_f32 v46, v46
v_exp_f32 v47, v47
v_exp_f32 v48, v48
v_exp_f32 v49, v49
v_cvt_pk_bf16_f32 v74, v44, v45
v_cvt_pk_bf16_f32 v75, v46, v47
v_mfma_f32_32x32x16_bf16 v[104:119], v[28:31], v[84:87], v[104:119]
s_add_u32 m0, s87, 18688
v_exp_f32 v50, v50
v_exp_f32 v51, v51
v_cvt_pk_bf16_f32 v76, v48, v49
v_exp_f32 v52, v52
v_exp_f32 v53, v53
v_cvt_pk_bf16_f32 v77, v50, v51
v_exp_f32 v54, v54
v_exp_f32 v55, v55
v_cvt_pk_bf16_f32 v78, v52, v53
v_cvt_pk_bf16_f32 v79, v54, v55
s_waitcnt lgkmcnt(0)
v_mfma_f32_32x32x16_bf16 v[40:55], v[16:19], v[8:11], 0
buffer_load_dwordx4 v138, s[24:27], s86 offen lds
buffer_load_dwordx4 v139, s[24:27], s86 offen offset:1024 lds
v_exp_f32 v56, v56
v_exp_f32 v57, v57
v_exp_f32 v58, v58
v_exp_f32 v59, v59
v_exp_f32 v60, v60
v_cvt_pk_bf16_f32 v80, v56, v57
v_cvt_pk_bf16_f32 v81, v58, v59
v_mfma_f32_32x32x16_bf16 v[88:103], v[32:35], v[72:75], v[88:103]
s_add_u32 s86, s86, 65536
v_exp_f32 v61, v61
v_exp_f32 v62, v62
v_exp_f32 v63, v63
v_exp_f32 v64, v64
v_exp_f32 v65, v65
v_cvt_pk_bf16_f32 v82, v60, v61
v_cvt_pk_bf16_f32 v83, v62, v63
v_mfma_f32_32x32x16_bf16 v[88:103], v[36:39], v[76:79], v[88:103]
v_exp_f32 v66, v66
v_exp_f32 v67, v67
v_cvt_pk_bf16_f32 v84, v64, v65
v_exp_f32 v68, v68
v_exp_f32 v69, v69
v_cvt_pk_bf16_f32 v85, v66, v67
v_exp_f32 v70, v70
v_exp_f32 v71, v71
v_cvt_pk_bf16_f32 v86, v68, v69
v_cvt_pk_bf16_f32 v87, v70, v71
v_mfma_f32_32x32x16_bf16 v[56:71], v[16:19], v[12:15], 0
ds_read_b128 v[20:23], v6 offset:60320
ds_read_b128 v[24:27], v121 offset:58240
ds_read_b128 v[28:31], v122 offset:58240
v_exp_f32 v40, v40
v_exp_f32 v41, v41
v_exp_f32 v42, v42
v_exp_f32 v43, v43
v_exp_f32 v44, v44
v_cvt_pk_bf16_f32 v72, v40, v41
v_cvt_pk_bf16_f32 v73, v42, v43
v_mfma_f32_32x32x16_bf16 v[104:119], v[32:35], v[80:83], v[104:119]
v_exp_f32 v45, v45
v_exp_f32 v46, v46
v_exp_f32 v47, v47
v_exp_f32 v48, v48
v_exp_f32 v49, v49
v_cvt_pk_bf16_f32 v74, v44, v45
v_cvt_pk_bf16_f32 v75, v46, v47
v_mfma_f32_32x32x16_bf16 v[104:119], v[36:39], v[84:87], v[104:119]
v_exp_f32 v50, v50
v_exp_f32 v51, v51
v_cvt_pk_bf16_f32 v76, v48, v49
v_exp_f32 v52, v52
v_exp_f32 v53, v53
v_cvt_pk_bf16_f32 v77, v50, v51
v_exp_f32 v54, v54
v_exp_f32 v55, v55
v_cvt_pk_bf16_f32 v78, v52, v53
v_cvt_pk_bf16_f32 v79, v54, v55
s_waitcnt lgkmcnt(0)
v_mfma_f32_32x32x16_bf16 v[40:55], v[20:23], v[8:11], 0
buffer_load_dwordx2 v[144:145], v142, s[8:11], s78 offen offset:0
buffer_load_dwordx2 v[146:147], v142, s[8:11], s78 offen offset:16
buffer_load_dwordx2 v[148:149], v142, s[8:11], s78 offen offset:32
buffer_load_dwordx2 v[150:151], v142, s[8:11], s78 offen offset:48
v_exp_f32 v56, v56
v_exp_f32 v57, v57
v_exp_f32 v58, v58
v_exp_f32 v59, v59
v_exp_f32 v60, v60
v_cvt_pk_bf16_f32 v80, v56, v57
v_cvt_pk_bf16_f32 v81, v58, v59
v_mfma_f32_32x32x16_bf16 v[88:103], v[24:27], v[72:75], v[88:103]
v_exp_f32 v61, v61
v_exp_f32 v62, v62
v_exp_f32 v63, v63
v_exp_f32 v64, v64
v_exp_f32 v65, v65
v_cvt_pk_bf16_f32 v82, v60, v61
v_cvt_pk_bf16_f32 v83, v62, v63
v_mfma_f32_32x32x16_bf16 v[88:103], v[28:31], v[76:79], v[88:103]
v_exp_f32 v66, v66
v_exp_f32 v67, v67
v_cvt_pk_bf16_f32 v84, v64, v65
v_exp_f32 v68, v68
v_exp_f32 v69, v69
v_cvt_pk_bf16_f32 v85, v66, v67
v_exp_f32 v70, v70
v_exp_f32 v71, v71
v_cvt_pk_bf16_f32 v86, v68, v69
v_cvt_pk_bf16_f32 v87, v70, v71
v_mfma_f32_32x32x16_bf16 v[56:71], v[20:23], v[12:15], 0
ds_read_b128 v[16:19], v6 offset:62400
ds_read_b128 v[32:35], v121 offset:60320
ds_read_b128 v[36:39], v122 offset:60320
v_exp_f32 v40, v40
v_exp_f32 v41, v41
v_exp_f32 v42, v42
v_exp_f32 v43, v43
v_exp_f32 v44, v44
v_cvt_pk_bf16_f32 v72, v40, v41
v_cvt_pk_bf16_f32 v73, v42, v43
v_mfma_f32_32x32x16_bf16 v[104:119], v[24:27], v[80:83], v[104:119]
v_exp_f32 v45, v45
v_exp_f32 v46, v46
v_exp_f32 v47, v47
v_exp_f32 v48, v48
v_exp_f32 v49, v49
v_cvt_pk_bf16_f32 v74, v44, v45
v_cvt_pk_bf16_f32 v75, v46, v47
v_mfma_f32_32x32x16_bf16 v[104:119], v[28:31], v[84:87], v[104:119]
v_exp_f32 v50, v50
v_exp_f32 v51, v51
v_cvt_pk_bf16_f32 v76, v48, v49
v_exp_f32 v52, v52
v_exp_f32 v53, v53
v_cvt_pk_bf16_f32 v77, v50, v51
v_exp_f32 v54, v54
v_exp_f32 v55, v55
v_cvt_pk_bf16_f32 v78, v52, v53
v_cvt_pk_bf16_f32 v79, v54, v55
s_waitcnt lgkmcnt(0)
v_mfma_f32_32x32x16_bf16 v[40:55], v[16:19], v[8:11], 0
v_lshrrev_b32 v1, 5, v0
v_lshlrev_b32 v1, 3, v1
buffer_load_dwordx2 v[136:137], v1, s[28:31], s73 offen offset:0
buffer_load_dwordx2 v[140:141], v1, s[28:31], s73 offen offset:16
buffer_load_dwordx2 v[142:143], v1, s[28:31], s73 offen offset:32
buffer_load_dwordx2 v[126:127], v1, s[28:31], s73 offen offset:48
v_and_b32 v2, 31, v0
v_lshlrev_b32 v2, 1, v2
buffer_load_ushort v125, v2, s[32:35], s77 offen
v_exp_f32 v56, v56
v_exp_f32 v57, v57
v_exp_f32 v58, v58
v_exp_f32 v59, v59
v_exp_f32 v60, v60
v_cvt_pk_bf16_f32 v80, v56, v57
v_cvt_pk_bf16_f32 v81, v58, v59
v_mfma_f32_32x32x16_bf16 v[88:103], v[32:35], v[72:75], v[88:103]
v_exp_f32 v61, v61
v_exp_f32 v62, v62
v_exp_f32 v63, v63
v_exp_f32 v64, v64
v_exp_f32 v65, v65
v_cvt_pk_bf16_f32 v82, v60, v61
v_cvt_pk_bf16_f32 v83, v62, v63
v_mfma_f32_32x32x16_bf16 v[88:103], v[36:39], v[76:79], v[88:103]
v_exp_f32 v66, v66
v_exp_f32 v67, v67
v_cvt_pk_bf16_f32 v84, v64, v65
v_exp_f32 v68, v68
v_exp_f32 v69, v69
v_cvt_pk_bf16_f32 v85, v66, v67
v_exp_f32 v70, v70
v_exp_f32 v71, v71
v_cvt_pk_bf16_f32 v86, v68, v69
v_cvt_pk_bf16_f32 v87, v70, v71
v_mfma_f32_32x32x16_bf16 v[56:71], v[16:19], v[12:15], 0
ds_read_b128 v[20:23], v6 offset:64480
ds_read_b128 v[24:27], v121 offset:62400
ds_read_b128 v[28:31], v122 offset:62400
v_exp_f32 v40, v40
v_exp_f32 v41, v41
v_exp_f32 v42, v42
v_exp_f32 v43, v43
v_exp_f32 v44, v44
v_cvt_pk_bf16_f32 v72, v40, v41
v_cvt_pk_bf16_f32 v73, v42, v43
v_mfma_f32_32x32x16_bf16 v[104:119], v[32:35], v[80:83], v[104:119]
v_exp_f32 v45, v45
v_exp_f32 v46, v46
v_exp_f32 v47, v47
v_exp_f32 v48, v48
v_exp_f32 v49, v49
v_cvt_pk_bf16_f32 v74, v44, v45
v_cvt_pk_bf16_f32 v75, v46, v47
v_mfma_f32_32x32x16_bf16 v[104:119], v[36:39], v[84:87], v[104:119]
v_exp_f32 v50, v50
v_exp_f32 v51, v51
v_cvt_pk_bf16_f32 v76, v48, v49
v_exp_f32 v52, v52
v_exp_f32 v53, v53
v_cvt_pk_bf16_f32 v77, v50, v51
v_exp_f32 v54, v54
v_exp_f32 v55, v55
v_cvt_pk_bf16_f32 v78, v52, v53
v_cvt_pk_bf16_f32 v79, v54, v55
s_waitcnt lgkmcnt(0)
v_mfma_f32_32x32x16_bf16 v[40:55], v[20:23], v[8:11], 0
v_exp_f32 v56, v56
v_exp_f32 v57, v57
v_exp_f32 v58, v58
v_exp_f32 v59, v59
v_exp_f32 v60, v60
v_cvt_pk_bf16_f32 v80, v56, v57
v_cvt_pk_bf16_f32 v81, v58, v59
v_mfma_f32_32x32x16_bf16 v[88:103], v[24:27], v[72:75], v[88:103]
v_exp_f32 v61, v61
v_exp_f32 v62, v62
v_exp_f32 v63, v63
v_exp_f32 v64, v64
v_exp_f32 v65, v65
v_cvt_pk_bf16_f32 v82, v60, v61
v_cvt_pk_bf16_f32 v83, v62, v63
v_mfma_f32_32x32x16_bf16 v[88:103], v[28:31], v[76:79], v[88:103]
v_exp_f32 v66, v66
v_exp_f32 v67, v67
v_cvt_pk_bf16_f32 v84, v64, v65
v_exp_f32 v68, v68
v_exp_f32 v69, v69
v_cvt_pk_bf16_f32 v85, v66, v67
v_exp_f32 v70, v70
v_exp_f32 v71, v71
v_cvt_pk_bf16_f32 v86, v68, v69
v_cvt_pk_bf16_f32 v87, v70, v71
v_mfma_f32_32x32x16_bf16 v[56:71], v[20:23], v[12:15], 0
ds_read_b128 v[32:35], v121 offset:64480
ds_read_b128 v[36:39], v122 offset:64480
v_exp_f32 v40, v40
v_exp_f32 v41, v41
v_exp_f32 v42, v42
v_exp_f32 v43, v43
v_exp_f32 v44, v44
v_cvt_pk_bf16_f32 v72, v40, v41
v_cvt_pk_bf16_f32 v73, v42, v43
v_mfma_f32_32x32x16_bf16 v[104:119], v[24:27], v[80:83], v[104:119]
v_exp_f32 v45, v45
v_exp_f32 v46, v46
v_exp_f32 v47, v47
v_exp_f32 v48, v48
v_exp_f32 v49, v49
v_cvt_pk_bf16_f32 v74, v44, v45
v_cvt_pk_bf16_f32 v75, v46, v47
v_mfma_f32_32x32x16_bf16 v[104:119], v[28:31], v[84:87], v[104:119]
v_exp_f32 v50, v50
v_exp_f32 v51, v51
v_cvt_pk_bf16_f32 v76, v48, v49
v_exp_f32 v52, v52
v_exp_f32 v53, v53
v_cvt_pk_bf16_f32 v77, v50, v51
v_exp_f32 v54, v54
v_exp_f32 v55, v55
v_cvt_pk_bf16_f32 v78, v52, v53
v_cvt_pk_bf16_f32 v79, v54, v55
s_waitcnt lgkmcnt(0)
v_exp_f32 v56, v56
v_exp_f32 v57, v57
v_exp_f32 v58, v58
v_exp_f32 v59, v59
v_exp_f32 v60, v60
v_cvt_pk_bf16_f32 v80, v56, v57
v_cvt_pk_bf16_f32 v81, v58, v59
v_mfma_f32_32x32x16_bf16 v[88:103], v[32:35], v[72:75], v[88:103]
v_exp_f32 v61, v61
v_exp_f32 v62, v62
v_exp_f32 v63, v63
v_exp_f32 v64, v64
v_exp_f32 v65, v65
v_cvt_pk_bf16_f32 v82, v60, v61
v_cvt_pk_bf16_f32 v83, v62, v63
v_mfma_f32_32x32x16_bf16 v[88:103], v[36:39], v[76:79], v[88:103]
v_exp_f32 v66, v66
v_exp_f32 v67, v67
v_cvt_pk_bf16_f32 v84, v64, v65
v_exp_f32 v68, v68
v_exp_f32 v69, v69
v_cvt_pk_bf16_f32 v85, v66, v67
v_exp_f32 v70, v70
v_exp_f32 v71, v71
v_cvt_pk_bf16_f32 v86, v68, v69
v_cvt_pk_bf16_f32 v87, v70, v71
v_mfma_f32_32x32x16_bf16 v[104:119], v[32:35], v[80:83], v[104:119]
s_nop 0
v_mfma_f32_32x32x16_bf16 v[104:119], v[36:39], v[84:87], v[104:119]
L_attn_epi:
s_lshl_b32 s67, s57, 8
s_add_u32 s67, s67, 4096
v_mov_b32 v1, v96
s_nop 1
v_permlane32_swap_b32 v96, v1
v_add_f32 v96, v96, v1
v_rcp_f32 v124, v96
s_nop 0
v_pk_mul_f32 v[88:89], v[124:125], v[88:89] op_sel_hi:[0,1]
v_pk_mul_f32 v[90:91], v[124:125], v[90:91] op_sel_hi:[0,1]
v_pk_mul_f32 v[92:93], v[124:125], v[92:93] op_sel_hi:[0,1]
v_pk_mul_f32 v[94:95], v[124:125], v[94:95] op_sel_hi:[0,1]
v_cvt_pk_bf16_f32 v72, v88, v89
v_cvt_pk_bf16_f32 v73, v90, v91
v_cvt_pk_bf16_f32 v74, v92, v93
v_cvt_pk_bf16_f32 v75, v94, v95
buffer_store_dwordx4 v[72:75], v6, s[40:43], s71 offen sc1
v_mov_b32 v1, v112
s_nop 1
v_permlane32_swap_b32 v112, v1
v_add_f32 v112, v112, v1
v_rcp_f32 v124, v112
s_nop 0
v_pk_mul_f32 v[104:105], v[124:125], v[104:105] op_sel_hi:[0,1]
v_pk_mul_f32 v[106:107], v[124:125], v[106:107] op_sel_hi:[0,1]
v_pk_mul_f32 v[108:109], v[124:125], v[108:109] op_sel_hi:[0,1]
v_pk_mul_f32 v[110:111], v[124:125], v[110:111] op_sel_hi:[0,1]
v_cvt_pk_bf16_f32 v80, v104, v105
v_cvt_pk_bf16_f32 v81, v106, v107
v_cvt_pk_bf16_f32 v82, v108, v109
v_cvt_pk_bf16_f32 v83, v110, v111
buffer_store_dwordx4 v[80:83], v6, s[40:43], s72 offen sc1
s_waitcnt vmcnt(0)
s_barrier
s_cmp_lg_u32 s3, 0
s_cbranch_scc1 L_w0_8
s_mov_b64 exec, 1
v_mov_b32 v1, 1
v_mov_b32 v2, s67
buffer_atomic_add v1, v2, s[40:43], 0 offen sc1
s_mov_b64 exec, -1
L_w0_8:
s_lshr_b32 s56, s3, 1
s_and_b32 s57, s3, 1
v_lshrrev_b32 v1, 5, v0
v_lshlrev_b32 v1, 2, v1
v_bfe_u32 v2, v0, 2, 2
v_add_u32 v1, v1, v2
v_lshlrev_b32 v1, 7, v1
v_bfe_u32 v2, v0, 4, 1
v_bfe_u32 v3, v0, 1, 1
v_lshl_add_u32 v2, v2, 1, v3
v_bfe_u32 v3, v0, 3, 1
v_lshlrev_b32 v3, 2, v3
v_xor_b32 v2, v2, v3
v_lshl_add_u32 v1, v2, 4, v1
v_and_b32 v3, 1, v0
v_lshl_add_u32 v7, v3, 3, v1
s_lshl_b32 s49, s57, 15
s_add_u32 s49, s49, 66560
v_add_u32 v120, s49, v7
v_xor_b32 v121, 64, v120
s_lshl_b32 s69, s88, 1
s_add_u32 s69, s69, s56
s_lshl_b32 s69, s69, 15
s_lshl_b32 s49, s57, 14
s_add_u32 s69, s69, s49
s_add_u32 s69, s69, 0x800000
s_lshl_b32 s51, s88, 13
s_lshl_b32 s49, s56, 8
s_add_u32 s51, s51, s49
s_add_u32 s61, s51, 0x8000
s_lshl_b32 s49, s89, 1
s_add_u32 s49, s49, s57
s_lshl_b32 s49, s49, 9
s_add_u32 s60, s49, s61
s_lshl_b32 s59, s89, 1
s_add_u32 s59, s59, s57
s_lshl_b32 s59, s59, 17
s_lshl_b32 s49, s88, 12
s_add_u32 s59, s59, s49
s_lshl_b32 s49, s56, 11
s_add_u32 s59, s59, s49
s_add_u32 s59, s59, 0xa00000
s_lshr_b32 s68, s88, 2
s_lshl_b32 s68, s68, 8
s_add_u32 s68, s68, 4096
s_lshl_b32 s70, s88, 3
s_add_u32 s70, s70, s89
s_lshl_b32 s70, s70, 2
s_add_u32 s70, s70, s3
s_lshl_b32 s70, s70, 11
s_add_u32 s70, s70, 0xd80000
s_xor_b32 s48, s3, 1
s_lshl_b32 s48, s48, 12
s_add_u32 s48, s48, 33280
v_add_u32 v122, s48, v6
s_lshl_b32 s58, s3, 12
s_add_u32 s58, s58, 33280
v_add_u32 v123, s58, v6
ds_read_b64_tr_b16 v[56:57], v120 offset:0
ds_read_b64_tr_b16 v[58:59], v120 offset:1024
ds_read_b64_tr_b16 v[60:61], v121 offset:0
ds_read_b64_tr_b16 v[62:63], v121 offset:1024
ds_read_b64_tr_b16 v[64:65], v120 offset:2048
ds_read_b64_tr_b16 v[66:67], v120 offset:3072
ds_read_b64_tr_b16 v[68:69], v121 offset:2048
ds_read_b64_tr_b16 v[70:71], v121 offset:3072
ds_read_b64_tr_b16 v[104:105], v120 offset:4096
ds_read_b64_tr_b16 v[106:107], v120 offset:5120
ds_read_b64_tr_b16 v[108:109], v121 offset:4096
ds_read_b64_tr_b16 v[110:111], v121 offset:5120
s_cmp_lg_u32 s3, 0
s_cbranch_scc1 L_w0_9
v_mov_b32 v2, s68
s_mov_b32 s76, 0
L_poll_10:
buffer_load_dword v1, v2, s[40:43], 0 offen sc1
s_add_u32 s76, s76, 1
s_waitcnt vmcnt(0)
v_readfirstlane_b32 s48, v1
s_nop 2
s_cmp_ge_u32 s48, 32
s_cbranch_scc1 L_w0_9
s_cmp_lt_u32 s76, 0x40000
s_cbranch_scc1 L_poll_10
L_w0_9:
s_barrier
buffer_load_dwordx4 v[8:11], v6, s[40:43], s69 offen offset:0 sc1
buffer_load_dwordx4 v[12:15], v6, s[40:43], s69 offen offset:1024 sc1
buffer_load_dwordx4 v[16:19], v6, s[40:43], s69 offen offset:2048 sc1
buffer_load_dwordx4 v[20:23], v6, s[40:43], s69 offen offset:3072 sc1
s_add_u32 s69, s69, 4096
buffer_load_dwordx4 v[24:27], v6, s[40:43], s69 offen offset:0 sc1
buffer_load_dwordx4 v[28:31], v6, s[40:43], s69 offen offset:1024 sc1
buffer_load_dwordx4 v[32:35], v6, s[40:43], s69 offen offset:2048 sc1
buffer_load_dwordx4 v[36:39], v6, s[40:43], s69 offen offset:3072 sc1
s_add_u32 s69, s69, 4096
buffer_load_dwordx4 v[40:43], v6, s[40:43], s69 offen offset:0 sc1
buffer_load_dwordx4 v[44:47], v6, s[40:43], s69 offen offset:1024 sc1
buffer_load_dwordx4 v[48:51], v6, s[40:43], s69 offen offset:2048 sc1
buffer_load_dwordx4 v[52:55], v6, s[40:43], s69 offen offset:3072 sc1
s_waitcnt lgkmcnt(8)
s_waitcnt vmcnt(11)
v_mfma_f32_32x32x16_bf16 v[72:87], v[56:59], v[8:11], 0
ds_read_b64_tr_b16 v[112:113], v120 offset:6144
ds_read_b64_tr_b16 v[114:115], v120 offset:7168
v_mfma_f32_32x32x16_bf16 v[88:103], v[60:63], v[8:11], 0
ds_read_b64_tr_b16 v[116:117], v121 offset:6144
ds_read_b64_tr_b16 v[118:119], v121 offset:7168
s_add_u32 s69, s69, 4096
buffer_load_dwordx4 v[8:11], v6, s[40:43], s69 offen offset:0 sc1
s_waitcnt lgkmcnt(8)
s_waitcnt vmcnt(11)
v_mfma_f32_32x32x16_bf16 v[72:87], v[64:67], v[12:15], v[72:87]
ds_read_b64_tr_b16 v[56:57], v120 offset:8192
ds_read_b64_tr_b16 v[58:59], v120 offset:9216
v_mfma_f32_32x32x16_bf16 v[88:103], v[68:71], v[12:15], v[88:103]
ds_read_b64_tr_b16 v[60:61], v121 offset:8192
ds_read_b64_tr_b16 v[62:63], v121 offset:9216
buffer_load_dwordx4 v[12:15], v6, s[40:43], s69 offen offset:1024 sc1
s_waitcnt lgkmcnt(8)
s_waitcnt vmcnt(11)
v_mfma_f32_32x32x16_bf16 v[72:87], v[104:107], v[16:19], v[72:87]
ds_read_b64_tr_b16 v[64:65], v120 offset:10240
ds_read_b64_tr_b16 v[66:67], v120 offset:11264
v_mfma_f32_32x32x16_bf16 v[88:103], v[108:111], v[16:19], v[88:103]
ds_read_b64_tr_b16 v[68:69], v121 offset:10240
ds_read_b64_tr_b16 v[70:71], v121 offset:11264
buffer_load_dwordx4 v[16:19], v6, s[40:43], s69 offen offset:2048 sc1
s_waitcnt lgkmcnt(8)
s_waitcnt vmcnt(11)
v_mfma_f32_32x32x16_bf16 v[72:87], v[112:115], v[20:23], v[72:87]
ds_read_b64_tr_b16 v[104:105], v120 offset:12288
ds_read_b64_tr_b16 v[106:107], v120 offset:13312
v_mfma_f32_32x32x16_bf16 v[88:103], v[116:119], v[20:23], v[88:103]
ds_read_b64_tr_b16 v[108:109], v121 offset:12288
ds_read_b64_tr_b16 v[110:111], v121 offset:13312
buffer_load_dwordx4 v[20:23], v6, s[40:43], s69 offen offset:3072 sc1
s_waitcnt lgkmcnt(8)
s_waitcnt vmcnt(11)
v_mfma_f32_32x32x16_bf16 v[72:87], v[56:59], v[24:27], v[72:87]
ds_read_b64_tr_b16 v[112:113], v120 offset:14336
ds_read_b64_tr_b16 v[114:115], v120 offset:15360
v_mfma_f32_32x32x16_bf16 v[88:103], v[60:63], v[24:27], v[88:103]
ds_read_b64_tr_b16 v[116:117], v121 offset:14336
ds_read_b64_tr_b16 v[118:119], v121 offset:15360
s_waitcnt lgkmcnt(8)
s_waitcnt vmcnt(10)
v_mfma_f32_32x32x16_bf16 v[72:87], v[64:67], v[28:31], v[72:87]
ds_read_b64_tr_b16 v[56:57], v120 offset:16384
ds_read_b64_tr_b16 v[58:59], v120 offset:17408
v_mfma_f32_32x32x16_bf16 v[88:103], v[68:71], v[28:31], v[88:103]
ds_read_b64_tr_b16 v[60:61], v121 offset:16384
ds_read_b64_tr_b16 v[62:63], v121 offset:17408
s_waitcnt lgkmcnt(8)
s_waitcnt vmcnt(9)
v_mfma_f32_32x32x16_bf16 v[72:87], v[104:107], v[32:35], v[72:87]
ds_read_b64_tr_b16 v[64:65], v120 offset:18432
ds_read_b64_tr_b16 v[66:67], v120 offset:19456
v_mfma_f32_32x32x16_bf16 v[88:103], v[108:111], v[32:35], v[88:103]
ds_read_b64_tr_b16 v[68:69], v121 offset:18432
ds_read_b64_tr_b16 v[70:71], v121 offset:19456
s_waitcnt lgkmcnt(8)
s_waitcnt vmcnt(8)
v_mfma_f32_32x32x16_bf16 v[72:87], v[112:115], v[36:39], v[72:87]
ds_read_b64_tr_b16 v[104:105], v120 offset:20480
ds_read_b64_tr_b16 v[106:107], v120 offset:21504
v_mfma_f32_32x32x16_bf16 v[88:103], v[116:119], v[36:39], v[88:103]
ds_read_b64_tr_b16 v[108:109], v121 offset:20480
ds_read_b64_tr_b16 v[110:111], v121 offset:21504
s_waitcnt lgkmcnt(8)
s_waitcnt vmcnt(7)
v_mfma_f32_32x32x16_bf16 v[72:87], v[56:59], v[40:43], v[72:87]
ds_read_b64_tr_b16 v[112:113], v120 offset:22528
ds_read_b64_tr_b16 v[114:115], v120 offset:23552
v_mfma_f32_32x32x16_bf16 v[88:103], v[60:63], v[40:43], v[88:103]
ds_read_b64_tr_b16 v[116:117], v121 offset:22528
ds_read_b64_tr_b16 v[118:119], v121 offset:23552
v_lshlrev_b32 v24, 16, v144
v_and_b32 v25, s83, v144
s_waitcnt lgkmcnt(8)
s_waitcnt vmcnt(6)
v_mfma_f32_32x32x16_bf16 v[72:87], v[64:67], v[44:47], v[72:87]
ds_read_b64_tr_b16 v[56:57], v120 offset:24576
ds_read_b64_tr_b16 v[58:59], v120 offset:25600
v_mfma_f32_32x32x16_bf16 v[88:103], v[68:71], v[44:47], v[88:103]
ds_read_b64_tr_b16 v[60:61], v121 offset:24576
ds_read_b64_tr_b16 v[62:63], v121 offset:25600
v_lshlrev_b32 v26, 16, v145
v_and_b32 v27, s83, v145
s_waitcnt lgkmcnt(8)
s_waitcnt vmcnt(5)
v_mfma_f32_32x32x16_bf16 v[72:87], v[104:107], v[48:51], v[72:87]
ds_read_b64_tr_b16 v[64:65], v120 offset:26624
ds_read_b64_tr_b16 v[66:67], v120 offset:27648
v_mfma_f32_32x32x16_bf16 v[88:103], v[108:111], v[48:51], v[88:103]
ds_read_b64_tr_b16 v[68:69], v121 offset:26624
ds_read_b64_tr_b16 v[70:71], v121 offset:27648
v_lshlrev_b32 v28, 16, v146
v_and_b32 v29, s83, v146
s_waitcnt lgkmcnt(8)
s_waitcnt vmcnt(4)
v_mfma_f32_32x32x16_bf16 v[72:87], v[112:115], v[52:55], v[72:87]
ds_read_b64_tr_b16 v[104:105], v120 offset:28672
ds_read_b64_tr_b16 v[106:107], v120 offset:29696
v_mfma_f32_32x32x16_bf16 v[88:103], v[116:119], v[52:55], v[88:103]
ds_read_b64_tr_b16 v[108:109], v121 offset:28672
ds_read_b64_tr_b16 v[110:111], v121 offset:29696
v_lshlrev_b32 v30, 16, v147
v_and_b32 v31, s83, v147
s_waitcnt lgkmcnt(8)
s_waitcnt vmcnt(3)
v_mfma_f32_32x32x16_bf16 v[72:87], v[56:59], v[8:11], v[72:87]
ds_read_b64_tr_b16 v[112:113], v120 offset:30720
ds_read_b64_tr_b16 v[114:115], v120 offset:31744
v_mfma_f32_32x32x16_bf16 v[88:103], v[60:63], v[8:11], v[88:103]
ds_read_b64_tr_b16 v[116:117], v121 offset:30720
ds_read_b64_tr_b16 v[118:119], v121 offset:31744
v_lshlrev_b32 v32, 16, v148
v_and_b32 v33, s83, v148
s_waitcnt lgkmcnt(8)
s_waitcnt vmcnt(2)
v_mfma_f32_32x32x16_bf16 v[72:87], v[64:67], v[12:15], v[72:87]
v_mfma_f32_32x32x16_bf16 v[88:103], v[68:71], v[12:15], v[88:103]
v_lshlrev_b32 v34, 16, v149
v_and_b32 v35, s83, v149
s_waitcnt lgkmcnt(4)
s_waitcnt vmcnt(1)
v_mfma_f32_32x32x16_bf16 v[72:87], v[104:107], v[16:19], v[72:87]
v_mfma_f32_32x32x16_bf16 v[88:103], v[108:111], v[16:19], v[88:103]
v_lshlrev_b32 v36, 16, v150
v_and_b32 v37, s83, v150
s_waitcnt lgkmcnt(0)
s_waitcnt vmcnt(0)
v_mfma_f32_32x32x16_bf16 v[72:87], v[112:115], v[20:23], v[72:87]
v_mfma_f32_32x32x16_bf16 v[88:103], v[116:119], v[20:23], v[88:103]
v_lshlrev_b32 v38, 16, v151
v_and_b32 v39, s83, v151
s_nop 9
s_cmp_eq_u32 s57, 1
s_cbranch_scc1 L_kh1_11
ds_write_b128 v122, v[88:91] offset:0
ds_write_b128 v122, v[92:95] offset:1024
ds_write_b128 v122, v[96:99] offset:2048
ds_write_b128 v122, v[100:103] offset:3072
v_pk_add_f32 v[24:25], v[24:25], v[72:73]
v_pk_add_f32 v[26:27], v[26:27], v[74:75]
v_pk_add_f32 v[28:29], v[28:29], v[76:77]
v_pk_add_f32 v[30:31], v[30:31], v[78:79]
v_pk_add_f32 v[32:33], v[32:33], v[80:81]
v_pk_add_f32 v[34:35], v[34:35], v[82:83]
v_pk_add_f32 v[36:37], v[36:37], v[84:85]
v_pk_add_f32 v[38:39], v[38:39], v[86:87]
s_branch L_khe_12
L_kh1_11:
ds_write_b128 v122, v[72:75] offset:0
ds_write_b128 v122, v[76:79] offset:1024
ds_write_b128 v122, v[80:83] offset:2048
ds_write_b128 v122, v[84:87] offset:3072
v_pk_add_f32 v[24:25], v[24:25], v[88:89]
v_pk_add_f32 v[26:27], v[26:27], v[90:91]
v_pk_add_f32 v[28:29], v[28:29], v[92:93]
v_pk_add_f32 v[30:31], v[30:31], v[94:95]
v_pk_add_f32 v[32:33], v[32:33], v[96:97]
v_pk_add_f32 v[34:35], v[34:35], v[98:99]
v_pk_add_f32 v[36:37], v[36:37], v[100:101]
v_pk_add_f32 v[38:39], v[38:39], v[102:103]
L_khe_12:
s_waitcnt lgkmcnt(0)
s_barrier
ds_read_b128 v[8:11], v123 offset:0
ds_read_b128 v[12:15], v123 offset:1024
ds_read_b128 v[16:19], v123 offset:2048
ds_read_b128 v[20:23], v123 offset:3072
v_and_b32 v7, 31, v0
v_lshlrev_b32 v7, 3, v7
v_lshrrev_b32 v2, 5, v0
v_lshl_add_u32 v3, v2, 12, v7
s_mov_b32 s74, -1
s_mov_b32 s75, 0
s_waitcnt lgkmcnt(0)
v_pk_add_f32 v[24:25], v[24:25], v[8:9]
v_pk_add_f32 v[26:27], v[26:27], v[10:11]
v_pk_add_f32 v[28:29], v[28:29], v[12:13]
v_pk_add_f32 v[30:31], v[30:31], v[14:15]
v_pk_add_f32 v[32:33], v[32:33], v[16:17]
v_pk_add_f32 v[34:35], v[34:35], v[18:19]
v_pk_add_f32 v[36:37], v[36:37], v[20:21]
v_pk_add_f32 v[38:39], v[38:39], v[22:23]
v_cvt_pk_bf16_f32 v128, v24, v25
v_cvt_pk_bf16_f32 v129, v26, v27
v_cvt_pk_bf16_f32 v130, v28, v29
v_cvt_pk_bf16_f32 v131, v30, v31
v_cvt_pk_bf16_f32 v132, v32, v33
v_cvt_pk_bf16_f32 v133, v34, v35
v_cvt_pk_bf16_f32 v134, v36, v37
v_cvt_pk_bf16_f32 v135, v38, v39
v_lshlrev_b32 v24, 16, v128
v_and_b32 v25, s83, v128
v_lshlrev_b32 v26, 16, v129
v_and_b32 v27, s83, v129
v_lshlrev_b32 v28, 16, v130
v_and_b32 v29, s83, v130
v_lshlrev_b32 v30, 16, v131
v_and_b32 v31, s83, v131
v_lshlrev_b32 v32, 16, v132
v_and_b32 v33, s83, v132
v_lshlrev_b32 v34, 16, v133
v_and_b32 v35, s83, v133
v_lshlrev_b32 v36, 16, v134
v_and_b32 v37, s83, v134
v_lshlrev_b32 v38, 16, v135
v_and_b32 v39, s83, v135
v_pk_add_f32 v[44:45], v[24:25], v[26:27]
v_pk_mul_f32 v[46:47], v[24:25], v[24:25]
v_pk_fma_f32 v[46:47], v[26:27], v[26:27], v[46:47]
v_pk_add_f32 v[44:45], v[44:45], v[28:29]
v_pk_fma_f32 v[46:47], v[28:29], v[28:29], v[46:47]
v_pk_add_f32 v[44:45], v[44:45], v[30:31]
v_pk_fma_f32 v[46:47], v[30:31], v[30:31], v[46:47]
v_pk_add_f32 v[44:45], v[44:45], v[32:33]
v_pk_fma_f32 v[46:47], v[32:33], v[32:33], v[46:47]
v_pk_add_f32 v[44:45], v[44:45], v[34:35]
v_pk_fma_f32 v[46:47], v[34:35], v[34:35], v[46:47]
v_pk_add_f32 v[44:45], v[44:45], v[36:37]
v_pk_fma_f32 v[46:47], v[36:37], v[36:37], v[46:47]
v_pk_add_f32 v[44:45], v[44:45], v[38:39]
v_pk_fma_f32 v[46:47], v[38:39], v[38:39], v[46:47]
v_add_f32 v48, v44, v45
v_add_f32 v49, v46, v47
v_mov_b32 v52, v48
s_nop 1
v_permlane32_swap_b32 v48, v52
v_add_f32 v48, v48, v52
v_mov_b32 v52, v49
s_nop 1
v_permlane32_swap_b32 v49, v52
v_add_f32 v49, v49, v52
s_mov_b64 exec, s[74:75]
buffer_store_dwordx2 v[48:49], v7, s[40:43], s60 offen sc1
s_mov_b64 exec, -1
v_and_b32 v1, 31, v0
v_mul_u32_u24 v1, 72, v1
v_lshl_add_u32 v1, v2, 3, v1
v_add_u32 v50, s58, v1
v_lshlrev_b32 v1, 3, v2
v_bfe_u32 v4, v0, 2, 2
v_add_u32 v1, v1, v4
v_mul_u32_u24 v1, 72, v1
v_bfe_u32 v4, v0, 4, 1
v_lshl_add_u32 v1, v4, 5, v1
v_and_b32 v4, 3, v0
v_lshl_add_u32 v1, v4, 3, v1
v_add_u32 v51, s58, v1
s_mov_b32 s76, 0
s_lshl_b32 s48, s65, 18
s_lshl_b32 s49, s3, 15
s_add_u32 s48, s48, s49
s_add_u32 s90, s48, 0xa00000
s_add_u32 s91, s90, 0x20000
v_lshrrev_b32 v44, 5, v0
v_lshlrev_b32 v44, 3, v44
v_bfe_u32 v45, v0, 2, 2
v_add_u32 v44, v44, v45
v_lshlrev_b32 v44, 7, v44
v_bfe_u32 v45, v0, 4, 1
v_bfe_u32 v46, v0, 1, 1
v_lshl_add_u32 v45, v45, 1, v46
v_bfe_u32 v46, v0, 3, 1
v_lshlrev_b32 v46, 2, v46
v_xor_b32 v45, v45, v46
v_lshl_add_u32 v44, v45, 4, v44
v_and_b32 v46, 1, v0
v_lshl_add_u32 v47, v46, 3, v44
s_lshl_b32 s92, s3, 14
s_add_u32 s92, s92, 66560
v_add_u32 v144, s92, v47
v_xor_b32 v145, 64, v144
v_add_u32 v146, s92, v6
s_lshl_b32 s95, s65, 8
s_add_u32 s95, s95, 14336
s_lshl_b32 s93, s64, 1
s_lshr_b32 s49, s3, 1
s_add_u32 s93, s93, s49
s_lshl_b32 s94, s93, 11
s_lshl_b32 s49, s65, 1
s_and_b32 s50, s3, 1
s_add_u32 s49, s49, s50
s_mul_i32 s49, s49, 90112
s_add_u32 s94, s94, s49
s_add_u32 s94, s94, 0xc00000
s_mul_i32 s48, s63, 180224
s_mul_i32 s49, s3, 22528
s_add_u32 s48, s48, s49
s_add_u32 s96, s48, 0xc00000
s_add_u32 s97, s96, 90112
v_lshrrev_b32 v44, 5, v0
v_lshlrev_b32 v44, 2, v44
v_bfe_u32 v45, v0, 2, 2
v_add_u32 v44, v44, v45
v_lshlrev_b32 v44, 7, v44
v_bfe_u32 v45, v0, 4, 1
v_bfe_u32 v46, v0, 1, 1
v_lshl_add_u32 v45, v45, 1, v46
v_bfe_u32 v46, v0, 3, 1
v_lshlrev_b32 v46, 2, v46
v_xor_b32 v45, v45, v46
v_lshl_add_u32 v44, v45, 4, v44
v_and_b32 v46, 1, v0
v_lshl_add_u32 v47, v46, 3, v44
s_lshl_b32 s48, s3, 13
s_add_u32 s48, s48, 33280
v_add_u32 v120, s48, v47
v_xor_b32 v121, 64, v120
v_add_u32 v150, s48, v6
s_mul_i32 s48, s3, 6144
s_add_u32 s48, s48, 132096
v_add_u32 v122, s48, v47
v_xor_b32 v123, 64, v122
s_lshl_b32 s48, s3, 12
v_add_u32 v148, s48, v47
v_xor_b32 v149, 64, v148
s_lshl_b32 s98, s63, 8
s_add_u32 s98, s98, 16384
s_lshl_b32 s99, s62, 3
s_add_u32 s99, s99, s63
s_lshl_b32 s99, s99, 2
s_add_u32 s99, s99, s3
s_lshl_b32 s99, s99, 11
s_add_u32 s99, s99, 0xd80000
v_and_b32 v44, 31, v0
v_lshlrev_b32 v44, 10, v44
v_lshrrev_b32 v45, 5, v0
v_lshl_add_u32 v151, v45, 4, v44
L_stat_13:
buffer_load_dwordx2 v[56:57], v3, s[40:43], s61 offen offset:0 sc1
buffer_load_dwordx2 v[58:59], v3, s[40:43], s61 offen offset:512 sc1
buffer_load_dwordx2 v[60:61], v3, s[40:43], s61 offen offset:1024 sc1
buffer_load_dwordx2 v[62:63], v3, s[40:43], s61 offen offset:1536 sc1
buffer_load_dwordx2 v[64:65], v3, s[40:43], s61 offen offset:2048 sc1
buffer_load_dwordx2 v[66:67], v3, s[40:43], s61 offen offset:2560 sc1
buffer_load_dwordx2 v[68:69], v3, s[40:43], s61 offen offset:3072 sc1
buffer_load_dwordx2 v[70:71], v3, s[40:43], s61 offen offset:3584 sc1
L_statc_15:
s_add_u32 s76, s76, 1
s_waitcnt vmcnt(0)
v_max3_u32 v1, v56, v57, v58
v_max3_u32 v1, v1, v59, v60
v_max3_u32 v1, v1, v61, v62
v_max3_u32 v1, v1, v63, v64
v_max3_u32 v1, v1, v65, v66
v_max3_u32 v1, v1, v67, v68
v_max3_u32 v1, v1, v69, v70
v_max_u32 v1, v1, v71
v_cmp_eq_u32 vcc, -1, v1
s_nop 2
s_cmp_eq_u64 vcc, 0
s_cbranch_scc1 L_statd_14
s_cmp_lt_u32 s76, 0x40000
s_cbranch_scc1 L_stat_13
L_statd_14:
v_pk_add_f32 v[56:57], v[56:57], v[58:59]
v_pk_add_f32 v[56:57], v[56:57], v[60:61]
v_pk_add_f32 v[56:57], v[56:57], v[62:63]
v_pk_add_f32 v[56:57], v[56:57], v[64:65]
v_pk_add_f32 v[56:57], v[56:57], v[66:67]
v_pk_add_f32 v[56:57], v[56:57], v[68:69]
v_pk_add_f32 v[56:57], v[56:57], v[70:71]
v_mov_b32 v52, v56
s_nop 1
v_permlane32_swap_b32 v56, v52
v_add_f32 v56, v56, v52
v_mov_b32 v52, v57
s_nop 1
v_permlane32_swap_b32 v57, v52
v_add_f32 v57, v57, v52
v_mul_f32 v40, 0x3b000000, v56
v_mul_f32 v41, 0x3b000000, v57
v_fma_f32 v41, -v40, v40, v41
v_max_f32 v41, 0, v41
v_add_f32 v43, 0x3727c5ac, v41
v_rsq_f32 v43, v43
s_nop 0
v_mul_f32 v42, v43, v43
v_mul_f32 v42, v42, v41
v_add_f32 v42, 0x3727c5ac, v42
v_rsq_f32 v42, v42
s_nop 0
v_mul_f32 v42, v42, v43
v_pk_add_f32 v[24:25], v[24:25], v[40:41] op_sel_hi:[1,0] neg_lo:[0,1] neg_hi:[0,1]
v_pk_add_f32 v[26:27], v[26:27], v[40:41] op_sel_hi:[1,0] neg_lo:[0,1] neg_hi:[0,1]
v_pk_add_f32 v[28:29], v[28:29], v[40:41] op_sel_hi:[1,0] neg_lo:[0,1] neg_hi:[0,1]
v_pk_add_f32 v[30:31], v[30:31], v[40:41] op_sel_hi:[1,0] neg_lo:[0,1] neg_hi:[0,1]
v_pk_add_f32 v[32:33], v[32:33], v[40:41] op_sel_hi:[1,0] neg_lo:[0,1] neg_hi:[0,1]
v_pk_add_f32 v[34:35], v[34:35], v[40:41] op_sel_hi:[1,0] neg_lo:[0,1] neg_hi:[0,1]
v_pk_add_f32 v[36:37], v[36:37], v[40:41] op_sel_hi:[1,0] neg_lo:[0,1] neg_hi:[0,1]
v_pk_add_f32 v[38:39], v[38:39], v[40:41] op_sel_hi:[1,0] neg_lo:[0,1] neg_hi:[0,1]
v_pk_mul_f32 v[24:25], v[42:43], v[24:25] op_sel_hi:[0,1]
v_pk_mul_f32 v[26:27], v[42:43], v[26:27] op_sel_hi:[0,1]
v_pk_mul_f32 v[28:29], v[42:43], v[28:29] op_sel_hi:[0,1]
v_pk_mul_f32 v[30:31], v[42:43], v[30:31] op_sel_hi:[0,1]
v_pk_mul_f32 v[32:33], v[42:43], v[32:33] op_sel_hi:[0,1]
v_pk_mul_f32 v[34:35], v[42:43], v[34:35] op_sel_hi:[0,1]
v_pk_mul_f32 v[36:37], v[42:43], v[36:37] op_sel_hi:[0,1]
v_pk_mul_f32 v[38:39], v[42:43], v[38:39] op_sel_hi:[0,1]
v_cvt_pk_bf16_f32 v8, v24, v25
v_cvt_pk_bf16_f32 v9, v26, v27
v_cvt_pk_bf16_f32 v10, v28, v29
v_cvt_pk_bf16_f32 v11, v30, v31
v_cvt_pk_bf16_f32 v12, v32, v33
v_cvt_pk_bf16_f32 v13, v34, v35
v_cvt_pk_bf16_f32 v14, v36, v37
v_cvt_pk_bf16_f32 v15, v38, v39
ds_write_b64 v50, v[8:9] offset:0
ds_write_b64 v50, v[10:11] offset:16
ds_write_b64 v50, v[12:13] offset:32
ds_write_b64 v50, v[14:15] offset:48
ds_read_b64_tr_b16 v[16:17], v51 offset:0
ds_read_b64_tr_b16 v[18:19], v51 offset:288
ds_read_b64_tr_b16 v[20:21], v51 offset:1152
ds_read_b64_tr_b16 v[22:23], v51 offset:1440
s_lshl_b32 s67, s89, 8
s_add_u32 s67, s67, 14336
s_waitcnt lgkmcnt(0)
buffer_store_dwordx4 v[16:19], v6, s[40:43], s59 offen offset:0 sc1
buffer_store_dwordx4 v[20:23], v6, s[40:43], s59 offen offset:1024 sc1
s_waitcnt vmcnt(0)
s_barrier
s_cmp_lg_u32 s3, 0
s_cbranch_scc1 L_w0_16
s_mov_b64 exec, 1
v_mov_b32 v2, 1
v_mov_b32 v3, s67
buffer_atomic_add v2, v3, s[40:43], 0 offen sc1
s_mov_b64 exec, -1
L_w0_16:
ds_write_b128 v146, a[0:3] offset:0
ds_write_b128 v146, a[4:7] offset:1024
ds_write_b128 v146, a[8:11] offset:2048
ds_write_b128 v146, a[12:15] offset:3072
ds_write_b128 v146, a[16:19] offset:4096
ds_write_b128 v146, a[20:23] offset:5120
ds_write_b128 v146, a[24:27] offset:6144
ds_write_b128 v146, a[28:31] offset:7168
ds_write_b128 v146, a[32:35] offset:8192
ds_write_b128 v146, a[36:39] offset:9216
ds_write_b128 v146, a[40:43] offset:10240
ds_write_b128 v146, a[44:47] offset:11264
ds_write_b128 v146, a[48:51] offset:12288
ds_write_b128 v146, a[52:55] offset:13312
ds_write_b128 v146, a[56:59] offset:14336
ds_write_b128 v146, a[60:63] offset:15360
ds_read_b64_tr_b16 v[72:73], v144 offset:0
ds_read_b64_tr_b16 v[74:75], v144 offset:512
ds_read_b64_tr_b16 v[76:77], v145 offset:0
ds_read_b64_tr_b16 v[78:79], v145 offset:512
ds_read_b64_tr_b16 v[80:81], v144 offset:2048
ds_read_b64_tr_b16 v[82:83], v144 offset:2560
ds_read_b64_tr_b16 v[84:85], v145 offset:2048
ds_read_b64_tr_b16 v[86:87], v145 offset:2560
s_cmp_ge_u32 s47, 22
s_cbranch_scc1 L_p4_skip
s_waitcnt lgkmcnt(0)
s_cmp_lg_u32 s3, 0
s_cbranch_scc1 L_w0_17
v_mov_b32 v2, s95
s_mov_b32 s76, 0
L_poll_18:
buffer_load_dword v1, v2, s[40:43], 0 offen sc1
s_add_u32 s76, s76, 1
s_waitcnt vmcnt(0)
v_readfirstlane_b32 s48, v1
s_nop 2
s_cmp_ge_u32 s48, 32
s_cbranch_scc1 L_w0_17
s_cmp_lt_u32 s76, 0x40000
s_cbranch_scc1 L_poll_18
L_w0_17:
s_barrier
buffer_load_dwordx4 v[96:99], v6, s[40:43], s90 offen offset:0 sc1
buffer_load_dwordx4 v[100:103], v6, s[40:43], s91 offen offset:0 sc1
buffer_load_dwordx4 v[104:107], v6, s[40:43], s90 offen offset:1024 sc1
buffer_load_dwordx4 v[108:111], v6, s[40:43], s91 offen offset:1024 sc1
buffer_load_dwordx4 v[112:115], v6, s[40:43], s90 offen offset:2048 sc1
buffer_load_dwordx4 v[116:119], v6, s[40:43], s91 offen offset:2048 sc1
buffer_load_dwordx4 a[0:3], v6, s[40:43], s90 offen offset:3072 sc1
s_add_u32 s90, s90, 4096
buffer_load_dwordx4 a[4:7], v6, s[40:43], s91 offen offset:3072 sc1
s_add_u32 s91, s91, 4096
buffer_load_dwordx4 a[8:11], v6, s[40:43], s90 offen offset:0 sc1
buffer_load_dwordx4 a[12:15], v6, s[40:43], s91 offen offset:0 sc1
buffer_load_dwordx4 a[16:19], v6, s[40:43], s90 offen offset:1024 sc1
buffer_load_dwordx4 a[20:23], v6, s[40:43], s91 offen offset:1024 sc1
s_waitcnt lgkmcnt(0)
s_waitcnt vmcnt(10)
v_mfma_f32_32x32x16_bf16 v[8:23], v[72:75], v[96:99], 0
ds_read_b64_tr_b16 v[88:89], v144 offset:4096
ds_read_b64_tr_b16 v[90:91], v144 offset:4608
buffer_load_dwordx4 a[24:27], v6, s[40:43], s90 offen offset:2048 sc1
v_mfma_f32_32x32x16_bf16 v[24:39], v[72:75], v[100:103], 0
ds_read_b64_tr_b16 v[92:93], v145 offset:4096
ds_read_b64_tr_b16 v[94:95], v145 offset:4608
buffer_load_dwordx4 a[28:31], v6, s[40:43], s91 offen offset:2048 sc1
v_mfma_f32_32x32x16_bf16 v[40:55], v[76:79], v[96:99], 0
ds_write_b128 v146, a[64:67] offset:0
buffer_load_dwordx4 a[32:35], v6, s[40:43], s90 offen offset:3072 sc1
s_add_u32 s90, s90, 4096
v_mfma_f32_32x32x16_bf16 v[56:71], v[76:79], v[100:103], 0
ds_write_b128 v146, a[68:71] offset:1024
buffer_load_dwordx4 a[36:39], v6, s[40:43], s91 offen offset:3072 sc1
s_add_u32 s91, s91, 4096
s_waitcnt lgkmcnt(6)
s_waitcnt vmcnt(12)
v_mfma_f32_32x32x16_bf16 v[8:23], v[80:83], v[104:107], v[8:23]
ds_read_b64_tr_b16 v[72:73], v144 offset:6144
ds_read_b64_tr_b16 v[74:75], v144 offset:6656
buffer_load_dwordx4 a[40:43], v6, s[40:43], s90 offen offset:0 sc1
v_mfma_f32_32x32x16_bf16 v[24:39], v[80:83], v[108:111], v[24:39]
ds_read_b64_tr_b16 v[76:77], v145 offset:6144
ds_read_b64_tr_b16 v[78:79], v145 offset:6656
buffer_load_dwordx4 a[44:47], v6, s[40:43], s91 offen offset:0 sc1
v_mfma_f32_32x32x16_bf16 v[40:55], v[84:87], v[104:107], v[40:55]
ds_write_b128 v146, a[72:75] offset:2048
buffer_load_dwordx4 a[48:51], v6, s[40:43], s90 offen offset:1024 sc1
v_mfma_f32_32x32x16_bf16 v[56:71], v[84:87], v[108:111], v[56:71]
ds_write_b128 v146, a[76:79] offset:3072
buffer_load_dwordx4 a[52:55], v6, s[40:43], s91 offen offset:1024 sc1
s_waitcnt lgkmcnt(8)
s_waitcnt vmcnt(14)
v_mfma_f32_32x32x16_bf16 v[8:23], v[88:91], v[112:115], v[8:23]
ds_read_b64_tr_b16 v[80:81], v144 offset:8192
ds_read_b64_tr_b16 v[82:83], v144 offset:8704
buffer_load_dwordx4 a[56:59], v6, s[40:43], s90 offen offset:2048 sc1
v_mfma_f32_32x32x16_bf16 v[24:39], v[88:91], v[116:119], v[24:39]
ds_read_b64_tr_b16 v[84:85], v145 offset:8192
ds_read_b64_tr_b16 v[86:87], v145 offset:8704
buffer_load_dwordx4 a[60:63], v6, s[40:43], s91 offen offset:2048 sc1
v_mfma_f32_32x32x16_bf16 v[40:55], v[92:95], v[112:115], v[40:55]
ds_write_b128 v146, a[80:83] offset:4096
buffer_load_dwordx4 a[64:67], v6, s[40:43], s90 offen offset:3072 sc1
s_add_u32 s90, s90, 4096
v_mfma_f32_32x32x16_bf16 v[56:71], v[92:95], v[116:119], v[56:71]
ds_write_b128 v146, a[84:87] offset:5120
buffer_load_dwordx4 a[68:71], v6, s[40:43], s91 offen offset:3072 sc1
s_add_u32 s91, s91, 4096
s_waitcnt lgkmcnt(8)
s_waitcnt vmcnt(16)
v_mfma_f32_32x32x16_bf16 v[8:23], v[72:75], a[0:3], v[8:23]
ds_read_b64_tr_b16 v[88:89], v144 offset:10240
ds_read_b64_tr_b16 v[90:91], v144 offset:10752
buffer_load_dwordx4 a[72:75], v6, s[40:43], s90 offen offset:0 sc1
v_mfma_f32_32x32x16_bf16 v[24:39], v[72:75], a[4:7], v[24:39]
ds_read_b64_tr_b16 v[92:93], v145 offset:10240
ds_read_b64_tr_b16 v[94:95], v145 offset:10752
buffer_load_dwordx4 a[76:79], v6, s[40:43], s91 offen offset:0 sc1
v_mfma_f32_32x32x16_bf16 v[40:55], v[76:79], a[0:3], v[40:55]
ds_write_b128 v146, a[88:91] offset:6144
buffer_load_dwordx4 a[80:83], v6, s[40:43], s90 offen offset:1024 sc1
v_mfma_f32_32x32x16_bf16 v[56:71], v[76:79], a[4:7], v[56:71]
ds_write_b128 v146, a[92:95] offset:7168
buffer_load_dwordx4 a[84:87], v6, s[40:43], s91 offen offset:1024 sc1
s_waitcnt lgkmcnt(8)
s_waitcnt vmcnt(18)
v_mfma_f32_32x32x16_bf16 v[8:23], v[80:83], a[8:11], v[8:23]
ds_read_b64_tr_b16 v[72:73], v144 offset:12288
ds_read_b64_tr_b16 v[74:75], v144 offset:12800
v_mfma_f32_32x32x16_bf16 v[24:39], v[80:83], a[12:15], v[24:39]
ds_read_b64_tr_b16 v[76:77], v145 offset:12288
ds_read_b64_tr_b16 v[78:79], v145 offset:12800
v_mfma_f32_32x32x16_bf16 v[40:55], v[84:87], a[8:11], v[40:55]
ds_write_b128 v146, a[96:99] offset:8192
buffer_load_dwordx4 a[88:91], v6, s[40:43], s90 offen offset:2048 sc1
v_mfma_f32_32x32x16_bf16 v[56:71], v[84:87], a[12:15], v[56:71]
ds_write_b128 v146, a[100:103] offset:9216
buffer_load_dwordx4 a[92:95], v6, s[40:43], s91 offen offset:2048 sc1
s_waitcnt lgkmcnt(8)
s_waitcnt vmcnt(18)
v_mfma_f32_32x32x16_bf16 v[8:23], v[88:91], a[16:19], v[8:23]
ds_read_b64_tr_b16 v[80:81], v144 offset:14336
ds_read_b64_tr_b16 v[82:83], v144 offset:14848
v_mfma_f32_32x32x16_bf16 v[24:39], v[88:91], a[20:23], v[24:39]
ds_read_b64_tr_b16 v[84:85], v145 offset:14336
ds_read_b64_tr_b16 v[86:87], v145 offset:14848
v_mfma_f32_32x32x16_bf16 v[40:55], v[92:95], a[16:19], v[40:55]
ds_write_b128 v146, a[104:107] offset:10240
buffer_load_dwordx4 a[96:99], v6, s[40:43], s90 offen offset:3072 sc1
s_add_u32 s90, s90, 4096
v_mfma_f32_32x32x16_bf16 v[56:71], v[92:95], a[20:23], v[56:71]
ds_write_b128 v146, a[108:111] offset:11264
buffer_load_dwordx4 a[100:103], v6, s[40:43], s91 offen offset:3072 sc1
s_add_u32 s91, s91, 4096
s_waitcnt lgkmcnt(8)
s_waitcnt vmcnt(18)
v_mfma_f32_32x32x16_bf16 v[8:23], v[72:75], a[24:27], v[8:23]
ds_read_b64_tr_b16 v[88:89], v144 offset:0
ds_read_b64_tr_b16 v[90:91], v144 offset:512
v_mfma_f32_32x32x16_bf16 v[24:39], v[72:75], a[28:31], v[24:39]
ds_read_b64_tr_b16 v[92:93], v145 offset:0
ds_read_b64_tr_b16 v[94:95], v145 offset:512
v_mfma_f32_32x32x16_bf16 v[40:55], v[76:79], a[24:27], v[40:55]
ds_write_b128 v146, a[112:115] offset:12288
buffer_load_dwordx4 a[104:107], v6, s[40:43], s90 offen offset:0 sc1
v_mfma_f32_32x32x16_bf16 v[56:71], v[76:79], a[28:31], v[56:71]
ds_write_b128 v146, a[116:119] offset:13312
buffer_load_dwordx4 a[108:111], v6, s[40:43], s91 offen offset:0 sc1
s_waitcnt lgkmcnt(8)
s_waitcnt vmcnt(18)
v_mfma_f32_32x32x16_bf16 v[8:23], v[80:83], a[32:35], v[8:23]
ds_read_b64_tr_b16 v[72:73], v144 offset:2048
ds_read_b64_tr_b16 v[74:75], v144 offset:2560
v_mfma_f32_32x32x16_bf16 v[24:39], v[80:83], a[36:39], v[24:39]
ds_read_b64_tr_b16 v[76:77], v145 offset:2048
ds_read_b64_tr_b16 v[78:79], v145 offset:2560
v_mfma_f32_32x32x16_bf16 v[40:55], v[84:87], a[32:35], v[40:55]
ds_write_b128 v146, a[120:123] offset:14336
buffer_load_dwordx4 a[112:115], v6, s[40:43], s90 offen offset:1024 sc1
v_mfma_f32_32x32x16_bf16 v[56:71], v[84:87], a[36:39], v[56:71]
ds_write_b128 v146, a[124:127] offset:15360
buffer_load_dwordx4 a[116:119], v6, s[40:43], s91 offen offset:1024 sc1
s_waitcnt lgkmcnt(8)
s_waitcnt vmcnt(18)
v_mfma_f32_32x32x16_bf16 v[8:23], v[88:91], a[40:43], v[8:23]
ds_read_b64_tr_b16 v[80:81], v144 offset:4096
ds_read_b64_tr_b16 v[82:83], v144 offset:4608
v_mfma_f32_32x32x16_bf16 v[24:39], v[88:91], a[44:47], v[24:39]
ds_read_b64_tr_b16 v[84:85], v145 offset:4096
ds_read_b64_tr_b16 v[86:87], v145 offset:4608
v_mfma_f32_32x32x16_bf16 v[40:55], v[92:95], a[40:43], v[40:55]
ds_write_b128 v146, a[128:131] offset:0
buffer_load_dwordx4 a[120:123], v6, s[40:43], s90 offen offset:2048 sc1
v_mfma_f32_32x32x16_bf16 v[56:71], v[92:95], a[44:47], v[56:71]
ds_write_b128 v146, a[132:135] offset:1024
buffer_load_dwordx4 a[124:127], v6, s[40:43], s91 offen offset:2048 sc1
s_waitcnt lgkmcnt(8)
s_waitcnt vmcnt(18)
v_mfma_f32_32x32x16_bf16 v[8:23], v[72:75], a[48:51], v[8:23]
ds_read_b64_tr_b16 v[88:89], v144 offset:6144
ds_read_b64_tr_b16 v[90:91], v144 offset:6656
v_mfma_f32_32x32x16_bf16 v[24:39], v[72:75], a[52:55], v[24:39]
ds_read_b64_tr_b16 v[92:93], v145 offset:6144
ds_read_b64_tr_b16 v[94:95], v145 offset:6656
v_mfma_f32_32x32x16_bf16 v[40:55], v[76:79], a[48:51], v[40:55]
ds_write_b128 v146, a[136:139] offset:2048
buffer_load_dwordx4 a[128:131], v6, s[40:43], s90 offen offset:3072 sc1
s_add_u32 s90, s90, 4096
v_mfma_f32_32x32x16_bf16 v[56:71], v[76:79], a[52:55], v[56:71]
ds_write_b128 v146, a[140:143] offset:3072
buffer_load_dwordx4 a[132:135], v6, s[40:43], s91 offen offset:3072 sc1
s_add_u32 s91, s91, 4096
s_waitcnt lgkmcnt(8)
s_waitcnt vmcnt(18)
v_mfma_f32_32x32x16_bf16 v[8:23], v[80:83], a[56:59], v[8:23]
ds_read_b64_tr_b16 v[72:73], v144 offset:8192
ds_read_b64_tr_b16 v[74:75], v144 offset:8704
v_mfma_f32_32x32x16_bf16 v[24:39], v[80:83], a[60:63], v[24:39]
ds_read_b64_tr_b16 v[76:77], v145 offset:8192
ds_read_b64_tr_b16 v[78:79], v145 offset:8704
v_mfma_f32_32x32x16_bf16 v[40:55], v[84:87], a[56:59], v[40:55]
ds_write_b128 v146, a[144:147] offset:4096
buffer_load_dwordx4 a[136:139], v6, s[40:43], s90 offen offset:0 sc1
v_mfma_f32_32x32x16_bf16 v[56:71], v[84:87], a[60:63], v[56:71]
ds_write_b128 v146, a[148:151] offset:5120
buffer_load_dwordx4 a[140:143], v6, s[40:43], s91 offen offset:0 sc1
s_waitcnt lgkmcnt(8)
s_waitcnt vmcnt(18)
v_mfma_f32_32x32x16_bf16 v[8:23], v[88:91], a[64:67], v[8:23]
ds_read_b64_tr_b16 v[80:81], v144 offset:10240
ds_read_b64_tr_b16 v[82:83], v144 offset:10752
v_mfma_f32_32x32x16_bf16 v[24:39], v[88:91], a[68:71], v[24:39]
ds_read_b64_tr_b16 v[84:85], v145 offset:10240
ds_read_b64_tr_b16 v[86:87], v145 offset:10752
v_mfma_f32_32x32x16_bf16 v[40:55], v[92:95], a[64:67], v[40:55]
ds_write_b128 v146, a[152:155] offset:6144
buffer_load_dwordx4 a[144:147], v6, s[40:43], s90 offen offset:1024 sc1
v_mfma_f32_32x32x16_bf16 v[56:71], v[92:95], a[68:71], v[56:71]
ds_write_b128 v146, a[156:159] offset:7168
buffer_load_dwordx4 a[148:151], v6, s[40:43], s91 offen offset:1024 sc1
s_waitcnt lgkmcnt(8)
s_waitcnt vmcnt(18)
v_mfma_f32_32x32x16_bf16 v[8:23], v[72:75], a[72:75], v[8:23]
ds_read_b64_tr_b16 v[88:89], v144 offset:12288
ds_read_b64_tr_b16 v[90:91], v144 offset:12800
v_mfma_f32_32x32x16_bf16 v[24:39], v[72:75], a[76:79], v[24:39]
ds_read_b64_tr_b16 v[92:93], v145 offset:12288
ds_read_b64_tr_b16 v[94:95], v145 offset:12800
v_mfma_f32_32x32x16_bf16 v[40:55], v[76:79], a[72:75], v[40:55]
ds_write_b128 v146, a[160:163] offset:8192
buffer_load_dwordx4 a[152:155], v6, s[40:43], s90 offen offset:2048 sc1
v_mfma_f32_32x32x16_bf16 v[56:71], v[76:79], a[76:79], v[56:71]
ds_write_b128 v146, a[164:167] offset:9216
buffer_load_dwordx4 a[156:159], v6, s[40:43], s91 offen offset:2048 sc1
s_waitcnt lgkmcnt(8)
s_waitcnt vmcnt(18)
v_mfma_f32_32x32x16_bf16 v[8:23], v[80:83], a[80:83], v[8:23]
ds_read_b64_tr_b16 v[72:73], v144 offset:14336
ds_read_b64_tr_b16 v[74:75], v144 offset:14848
v_mfma_f32_32x32x16_bf16 v[24:39], v[80:83], a[84:87], v[24:39]
ds_read_b64_tr_b16 v[76:77], v145 offset:14336
ds_read_b64_tr_b16 v[78:79], v145 offset:14848
v_mfma_f32_32x32x16_bf16 v[40:55], v[84:87], a[80:83], v[40:55]
ds_write_b128 v146, a[168:171] offset:10240
buffer_load_dwordx4 a[160:163], v6, s[40:43], s90 offen offset:3072 sc1
s_add_u32 s90, s90, 4096
v_mfma_f32_32x32x16_bf16 v[56:71], v[84:87], a[84:87], v[56:71]
ds_write_b128 v146, a[172:175] offset:11264
buffer_load_dwordx4 a[164:167], v6, s[40:43], s91 offen offset:3072 sc1
s_add_u32 s91, s91, 4096
s_waitcnt lgkmcnt(8)
s_waitcnt vmcnt(18)
v_mfma_f32_32x32x16_bf16 v[8:23], v[88:91], a[88:91], v[8:23]
ds_read_b64_tr_b16 v[80:81], v144 offset:0
ds_read_b64_tr_b16 v[82:83], v144 offset:512
v_mfma_f32_32x32x16_bf16 v[24:39], v[88:91], a[92:95], v[24:39]
ds_read_b64_tr_b16 v[84:85], v145 offset:0
ds_read_b64_tr_b16 v[86:87], v145 offset:512
v_mfma_f32_32x32x16_bf16 v[40:55], v[92:95], a[88:91], v[40:55]
ds_write_b128 v146, a[176:179] offset:12288
buffer_load_dwordx4 a[168:171], v6, s[40:43], s90 offen offset:0 sc1
v_mfma_f32_32x32x16_bf16 v[56:71], v[92:95], a[92:95], v[56:71]
ds_write_b128 v146, a[180:183] offset:13312
buffer_load_dwordx4 a[172:175], v6, s[40:43], s91 offen offset:0 sc1
s_waitcnt lgkmcnt(8)
s_waitcnt vmcnt(18)
v_mfma_f32_32x32x16_bf16 v[8:23], v[72:75], a[96:99], v[8:23]
ds_read_b64_tr_b16 v[88:89], v144 offset:2048
ds_read_b64_tr_b16 v[90:91], v144 offset:2560
v_mfma_f32_32x32x16_bf16 v[24:39], v[72:75], a[100:103], v[24:39]
ds_read_b64_tr_b16 v[92:93], v145 offset:2048
ds_read_b64_tr_b16 v[94:95], v145 offset:2560
v_mfma_f32_32x32x16_bf16 v[40:55], v[76:79], a[96:99], v[40:55]
ds_write_b128 v146, a[184:187] offset:14336
buffer_load_dwordx4 a[176:179], v6, s[40:43], s90 offen offset:1024 sc1
v_mfma_f32_32x32x16_bf16 v[56:71], v[76:79], a[100:103], v[56:71]
ds_write_b128 v146, a[188:191] offset:15360
buffer_load_dwordx4 a[180:183], v6, s[40:43], s91 offen offset:1024 sc1
s_waitcnt lgkmcnt(8)
s_waitcnt vmcnt(18)
v_mfma_f32_32x32x16_bf16 v[8:23], v[80:83], a[104:107], v[8:23]
ds_read_b64_tr_b16 v[72:73], v144 offset:4096
ds_read_b64_tr_b16 v[74:75], v144 offset:4608
v_mfma_f32_32x32x16_bf16 v[24:39], v[80:83], a[108:111], v[24:39]
ds_read_b64_tr_b16 v[76:77], v145 offset:4096
ds_read_b64_tr_b16 v[78:79], v145 offset:4608
v_mfma_f32_32x32x16_bf16 v[40:55], v[84:87], a[104:107], v[40:55]
ds_write_b128 v146, a[192:195] offset:0
buffer_load_dwordx4 a[184:187], v6, s[40:43], s90 offen offset:2048 sc1
v_mfma_f32_32x32x16_bf16 v[56:71], v[84:87], a[108:111], v[56:71]
ds_write_b128 v146, a[196:199] offset:1024
buffer_load_dwordx4 a[188:191], v6, s[40:43], s91 offen offset:2048 sc1
s_waitcnt lgkmcnt(8)
s_waitcnt vmcnt(18)
v_mfma_f32_32x32x16_bf16 v[8:23], v[88:91], a[112:115], v[8:23]
ds_read_b64_tr_b16 v[80:81], v144 offset:6144
ds_read_b64_tr_b16 v[82:83], v144 offset:6656
v_mfma_f32_32x32x16_bf16 v[24:39], v[88:91], a[116:119], v[24:39]
ds_read_b64_tr_b16 v[84:85], v145 offset:6144
ds_read_b64_tr_b16 v[86:87], v145 offset:6656
v_mfma_f32_32x32x16_bf16 v[40:55], v[92:95], a[112:115], v[40:55]
ds_write_b128 v146, a[200:203] offset:2048
buffer_load_dwordx4 a[192:195], v6, s[40:43], s90 offen offset:3072 sc1
s_add_u32 s90, s90, 4096
v_mfma_f32_32x32x16_bf16 v[56:71], v[92:95], a[116:119], v[56:71]
ds_write_b128 v146, a[204:207] offset:3072
buffer_load_dwordx4 a[196:199], v6, s[40:43], s91 offen offset:3072 sc1
s_add_u32 s91, s91, 4096
s_waitcnt lgkmcnt(8)
s_waitcnt vmcnt(18)
v_mfma_f32_32x32x16_bf16 v[8:23], v[72:75], a[120:123], v[8:23]
ds_read_b64_tr_b16 v[88:89], v144 offset:8192
ds_read_b64_tr_b16 v[90:91], v144 offset:8704
v_mfma_f32_32x32x16_bf16 v[24:39], v[72:75], a[124:127], v[24:39]
ds_read_b64_tr_b16 v[92:93], v145 offset:8192
ds_read_b64_tr_b16 v[94:95], v145 offset:8704
v_mfma_f32_32x32x16_bf16 v[40:55], v[76:79], a[120:123], v[40:55]
ds_write_b128 v146, a[208:211] offset:4096
buffer_load_dwordx4 a[200:203], v6, s[40:43], s90 offen offset:0 sc1
v_mfma_f32_32x32x16_bf16 v[56:71], v[76:79], a[124:127], v[56:71]
ds_write_b128 v146, a[212:215] offset:5120
buffer_load_dwordx4 a[204:207], v6, s[40:43], s91 offen offset:0 sc1
s_waitcnt lgkmcnt(8)
s_waitcnt vmcnt(18)
v_mfma_f32_32x32x16_bf16 v[8:23], v[80:83], a[128:131], v[8:23]
ds_read_b64_tr_b16 v[72:73], v144 offset:10240
ds_read_b64_tr_b16 v[74:75], v144 offset:10752
v_mfma_f32_32x32x16_bf16 v[24:39], v[80:83], a[132:135], v[24:39]
ds_read_b64_tr_b16 v[76:77], v145 offset:10240
ds_read_b64_tr_b16 v[78:79], v145 offset:10752
v_mfma_f32_32x32x16_bf16 v[40:55], v[84:87], a[128:131], v[40:55]
ds_write_b128 v146, a[216:219] offset:6144
buffer_load_dwordx4 a[208:211], v6, s[40:43], s90 offen offset:1024 sc1
v_mfma_f32_32x32x16_bf16 v[56:71], v[84:87], a[132:135], v[56:71]
ds_write_b128 v146, a[220:223] offset:7168
buffer_load_dwordx4 a[212:215], v6, s[40:43], s91 offen offset:1024 sc1
s_waitcnt lgkmcnt(8)
s_waitcnt vmcnt(18)
v_mfma_f32_32x32x16_bf16 v[8:23], v[88:91], a[136:139], v[8:23]
ds_read_b64_tr_b16 v[80:81], v144 offset:12288
ds_read_b64_tr_b16 v[82:83], v144 offset:12800
v_mfma_f32_32x32x16_bf16 v[24:39], v[88:91], a[140:143], v[24:39]
ds_read_b64_tr_b16 v[84:85], v145 offset:12288
ds_read_b64_tr_b16 v[86:87], v145 offset:12800
v_mfma_f32_32x32x16_bf16 v[40:55], v[92:95], a[136:139], v[40:55]
ds_write_b128 v146, a[224:227] offset:8192
buffer_load_dwordx4 a[216:219], v6, s[40:43], s90 offen offset:2048 sc1
v_mfma_f32_32x32x16_bf16 v[56:71], v[92:95], a[140:143], v[56:71]
ds_write_b128 v146, a[228:231] offset:9216
buffer_load_dwordx4 a[220:223], v6, s[40:43], s91 offen offset:2048 sc1
s_waitcnt lgkmcnt(8)
s_waitcnt vmcnt(18)
v_mfma_f32_32x32x16_bf16 v[8:23], v[72:75], a[144:147], v[8:23]
ds_read_b64_tr_b16 v[88:89], v144 offset:14336
ds_read_b64_tr_b16 v[90:91], v144 offset:14848
v_mfma_f32_32x32x16_bf16 v[24:39], v[72:75], a[148:151], v[24:39]
ds_read_b64_tr_b16 v[92:93], v145 offset:14336
ds_read_b64_tr_b16 v[94:95], v145 offset:14848
v_mfma_f32_32x32x16_bf16 v[40:55], v[76:79], a[144:147], v[40:55]
ds_write_b128 v146, a[232:235] offset:10240
buffer_load_dwordx4 a[224:227], v6, s[40:43], s90 offen offset:3072 sc1
s_add_u32 s90, s90, 4096
v_mfma_f32_32x32x16_bf16 v[56:71], v[76:79], a[148:151], v[56:71]
ds_write_b128 v146, a[236:239] offset:11264
buffer_load_dwordx4 a[228:231], v6, s[40:43], s91 offen offset:3072 sc1
s_add_u32 s91, s91, 4096
s_waitcnt lgkmcnt(8)
s_waitcnt vmcnt(18)
v_mfma_f32_32x32x16_bf16 v[8:23], v[80:83], a[152:155], v[8:23]
ds_read_b64_tr_b16 v[72:73], v144 offset:0
ds_read_b64_tr_b16 v[74:75], v144 offset:512
v_mfma_f32_32x32x16_bf16 v[24:39], v[80:83], a[156:159], v[24:39]
ds_read_b64_tr_b16 v[76:77], v145 offset:0
ds_read_b64_tr_b16 v[78:79], v145 offset:512
v_mfma_f32_32x32x16_bf16 v[40:55], v[84:87], a[152:155], v[40:55]
ds_write_b128 v146, a[240:243] offset:12288
v_mfma_f32_32x32x16_bf16 v[56:71], v[84:87], a[156:159], v[56:71]
ds_write_b128 v146, a[244:247] offset:13312
s_waitcnt lgkmcnt(8)
s_waitcnt vmcnt(16)
v_mfma_f32_32x32x16_bf16 v[8:23], v[88:91], a[160:163], v[8:23]
ds_read_b64_tr_b16 v[80:81], v144 offset:2048
ds_read_b64_tr_b16 v[82:83], v144 offset:2560
v_mfma_f32_32x32x16_bf16 v[24:39], v[88:91], a[164:167], v[24:39]
ds_read_b64_tr_b16 v[84:85], v145 offset:2048
ds_read_b64_tr_b16 v[86:87], v145 offset:2560
v_mfma_f32_32x32x16_bf16 v[40:55], v[92:95], a[160:163], v[40:55]
ds_write_b128 v146, a[248:251] offset:14336
v_mfma_f32_32x32x16_bf16 v[56:71], v[92:95], a[164:167], v[56:71]
ds_write_b128 v146, a[252:255] offset:15360
s_waitcnt lgkmcnt(8)
s_waitcnt vmcnt(14)
v_mfma_f32_32x32x16_bf16 v[8:23], v[72:75], a[168:171], v[8:23]
ds_read_b64_tr_b16 v[88:89], v144 offset:4096
ds_read_b64_tr_b16 v[90:91], v144 offset:4608
v_mfma_f32_32x32x16_bf16 v[24:39], v[72:75], a[172:175], v[24:39]
ds_read_b64_tr_b16 v[92:93], v145 offset:4096
ds_read_b64_tr_b16 v[94:95], v145 offset:4608
v_mfma_f32_32x32x16_bf16 v[40:55], v[76:79], a[168:171], v[40:55]
v_mfma_f32_32x32x16_bf16 v[56:71], v[76:79], a[172:175], v[56:71]
s_waitcnt lgkmcnt(6)
s_waitcnt vmcnt(12)
v_mfma_f32_32x32x16_bf16 v[8:23], v[80:83], a[176:179], v[8:23]
ds_read_b64_tr_b16 v[72:73], v144 offset:6144
ds_read_b64_tr_b16 v[74:75], v144 offset:6656
v_mfma_f32_32x32x16_bf16 v[24:39], v[80:83], a[180:183], v[24:39]
ds_read_b64_tr_b16 v[76:77], v145 offset:6144
ds_read_b64_tr_b16 v[78:79], v145 offset:6656
v_mfma_f32_32x32x16_bf16 v[40:55], v[84:87], a[176:179], v[40:55]
v_mfma_f32_32x32x16_bf16 v[56:71], v[84:87], a[180:183], v[56:71]
s_waitcnt lgkmcnt(4)
s_waitcnt vmcnt(10)
v_mfma_f32_32x32x16_bf16 v[8:23], v[88:91], a[184:187], v[8:23]
ds_read_b64_tr_b16 v[80:81], v144 offset:8192
ds_read_b64_tr_b16 v[82:83], v144 offset:8704
v_mfma_f32_32x32x16_bf16 v[24:39], v[88:91], a[188:191], v[24:39]
ds_read_b64_tr_b16 v[84:85], v145 offset:8192
ds_read_b64_tr_b16 v[86:87], v145 offset:8704
v_mfma_f32_32x32x16_bf16 v[40:55], v[92:95], a[184:187], v[40:55]
v_mfma_f32_32x32x16_bf16 v[56:71], v[92:95], a[188:191], v[56:71]
s_waitcnt lgkmcnt(4)
s_waitcnt vmcnt(8)
v_mfma_f32_32x32x16_bf16 v[8:23], v[72:75], a[192:195], v[8:23]
ds_read_b64_tr_b16 v[88:89], v144 offset:10240
ds_read_b64_tr_b16 v[90:91], v144 offset:10752
v_mfma_f32_32x32x16_bf16 v[24:39], v[72:75], a[196:199], v[24:39]
ds_read_b64_tr_b16 v[92:93], v145 offset:10240
ds_read_b64_tr_b16 v[94:95], v145 offset:10752
v_mfma_f32_32x32x16_bf16 v[40:55], v[76:79], a[192:195], v[40:55]
v_mfma_f32_32x32x16_bf16 v[56:71], v[76:79], a[196:199], v[56:71]
s_waitcnt lgkmcnt(4)
s_waitcnt vmcnt(6)
v_mfma_f32_32x32x16_bf16 v[8:23], v[80:83], a[200:203], v[8:23]
ds_read_b64_tr_b16 v[72:73], v144 offset:12288
ds_read_b64_tr_b16 v[74:75], v144 offset:12800
v_mfma_f32_32x32x16_bf16 v[24:39], v[80:83], a[204:207], v[24:39]
ds_read_b64_tr_b16 v[76:77], v145 offset:12288
ds_read_b64_tr_b16 v[78:79], v145 offset:12800
v_mfma_f32_32x32x16_bf16 v[40:55], v[84:87], a[200:203], v[40:55]
v_mfma_f32_32x32x16_bf16 v[56:71], v[84:87], a[204:207], v[56:71]
s_waitcnt lgkmcnt(4)
s_waitcnt vmcnt(4)
v_mfma_f32_32x32x16_bf16 v[8:23], v[88:91], a[208:211], v[8:23]
ds_read_b64_tr_b16 v[80:81], v144 offset:14336
ds_read_b64_tr_b16 v[82:83], v144 offset:14848
v_mfma_f32_32x32x16_bf16 v[24:39], v[88:91], a[212:215], v[24:39]
ds_read_b64_tr_b16 v[84:85], v145 offset:14336
ds_read_b64_tr_b16 v[86:87], v145 offset:14848
v_mfma_f32_32x32x16_bf16 v[40:55], v[92:95], a[208:211], v[40:55]
v_mfma_f32_32x32x16_bf16 v[56:71], v[92:95], a[212:215], v[56:71]
s_waitcnt lgkmcnt(4)
s_waitcnt vmcnt(2)
v_mfma_f32_32x32x16_bf16 v[8:23], v[72:75], a[216:219], v[8:23]
v_mfma_f32_32x32x16_bf16 v[24:39], v[72:75], a[220:223], v[24:39]
v_mfma_f32_32x32x16_bf16 v[40:55], v[76:79], a[216:219], v[40:55]
v_mfma_f32_32x32x16_bf16 v[56:71], v[76:79], a[220:223], v[56:71]
s_waitcnt lgkmcnt(0)
s_waitcnt vmcnt(0)
v_mfma_f32_32x32x16_bf16 v[8:23], v[80:83], a[224:227], v[8:23]
v_mfma_f32_32x32x16_bf16 v[24:39], v[80:83], a[228:231], v[24:39]
v_mfma_f32_32x32x16_bf16 v[40:55], v[84:87], a[224:227], v[40:55]
v_mfma_f32_32x32x16_bf16 v[56:71], v[84:87], a[228:231], v[56:71]
buffer_load_dwordx4 a[240:243], v138, s[24:27], s86 offen
buffer_load_dwordx4 a[244:247], v139, s[24:27], s86 offen offset:1024
s_add_u32 s86, s86, 65536
buffer_load_dwordx4 a[248:251], v138, s[24:27], s86 offen
buffer_load_dwordx4 a[252:255], v139, s[24:27], s86 offen offset:1024
s_add_u32 s86, s86, 65536
s_barrier
s_nop 4
s_cmp_lg_u32 s3, 0
s_cbranch_scc1 L_rw_20
v_add_u32 v1, 87040, v6
ds_write_b128 v1, v[24:27] offset:0
v_lshlrev_b32 v72, 16, v136
v_and_b32 v73, s83, v136
ds_write_b128 v1, v[28:31] offset:1024
v_lshlrev_b32 v74, 16, v137
v_and_b32 v75, s83, v137
ds_write_b128 v1, v[32:35] offset:2048
v_lshlrev_b32 v76, 16, v140
v_and_b32 v77, s83, v140
ds_write_b128 v1, v[36:39] offset:3072
v_lshlrev_b32 v78, 16, v141
v_and_b32 v79, s83, v141
v_add_u32 v1, 95232, v6
ds_write_b128 v1, v[40:43] offset:0
v_lshlrev_b32 v80, 16, v142
v_and_b32 v81, s83, v142
ds_write_b128 v1, v[44:47] offset:1024
v_lshlrev_b32 v82, 16, v143
v_and_b32 v83, s83, v143
ds_write_b128 v1, v[48:51] offset:2048
v_lshlrev_b32 v84, 16, v126
v_and_b32 v85, s83, v126
ds_write_b128 v1, v[52:55] offset:3072
v_lshlrev_b32 v86, 16, v127
v_and_b32 v87, s83, v127
v_add_u32 v1, 103424, v6
ds_write_b128 v1, v[56:59] offset:0
ds_write_b128 v1, v[60:63] offset:1024
ds_write_b128 v1, v[64:67] offset:2048
ds_write_b128 v1, v[68:71] offset:3072
s_nop 1
v_pk_add_f32 v[8:9], v[8:9], v[72:73]
v_pk_add_f32 v[10:11], v[10:11], v[74:75]
v_pk_add_f32 v[12:13], v[12:13], v[76:77]
v_pk_add_f32 v[14:15], v[14:15], v[78:79]
v_pk_add_f32 v[16:17], v[16:17], v[80:81]
v_pk_add_f32 v[18:19], v[18:19], v[82:83]
v_pk_add_f32 v[20:21], v[20:21], v[84:85]
v_pk_add_f32 v[22:23], v[22:23], v[86:87]
s_branch L_red_19
L_rw_20:
s_cmp_lg_u32 s3, 1
s_cbranch_scc1 L_rw_21
v_add_u32 v1, 66560, v6
ds_write_b128 v1, v[8:11] offset:0
v_lshlrev_b32 v72, 16, v136
v_and_b32 v73, s83, v136
ds_write_b128 v1, v[12:15] offset:1024
v_lshlrev_b32 v74, 16, v137
v_and_b32 v75, s83, v137
ds_write_b128 v1, v[16:19] offset:2048
v_lshlrev_b32 v76, 16, v140
v_and_b32 v77, s83, v140
ds_write_b128 v1, v[20:23] offset:3072
v_lshlrev_b32 v78, 16, v141
v_and_b32 v79, s83, v141
v_add_u32 v1, 99328, v6
ds_write_b128 v1, v[40:43] offset:0
v_lshlrev_b32 v80, 16, v142
v_and_b32 v81, s83, v142
ds_write_b128 v1, v[44:47] offset:1024
v_lshlrev_b32 v82, 16, v143
v_and_b32 v83, s83, v143
ds_write_b128 v1, v[48:51] offset:2048
v_lshlrev_b32 v84, 16, v126
v_and_b32 v85, s83, v126
ds_write_b128 v1, v[52:55] offset:3072
v_lshlrev_b32 v86, 16, v127
v_and_b32 v87, s83, v127
v_add_u32 v1, 107520, v6
ds_write_b128 v1, v[56:59] offset:0
ds_write_b128 v1, v[60:63] offset:1024
ds_write_b128 v1, v[64:67] offset:2048
ds_write_b128 v1, v[68:71] offset:3072
s_nop 1
v_pk_add_f32 v[8:9], v[24:25], v[72:73]
v_pk_add_f32 v[10:11], v[26:27], v[74:75]
v_pk_add_f32 v[12:13], v[28:29], v[76:77]
v_pk_add_f32 v[14:15], v[30:31], v[78:79]
v_pk_add_f32 v[16:17], v[32:33], v[80:81]
v_pk_add_f32 v[18:19], v[34:35], v[82:83]
v_pk_add_f32 v[20:21], v[36:37], v[84:85]
v_pk_add_f32 v[22:23], v[38:39], v[86:87]
s_branch L_red_19
L_rw_21:
s_cmp_lg_u32 s3, 2
s_cbranch_scc1 L_rw_22
v_add_u32 v1, 70656, v6
ds_write_b128 v1, v[8:11] offset:0
v_lshlrev_b32 v72, 16, v136
v_and_b32 v73, s83, v136
ds_write_b128 v1, v[12:15] offset:1024
v_lshlrev_b32 v74, 16, v137
v_and_b32 v75, s83, v137
ds_write_b128 v1, v[16:19] offset:2048
v_lshlrev_b32 v76, 16, v140
v_and_b32 v77, s83, v140
ds_write_b128 v1, v[20:23] offset:3072
v_lshlrev_b32 v78, 16, v141
v_and_b32 v79, s83, v141
v_add_u32 v1, 78848, v6
ds_write_b128 v1, v[24:27] offset:0
v_lshlrev_b32 v80, 16, v142
v_and_b32 v81, s83, v142
ds_write_b128 v1, v[28:31] offset:1024
v_lshlrev_b32 v82, 16, v143
v_and_b32 v83, s83, v143
ds_write_b128 v1, v[32:35] offset:2048
v_lshlrev_b32 v84, 16, v126
v_and_b32 v85, s83, v126
ds_write_b128 v1, v[36:39] offset:3072
v_lshlrev_b32 v86, 16, v127
v_and_b32 v87, s83, v127
v_add_u32 v1, 111616, v6
ds_write_b128 v1, v[56:59] offset:0
ds_write_b128 v1, v[60:63] offset:1024
ds_write_b128 v1, v[64:67] offset:2048
ds_write_b128 v1, v[68:71] offset:3072
s_nop 1
v_pk_add_f32 v[8:9], v[40:41], v[72:73]
v_pk_add_f32 v[10:11], v[42:43], v[74:75]
v_pk_add_f32 v[12:13], v[44:45], v[76:77]
v_pk_add_f32 v[14:15], v[46:47], v[78:79]
v_pk_add_f32 v[16:17], v[48:49], v[80:81]
v_pk_add_f32 v[18:19], v[50:51], v[82:83]
v_pk_add_f32 v[20:21], v[52:53], v[84:85]
v_pk_add_f32 v[22:23], v[54:55], v[86:87]
s_branch L_red_19
L_rw_22:
v_add_u32 v1, 74752, v6
ds_write_b128 v1, v[8:11] offset:0
v_lshlrev_b32 v72, 16, v136
v_and_b32 v73, s83, v136
ds_write_b128 v1, v[12:15] offset:1024
v_lshlrev_b32 v74, 16, v137
v_and_b32 v75, s83, v137
ds_write_b128 v1, v[16:19] offset:2048
v_lshlrev_b32 v76, 16, v140
v_and_b32 v77, s83, v140
ds_write_b128 v1, v[20:23] offset:3072
v_lshlrev_b32 v78, 16, v141
v_and_b32 v79, s83, v141
v_add_u32 v1, 82944, v6
ds_write_b128 v1, v[24:27] offset:0
v_lshlrev_b32 v80, 16, v142
v_and_b32 v81, s83, v142
ds_write_b128 v1, v[28:31] offset:1024
v_lshlrev_b32 v82, 16, v143
v_and_b32 v83, s83, v143
ds_write_b128 v1, v[32:35] offset:2048
v_lshlrev_b32 v84, 16, v126
v_and_b32 v85, s83, v126
ds_write_b128 v1, v[36:39] offset:3072
v_lshlrev_b32 v86, 16, v127
v_and_b32 v87, s83, v127
v_add_u32 v1, 91136, v6
ds_write_b128 v1, v[40:43] offset:0
ds_write_b128 v1, v[44:47] offset:1024
ds_write_b128 v1, v[48:51] offset:2048
ds_write_b128 v1, v[52:55] offset:3072
s_nop 1
v_pk_add_f32 v[8:9], v[56:57], v[72:73]
v_pk_add_f32 v[10:11], v[58:59], v[74:75]
v_pk_add_f32 v[12:13], v[60:61], v[76:77]
v_pk_add_f32 v[14:15], v[62:63], v[78:79]
v_pk_add_f32 v[16:17], v[64:65], v[80:81]
v_pk_add_f32 v[18:19], v[66:67], v[82:83]
v_pk_add_f32 v[20:21], v[68:69], v[84:85]
v_pk_add_f32 v[22:23], v[70:71], v[86:87]
L_red_19:
s_mul_i32 s48, s3, 12288
s_add_u32 s48, s48, 66560
v_add_u32 v1, s48, v6
s_waitcnt lgkmcnt(0)
s_barrier
ds_read_b128 v[72:75], v1 offset:0
ds_read_b128 v[76:79], v1 offset:1024
ds_read_b128 v[80:83], v1 offset:2048
ds_read_b128 v[84:87], v1 offset:3072
ds_read_b128 v[88:91], v1 offset:4096
ds_read_b128 v[92:95], v1 offset:5120
ds_read_b128 v[96:99], v1 offset:6144
ds_read_b128 v[100:103], v1 offset:7168
ds_read_b128 v[104:107], v1 offset:8192
ds_read_b128 v[108:111], v1 offset:9216
ds_read_b128 v[112:115], v1 offset:10240
ds_read_b128 v[116:119], v1 offset:11264
s_waitcnt lgkmcnt(4)
v_pk_add_f32 v[72:73], v[72:73], v[88:89]
v_pk_add_f32 v[74:75], v[74:75], v[90:91]
v_pk_add_f32 v[76:77], v[76:77], v[92:93]
v_pk_add_f32 v[78:79], v[78:79], v[94:95]
v_pk_add_f32 v[80:81], v[80:81], v[96:97]
v_pk_add_f32 v[82:83], v[82:83], v[98:99]
v_pk_add_f32 v[84:85], v[84:85], v[100:101]
v_pk_add_f32 v[86:87], v[86:87], v[102:103]
v_pk_add_f32 v[8:9], v[8:9], v[72:73]
v_pk_add_f32 v[10:11], v[10:11], v[74:75]
v_pk_add_f32 v[12:13], v[12:13], v[76:77]
v_pk_add_f32 v[14:15], v[14:15], v[78:79]
v_pk_add_f32 v[16:17], v[16:17], v[80:81]
v_pk_add_f32 v[18:19], v[18:19], v[82:83]
v_pk_add_f32 v[20:21], v[20:21], v[84:85]
v_pk_add_f32 v[22:23], v[22:23], v[86:87]
s_waitcnt lgkmcnt(0)
v_pk_add_f32 v[8:9], v[8:9], v[104:105]
v_pk_add_f32 v[10:11], v[10:11], v[106:107]
v_pk_add_f32 v[12:13], v[12:13], v[108:109]
v_pk_add_f32 v[14:15], v[14:15], v[110:111]
v_pk_add_f32 v[16:17], v[16:17], v[112:113]
v_pk_add_f32 v[18:19], v[18:19], v[114:115]
v_pk_add_f32 v[20:21], v[20:21], v[116:117]
v_pk_add_f32 v[22:23], v[22:23], v[118:119]
v_mov_b32 v2, 0xc0135761
v_mov_b32 v4, 0xbdd2d3e8
v_pk_mul_f32 v[72:73], v[8:9], v[8:9]
v_pk_mul_f32 v[74:75], v[10:11], v[10:11]
v_pk_mul_f32 v[76:77], v[12:13], v[12:13]
v_pk_mul_f32 v[78:79], v[14:15], v[14:15]
v_pk_mul_f32 v[80:81], v[16:17], v[16:17]
v_pk_mul_f32 v[82:83], v[18:19], v[18:19]
v_pk_mul_f32 v[84:85], v[20:21], v[20:21]
v_pk_mul_f32 v[86:87], v[22:23], v[22:23]
v_pk_fma_f32 v[72:73], v[72:73], v[4:5], v[2:3] op_sel_hi:[1,0,0]
v_pk_fma_f32 v[74:75], v[74:75], v[4:5], v[2:3] op_sel_hi:[1,0,0]
v_pk_fma_f32 v[76:77], v[76:77], v[4:5], v[2:3] op_sel_hi:[1,0,0]
v_pk_fma_f32 v[78:79], v[78:79], v[4:5], v[2:3] op_sel_hi:[1,0,0]
v_pk_fma_f32 v[80:81], v[80:81], v[4:5], v[2:3] op_sel_hi:[1,0,0]
v_pk_fma_f32 v[82:83], v[82:83], v[4:5], v[2:3] op_sel_hi:[1,0,0]
v_pk_fma_f32 v[84:85], v[84:85], v[4:5], v[2:3] op_sel_hi:[1,0,0]
v_pk_fma_f32 v[86:87], v[86:87], v[4:5], v[2:3] op_sel_hi:[1,0,0]
v_pk_mul_f32 v[72:73], v[72:73], v[8:9]
v_pk_mul_f32 v[74:75], v[74:75], v[10:11]
v_pk_mul_f32 v[76:77], v[76:77], v[12:13]
v_pk_mul_f32 v[78:79], v[78:79], v[14:15]
v_pk_mul_f32 v[80:81], v[80:81], v[16:17]
v_pk_mul_f32 v[82:83], v[82:83], v[18:19]
v_pk_mul_f32 v[84:85], v[84:85], v[20:21]
v_pk_mul_f32 v[86:87], v[86:87], v[22:23]
v_exp_f32 v72, v72
v_exp_f32 v73, v73
v_exp_f32 v74, v74
v_exp_f32 v75, v75
v_exp_f32 v76, v76
v_exp_f32 v77, v77
v_exp_f32 v78, v78
v_exp_f32 v79, v79
v_exp_f32 v80, v80
v_exp_f32 v81, v81
v_exp_f32 v82, v82
v_exp_f32 v83, v83
v_exp_f32 v84, v84
v_exp_f32 v85, v85
v_exp_f32 v86, v86
v_exp_f32 v87, v87
v_pk_add_f32 v[72:73], v[72:73], 1.0 op_sel_hi:[1,0]
v_pk_add_f32 v[74:75], v[74:75], 1.0 op_sel_hi:[1,0]
v_pk_add_f32 v[76:77], v[76:77], 1.0 op_sel_hi:[1,0]
v_pk_add_f32 v[78:79], v[78:79], 1.0 op_sel_hi:[1,0]
v_pk_add_f32 v[80:81], v[80:81], 1.0 op_sel_hi:[1,0]
v_pk_add_f32 v[82:83], v[82:83], 1.0 op_sel_hi:[1,0]
v_pk_add_f32 v[84:85], v[84:85], 1.0 op_sel_hi:[1,0]
v_pk_add_f32 v[86:87], v[86:87], 1.0 op_sel_hi:[1,0]
v_rcp_f32 v72, v72
v_rcp_f32 v73, v73
v_rcp_f32 v74, v74
v_rcp_f32 v75, v75
v_rcp_f32 v76, v76
v_rcp_f32 v77, v77
v_rcp_f32 v78, v78
v_rcp_f32 v79, v79
v_rcp_f32 v80, v80
v_rcp_f32 v81, v81
v_rcp_f32 v82, v82
v_rcp_f32 v83, v83
v_rcp_f32 v84, v84
v_rcp_f32 v85, v85
v_rcp_f32 v86, v86
v_rcp_f32 v87, v87
v_pk_mul_f32 v[8:9], v[8:9], v[72:73]
v_pk_mul_f32 v[10:11], v[10:11], v[74:75]
v_pk_mul_f32 v[12:13], v[12:13], v[76:77]
v_pk_mul_f32 v[14:15], v[14:15], v[78:79]
v_pk_mul_f32 v[16:17], v[16:17], v[80:81]
v_pk_mul_f32 v[18:19], v[18:19], v[82:83]
v_pk_mul_f32 v[20:21], v[20:21], v[84:85]
v_pk_mul_f32 v[22:23], v[22:23], v[86:87]
v_cvt_pk_bf16_f32 v96, v8, v9
v_cvt_pk_bf16_f32 v97, v10, v11
v_cvt_pk_bf16_f32 v98, v12, v13
v_cvt_pk_bf16_f32 v99, v14, v15
v_cvt_pk_bf16_f32 v100, v16, v17
v_cvt_pk_bf16_f32 v101, v18, v19
v_cvt_pk_bf16_f32 v102, v20, v21
v_cvt_pk_bf16_f32 v103, v22, v23
s_cmp_lg_u32 s93, 43
s_cbranch_scc1 L_nz_24
v_mov_b32 v96, 0
v_mov_b32 v97, 0
v_mov_b32 v98, 0
v_mov_b32 v99, 0
v_mov_b32 v100, 0
v_mov_b32 v101, 0
v_mov_b32 v102, 0
v_mov_b32 v103, 0
L_nz_24:
s_lshl_b32 s67, s65, 8
s_add_u32 s67, s67, 16384
buffer_store_dwordx4 v[96:99], v6, s[40:43], s94 offen offset:0 sc1
buffer_store_dwordx4 v[100:103], v6, s[40:43], s94 offen offset:1024 sc1
s_branch L_p4_join
L_p4_skip:
buffer_load_dwordx4 a[240:243], v138, s[24:27], s86 offen
buffer_load_dwordx4 a[244:247], v139, s[24:27], s86 offen offset:1024
s_add_u32 s86, s86, 65536
buffer_load_dwordx4 a[248:251], v138, s[24:27], s86 offen
buffer_load_dwordx4 a[252:255], v139, s[24:27], s86 offen offset:1024
s_add_u32 s86, s86, 65536
L_p4_join:
s_nop 0
s_cmp_ge_u32 s47, 22
s_cbranch_scc1 L_noarr_25
s_waitcnt vmcnt(0)
s_barrier
s_cmp_lg_u32 s3, 0
s_cbranch_scc1 L_w0_26
s_mov_b64 exec, 1
v_mov_b32 v1, 1
v_mov_b32 v2, s67
buffer_atomic_add v1, v2, s[40:43], 0 offen sc1
s_mov_b64 exec, -1
L_w0_26:
L_noarr_25:
ds_write_b128 v150, v[152:155] offset:0
ds_write_b128 v150, v[156:159] offset:1024
ds_write_b128 v150, v[160:163] offset:2048
ds_write_b128 v150, v[164:167] offset:3072
ds_write_b128 v150, v[168:171] offset:4096
ds_write_b128 v150, v[172:175] offset:5120
ds_write_b128 v150, v[176:179] offset:6144
ds_write_b128 v150, v[180:183] offset:7168
ds_read_b64_tr_b16 v[72:73], v120 offset:0
ds_read_b64_tr_b16 v[74:75], v120 offset:1024
ds_read_b64_tr_b16 v[76:77], v121 offset:0
ds_read_b64_tr_b16 v[78:79], v121 offset:1024
ds_read_b64_tr_b16 v[80:81], v120 offset:2048
ds_read_b64_tr_b16 v[82:83], v120 offset:3072
ds_read_b64_tr_b16 v[84:85], v121 offset:2048
ds_read_b64_tr_b16 v[86:87], v121 offset:3072
s_waitcnt vmcnt(0)
s_waitcnt lgkmcnt(0)
s_cmp_lg_u32 s3, 0
s_cbranch_scc1 L_w0_27
v_mov_b32 v2, s98
s_mov_b32 s76, 0
L_poll_28:
buffer_load_dword v1, v2, s[40:43], 0 offen sc1
s_add_u32 s76, s76, 1
s_waitcnt vmcnt(0)
v_readfirstlane_b32 s48, v1
s_nop 2
s_cmp_ge_u32 s48, 22
s_cbranch_scc1 L_w0_27
s_cmp_lt_u32 s76, 0x40000
s_cbranch_scc1 L_poll_28
L_w0_27:
s_barrier
buffer_load_dwordx4 a[0:3], v6, s[40:43], s96 offen offset:0 sc1
buffer_load_dwordx4 a[4:7], v6, s[40:43], s97 offen offset:0 sc1
buffer_load_dwordx4 a[8:11], v6, s[40:43], s96 offen offset:1024 sc1
buffer_load_dwordx4 a[12:15], v6, s[40:43], s97 offen offset:1024 sc1
buffer_load_dwordx4 a[16:19], v6, s[40:43], s96 offen offset:2048 sc1
buffer_load_dwordx4 a[20:23], v6, s[40:43], s97 offen offset:2048 sc1
buffer_load_dwordx4 a[24:27], v6, s[40:43], s96 offen offset:3072 sc1
s_add_u32 s96, s96, 4096
buffer_load_dwordx4 a[28:31], v6, s[40:43], s97 offen offset:3072 sc1
s_add_u32 s97, s97, 4096
buffer_load_dwordx4 a[32:35], v6, s[40:43], s96 offen offset:0 sc1
buffer_load_dwordx4 a[36:39], v6, s[40:43], s97 offen offset:0 sc1
buffer_load_dwordx4 a[40:43], v6, s[40:43], s96 offen offset:1024 sc1
buffer_load_dwordx4 a[44:47], v6, s[40:43], s97 offen offset:1024 sc1
s_waitcnt lgkmcnt(0)
s_waitcnt vmcnt(10)
v_mfma_f32_32x32x16_bf16 v[8:23], a[0:3], v[72:75], 0
ds_read_b64_tr_b16 v[88:89], v120 offset:4096
ds_read_b64_tr_b16 v[90:91], v120 offset:5120
buffer_load_dwordx4 a[48:51], v6, s[40:43], s96 offen offset:2048 sc1
v_mfma_f32_32x32x16_bf16 v[24:39], a[4:7], v[72:75], 0
ds_read_b64_tr_b16 v[92:93], v121 offset:4096
ds_read_b64_tr_b16 v[94:95], v121 offset:5120
buffer_load_dwordx4 a[52:55], v6, s[40:43], s97 offen offset:2048 sc1
v_mfma_f32_32x32x16_bf16 v[40:55], a[0:3], v[76:79], 0
ds_write_b128 v150, v[184:187] offset:0
buffer_load_dwordx4 a[56:59], v6, s[40:43], s96 offen offset:3072 sc1
s_add_u32 s96, s96, 4096
v_mfma_f32_32x32x16_bf16 v[56:71], a[4:7], v[76:79], 0
ds_write_b128 v150, v[188:191] offset:1024
buffer_load_dwordx4 a[60:63], v6, s[40:43], s97 offen offset:3072 sc1
s_add_u32 s97, s97, 4096
s_waitcnt lgkmcnt(6)
s_waitcnt vmcnt(12)
v_mfma_f32_32x32x16_bf16 v[8:23], a[8:11], v[80:83], v[8:23]
ds_read_b64_tr_b16 v[72:73], v120 offset:6144
ds_read_b64_tr_b16 v[74:75], v120 offset:7168
buffer_load_dwordx4 a[64:67], v6, s[40:43], s96 offen offset:0 sc1
v_mfma_f32_32x32x16_bf16 v[24:39], a[12:15], v[80:83], v[24:39]
ds_read_b64_tr_b16 v[76:77], v121 offset:6144
ds_read_b64_tr_b16 v[78:79], v121 offset:7168
buffer_load_dwordx4 a[68:71], v6, s[40:43], s97 offen offset:0 sc1
v_mfma_f32_32x32x16_bf16 v[40:55], a[8:11], v[84:87], v[40:55]
ds_write_b128 v150, v[192:195] offset:2048
buffer_load_dwordx4 a[72:75], v6, s[40:43], s96 offen offset:1024 sc1
v_mfma_f32_32x32x16_bf16 v[56:71], a[12:15], v[84:87], v[56:71]
ds_write_b128 v150, v[196:199] offset:3072
buffer_load_dwordx4 a[76:79], v6, s[40:43], s97 offen offset:1024 sc1
s_waitcnt lgkmcnt(8)
s_waitcnt vmcnt(14)
v_mfma_f32_32x32x16_bf16 v[8:23], a[16:19], v[88:91], v[8:23]
ds_read_b64_tr_b16 v[80:81], v120 offset:0
ds_read_b64_tr_b16 v[82:83], v120 offset:1024
v_mfma_f32_32x32x16_bf16 v[24:39], a[20:23], v[88:91], v[24:39]
ds_read_b64_tr_b16 v[84:85], v121 offset:0
ds_read_b64_tr_b16 v[86:87], v121 offset:1024
v_mfma_f32_32x32x16_bf16 v[40:55], a[16:19], v[92:95], v[40:55]
ds_write_b128 v150, v[200:203] offset:4096
buffer_load_dwordx4 a[80:83], v6, s[40:43], s96 offen offset:2048 sc1
v_mfma_f32_32x32x16_bf16 v[56:71], a[20:23], v[92:95], v[56:71]
ds_write_b128 v150, v[204:207] offset:5120
buffer_load_dwordx4 a[84:87], v6, s[40:43], s97 offen offset:2048 sc1
s_waitcnt lgkmcnt(8)
s_waitcnt vmcnt(14)
v_mfma_f32_32x32x16_bf16 v[8:23], a[24:27], v[72:75], v[8:23]
ds_read_b64_tr_b16 v[88:89], v120 offset:2048
ds_read_b64_tr_b16 v[90:91], v120 offset:3072
v_mfma_f32_32x32x16_bf16 v[24:39], a[28:31], v[72:75], v[24:39]
ds_read_b64_tr_b16 v[92:93], v121 offset:2048
ds_read_b64_tr_b16 v[94:95], v121 offset:3072
v_mfma_f32_32x32x16_bf16 v[40:55], a[24:27], v[76:79], v[40:55]
ds_write_b128 v150, v[208:211] offset:6144
buffer_load_dwordx4 a[88:91], v6, s[40:43], s96 offen offset:3072 sc1
s_add_u32 s96, s96, 4096
v_mfma_f32_32x32x16_bf16 v[56:71], a[28:31], v[76:79], v[56:71]
ds_write_b128 v150, v[212:215] offset:7168
buffer_load_dwordx4 a[92:95], v6, s[40:43], s97 offen offset:3072 sc1
s_add_u32 s97, s97, 4096
s_waitcnt lgkmcnt(8)
s_waitcnt vmcnt(14)
v_mfma_f32_32x32x16_bf16 v[8:23], a[32:35], v[80:83], v[8:23]
ds_read_b64_tr_b16 v[72:73], v120 offset:4096
ds_read_b64_tr_b16 v[74:75], v120 offset:5120
v_mfma_f32_32x32x16_bf16 v[24:39], a[36:39], v[80:83], v[24:39]
ds_read_b64_tr_b16 v[76:77], v121 offset:4096
ds_read_b64_tr_b16 v[78:79], v121 offset:5120
v_mfma_f32_32x32x16_bf16 v[40:55], a[32:35], v[84:87], v[40:55]
ds_write_b128 v150, v[216:219] offset:0
buffer_load_dwordx4 a[96:99], v6, s[40:43], s96 offen offset:0 sc1
v_mfma_f32_32x32x16_bf16 v[56:71], a[36:39], v[84:87], v[56:71]
ds_write_b128 v150, v[220:223] offset:1024
buffer_load_dwordx4 a[100:103], v6, s[40:43], s97 offen offset:0 sc1
s_waitcnt lgkmcnt(8)
s_waitcnt vmcnt(14)
v_mfma_f32_32x32x16_bf16 v[8:23], a[40:43], v[88:91], v[8:23]
ds_read_b64_tr_b16 v[80:81], v120 offset:6144
ds_read_b64_tr_b16 v[82:83], v120 offset:7168
v_mfma_f32_32x32x16_bf16 v[24:39], a[44:47], v[88:91], v[24:39]
ds_read_b64_tr_b16 v[84:85], v121 offset:6144
ds_read_b64_tr_b16 v[86:87], v121 offset:7168
v_mfma_f32_32x32x16_bf16 v[40:55], a[40:43], v[92:95], v[40:55]
ds_write_b128 v150, v[224:227] offset:2048
buffer_load_dwordx4 a[104:107], v6, s[40:43], s96 offen offset:1024 sc1
v_mfma_f32_32x32x16_bf16 v[56:71], a[44:47], v[92:95], v[56:71]
ds_write_b128 v150, v[228:231] offset:3072
buffer_load_dwordx4 a[108:111], v6, s[40:43], s97 offen offset:1024 sc1
s_waitcnt lgkmcnt(8)
s_waitcnt vmcnt(14)
v_mfma_f32_32x32x16_bf16 v[8:23], a[48:51], v[72:75], v[8:23]
ds_read_b64_tr_b16 v[88:89], v120 offset:0
ds_read_b64_tr_b16 v[90:91], v120 offset:1024
v_mfma_f32_32x32x16_bf16 v[24:39], a[52:55], v[72:75], v[24:39]
ds_read_b64_tr_b16 v[92:93], v121 offset:0
ds_read_b64_tr_b16 v[94:95], v121 offset:1024
v_mfma_f32_32x32x16_bf16 v[40:55], a[48:51], v[76:79], v[40:55]
ds_write_b128 v150, v[232:235] offset:4096
buffer_load_dwordx4 a[112:115], v6, s[40:43], s96 offen offset:2048 sc1
v_mfma_f32_32x32x16_bf16 v[56:71], a[52:55], v[76:79], v[56:71]
ds_write_b128 v150, v[236:239] offset:5120
buffer_load_dwordx4 a[116:119], v6, s[40:43], s97 offen offset:2048 sc1
s_waitcnt lgkmcnt(8)
s_waitcnt vmcnt(14)
v_mfma_f32_32x32x16_bf16 v[8:23], a[56:59], v[80:83], v[8:23]
ds_read_b64_tr_b16 v[72:73], v120 offset:2048
ds_read_b64_tr_b16 v[74:75], v120 offset:3072
v_mfma_f32_32x32x16_bf16 v[24:39], a[60:63], v[80:83], v[24:39]
ds_read_b64_tr_b16 v[76:77], v121 offset:2048
ds_read_b64_tr_b16 v[78:79], v121 offset:3072
v_mfma_f32_32x32x16_bf16 v[40:55], a[56:59], v[84:87], v[40:55]
ds_write_b128 v150, v[240:243] offset:6144
buffer_load_dwordx4 a[120:123], v6, s[40:43], s96 offen offset:3072 sc1
s_add_u32 s96, s96, 4096
v_mfma_f32_32x32x16_bf16 v[56:71], a[60:63], v[84:87], v[56:71]
ds_write_b128 v150, v[244:247] offset:7168
buffer_load_dwordx4 a[124:127], v6, s[40:43], s97 offen offset:3072 sc1
s_add_u32 s97, s97, 4096
s_waitcnt lgkmcnt(8)
s_waitcnt vmcnt(14)
v_mfma_f32_32x32x16_bf16 v[8:23], a[64:67], v[88:91], v[8:23]
ds_read_b64_tr_b16 v[80:81], v120 offset:4096
ds_read_b64_tr_b16 v[82:83], v120 offset:5120
v_mfma_f32_32x32x16_bf16 v[24:39], a[68:71], v[88:91], v[24:39]
ds_read_b64_tr_b16 v[84:85], v121 offset:4096
ds_read_b64_tr_b16 v[86:87], v121 offset:5120
v_mfma_f32_32x32x16_bf16 v[40:55], a[64:67], v[92:95], v[40:55]
ds_write_b128 v150, v[248:251] offset:0
buffer_load_dwordx4 a[128:131], v6, s[40:43], s96 offen offset:0 sc1
v_mfma_f32_32x32x16_bf16 v[56:71], a[68:71], v[92:95], v[56:71]
ds_write_b128 v150, v[252:255] offset:1024
buffer_load_dwordx4 a[132:135], v6, s[40:43], s97 offen offset:0 sc1
s_waitcnt lgkmcnt(8)
s_waitcnt vmcnt(14)
v_mfma_f32_32x32x16_bf16 v[8:23], a[72:75], v[72:75], v[8:23]
ds_read_b64_tr_b16 v[88:89], v120 offset:6144
ds_read_b64_tr_b16 v[90:91], v120 offset:7168
v_mfma_f32_32x32x16_bf16 v[24:39], a[76:79], v[72:75], v[24:39]
ds_read_b64_tr_b16 v[92:93], v121 offset:6144
ds_read_b64_tr_b16 v[94:95], v121 offset:7168
v_mfma_f32_32x32x16_bf16 v[40:55], a[72:75], v[76:79], v[40:55]
buffer_load_dwordx4 a[136:139], v6, s[40:43], s96 offen offset:1024 sc1
v_mfma_f32_32x32x16_bf16 v[56:71], a[76:79], v[76:79], v[56:71]
buffer_load_dwordx4 a[140:143], v6, s[40:43], s97 offen offset:1024 sc1
s_waitcnt lgkmcnt(6)
s_waitcnt vmcnt(14)
v_mfma_f32_32x32x16_bf16 v[8:23], a[80:83], v[80:83], v[8:23]
ds_read_b64_tr_b16 v[72:73], v120 offset:0
ds_read_b64_tr_b16 v[74:75], v120 offset:1024
v_mfma_f32_32x32x16_bf16 v[24:39], a[84:87], v[80:83], v[24:39]
ds_read_b64_tr_b16 v[76:77], v121 offset:0
ds_read_b64_tr_b16 v[78:79], v121 offset:1024
v_mfma_f32_32x32x16_bf16 v[40:55], a[80:83], v[84:87], v[40:55]
buffer_load_dwordx4 a[144:147], v6, s[40:43], s96 offen offset:2048 sc1
v_mfma_f32_32x32x16_bf16 v[56:71], a[84:87], v[84:87], v[56:71]
buffer_load_dwordx4 a[148:151], v6, s[40:43], s97 offen offset:2048 sc1
s_waitcnt lgkmcnt(4)
s_waitcnt vmcnt(14)
v_mfma_f32_32x32x16_bf16 v[8:23], a[88:91], v[88:91], v[8:23]
ds_read_b64_tr_b16 v[80:81], v122 offset:0
ds_read_b64_tr_b16 v[82:83], v122 offset:1024
v_mfma_f32_32x32x16_bf16 v[24:39], a[92:95], v[88:91], v[24:39]
ds_read_b64_tr_b16 v[84:85], v123 offset:0
ds_read_b64_tr_b16 v[86:87], v123 offset:1024
v_mfma_f32_32x32x16_bf16 v[40:55], a[88:91], v[92:95], v[40:55]
buffer_load_dwordx4 a[152:155], v6, s[40:43], s96 offen offset:3072 sc1
s_add_u32 s96, s96, 4096
v_mfma_f32_32x32x16_bf16 v[56:71], a[92:95], v[92:95], v[56:71]
buffer_load_dwordx4 a[156:159], v6, s[40:43], s97 offen offset:3072 sc1
s_add_u32 s97, s97, 4096
s_waitcnt lgkmcnt(4)
s_waitcnt vmcnt(14)
v_mfma_f32_32x32x16_bf16 v[8:23], a[96:99], v[72:75], v[8:23]
ds_read_b64_tr_b16 v[88:89], v122 offset:2048
ds_read_b64_tr_b16 v[90:91], v122 offset:3072
v_mfma_f32_32x32x16_bf16 v[24:39], a[100:103], v[72:75], v[24:39]
ds_read_b64_tr_b16 v[92:93], v123 offset:2048
ds_read_b64_tr_b16 v[94:95], v123 offset:3072
v_mfma_f32_32x32x16_bf16 v[40:55], a[96:99], v[76:79], v[40:55]
buffer_load_dwordx4 a[160:163], v6, s[40:43], s96 offen offset:0 sc1
v_mfma_f32_32x32x16_bf16 v[56:71], a[100:103], v[76:79], v[56:71]
buffer_load_dwordx4 a[164:167], v6, s[40:43], s97 offen offset:0 sc1
s_waitcnt lgkmcnt(4)
s_waitcnt vmcnt(14)
v_mfma_f32_32x32x16_bf16 v[8:23], a[104:107], v[80:83], v[8:23]
ds_read_b64_tr_b16 v[72:73], v122 offset:4096
ds_read_b64_tr_b16 v[74:75], v122 offset:5120
v_mfma_f32_32x32x16_bf16 v[24:39], a[108:111], v[80:83], v[24:39]
ds_read_b64_tr_b16 v[76:77], v123 offset:4096
ds_read_b64_tr_b16 v[78:79], v123 offset:5120
v_mfma_f32_32x32x16_bf16 v[40:55], a[104:107], v[84:87], v[40:55]
buffer_load_dwordx4 a[168:171], v6, s[40:43], s96 offen offset:1024 sc1
v_mfma_f32_32x32x16_bf16 v[56:71], a[108:111], v[84:87], v[56:71]
buffer_load_dwordx4 a[172:175], v6, s[40:43], s97 offen offset:1024 sc1
s_waitcnt lgkmcnt(4)
s_waitcnt vmcnt(14)
v_mfma_f32_32x32x16_bf16 v[8:23], a[112:115], v[88:91], v[8:23]
ds_read_b64_tr_b16 v[80:81], v148 offset:0
ds_read_b64_tr_b16 v[82:83], v148 offset:1024
v_mfma_f32_32x32x16_bf16 v[24:39], a[116:119], v[88:91], v[24:39]
ds_read_b64_tr_b16 v[84:85], v149 offset:0
ds_read_b64_tr_b16 v[86:87], v149 offset:1024
v_mfma_f32_32x32x16_bf16 v[40:55], a[112:115], v[92:95], v[40:55]
v_mfma_f32_32x32x16_bf16 v[56:71], a[116:119], v[92:95], v[56:71]
s_waitcnt lgkmcnt(4)
s_waitcnt vmcnt(12)
v_mfma_f32_32x32x16_bf16 v[8:23], a[120:123], v[72:75], v[8:23]
ds_read_b64_tr_b16 v[88:89], v148 offset:2048
ds_read_b64_tr_b16 v[90:91], v148 offset:3072
v_mfma_f32_32x32x16_bf16 v[24:39], a[124:127], v[72:75], v[24:39]
ds_read_b64_tr_b16 v[92:93], v149 offset:2048
ds_read_b64_tr_b16 v[94:95], v149 offset:3072
v_mfma_f32_32x32x16_bf16 v[40:55], a[120:123], v[76:79], v[40:55]
v_mfma_f32_32x32x16_bf16 v[56:71], a[124:127], v[76:79], v[56:71]
s_waitcnt lgkmcnt(4)
s_waitcnt vmcnt(10)
v_mfma_f32_32x32x16_bf16 v[8:23], a[128:131], v[80:83], v[8:23]
ds_read_b64_tr_b16 v[72:73], v148 offset:16640
ds_read_b64_tr_b16 v[74:75], v148 offset:17664
v_mfma_f32_32x32x16_bf16 v[24:39], a[132:135], v[80:83], v[24:39]
ds_read_b64_tr_b16 v[76:77], v149 offset:16640
ds_read_b64_tr_b16 v[78:79], v149 offset:17664
v_mfma_f32_32x32x16_bf16 v[40:55], a[128:131], v[84:87], v[40:55]
ds_write_b128 v150, a[240:243] offset:0
v_mfma_f32_32x32x16_bf16 v[56:71], a[132:135], v[84:87], v[56:71]
ds_write_b128 v150, a[244:247] offset:1024
s_waitcnt lgkmcnt(6)
s_waitcnt vmcnt(8)
v_mfma_f32_32x32x16_bf16 v[8:23], a[136:139], v[88:91], v[8:23]
ds_read_b64_tr_b16 v[80:81], v148 offset:18688
ds_read_b64_tr_b16 v[82:83], v148 offset:19712
v_mfma_f32_32x32x16_bf16 v[24:39], a[140:143], v[88:91], v[24:39]
ds_read_b64_tr_b16 v[84:85], v149 offset:18688
ds_read_b64_tr_b16 v[86:87], v149 offset:19712
v_mfma_f32_32x32x16_bf16 v[40:55], a[136:139], v[92:95], v[40:55]
ds_write_b128 v150, a[248:251] offset:2048
v_mfma_f32_32x32x16_bf16 v[56:71], a[140:143], v[92:95], v[56:71]
ds_write_b128 v150, a[252:255] offset:3072
s_waitcnt lgkmcnt(8)
s_waitcnt vmcnt(6)
v_mfma_f32_32x32x16_bf16 v[8:23], a[144:147], v[72:75], v[8:23]
ds_read_b64_tr_b16 v[88:89], v120 offset:0
ds_read_b64_tr_b16 v[90:91], v120 offset:1024
v_mfma_f32_32x32x16_bf16 v[24:39], a[148:151], v[72:75], v[24:39]
ds_read_b64_tr_b16 v[92:93], v121 offset:0
ds_read_b64_tr_b16 v[94:95], v121 offset:1024
v_mfma_f32_32x32x16_bf16 v[40:55], a[144:147], v[76:79], v[40:55]
v_mfma_f32_32x32x16_bf16 v[56:71], a[148:151], v[76:79], v[56:71]
s_waitcnt lgkmcnt(6)
s_waitcnt vmcnt(4)
v_mfma_f32_32x32x16_bf16 v[8:23], a[152:155], v[80:83], v[8:23]
ds_read_b64_tr_b16 v[72:73], v120 offset:2048
ds_read_b64_tr_b16 v[74:75], v120 offset:3072
v_mfma_f32_32x32x16_bf16 v[24:39], a[156:159], v[80:83], v[24:39]
ds_read_b64_tr_b16 v[76:77], v121 offset:2048
ds_read_b64_tr_b16 v[78:79], v121 offset:3072
v_mfma_f32_32x32x16_bf16 v[40:55], a[152:155], v[84:87], v[40:55]
v_mfma_f32_32x32x16_bf16 v[56:71], a[156:159], v[84:87], v[56:71]
s_waitcnt lgkmcnt(4)
s_waitcnt vmcnt(2)
v_mfma_f32_32x32x16_bf16 v[8:23], a[160:163], v[88:91], v[8:23]
v_mfma_f32_32x32x16_bf16 v[24:39], a[164:167], v[88:91], v[24:39]
v_mfma_f32_32x32x16_bf16 v[40:55], a[160:163], v[92:95], v[40:55]
v_mfma_f32_32x32x16_bf16 v[56:71], a[164:167], v[92:95], v[56:71]
s_waitcnt lgkmcnt(0)
s_waitcnt vmcnt(0)
v_mfma_f32_32x32x16_bf16 v[8:23], a[168:171], v[72:75], v[8:23]
v_mfma_f32_32x32x16_bf16 v[24:39], a[172:175], v[72:75], v[24:39]
v_mfma_f32_32x32x16_bf16 v[40:55], a[168:171], v[76:79], v[40:55]
v_mfma_f32_32x32x16_bf16 v[56:71], a[172:175], v[76:79], v[56:71]
s_waitcnt vmcnt(0)
v_lshlrev_b32 v2, 16, v125
s_nop 9
s_cmp_lg_u32 s3, 0
s_cbranch_scc1 L_rw_30
v_add_u32 v1, 87040, v6
ds_write_b128 v1, v[24:27] offset:0
v_lshlrev_b32 v72, 16, v128
v_and_b32 v73, s83, v128
ds_write_b128 v1, v[28:31] offset:1024
v_lshlrev_b32 v74, 16, v129
v_and_b32 v75, s83, v129
ds_write_b128 v1, v[32:35] offset:2048
v_lshlrev_b32 v76, 16, v130
v_and_b32 v77, s83, v130
ds_write_b128 v1, v[36:39] offset:3072
v_lshlrev_b32 v78, 16, v131
v_and_b32 v79, s83, v131
v_add_u32 v1, 95232, v6
ds_write_b128 v1, v[40:43] offset:0
v_lshlrev_b32 v80, 16, v132
v_and_b32 v81, s83, v132
ds_write_b128 v1, v[44:47] offset:1024
v_lshlrev_b32 v82, 16, v133
v_and_b32 v83, s83, v133
ds_write_b128 v1, v[48:51] offset:2048
v_lshlrev_b32 v84, 16, v134
v_and_b32 v85, s83, v134
ds_write_b128 v1, v[52:55] offset:3072
v_lshlrev_b32 v86, 16, v135
v_and_b32 v87, s83, v135
v_add_u32 v1, 103424, v6
ds_write_b128 v1, v[56:59] offset:0
v_pk_add_f32 v[72:73], v[72:73], v[2:3] op_sel_hi:[1,0]
v_pk_add_f32 v[74:75], v[74:75], v[2:3] op_sel_hi:[1,0]
ds_write_b128 v1, v[60:63] offset:1024
v_pk_add_f32 v[76:77], v[76:77], v[2:3] op_sel_hi:[1,0]
v_pk_add_f32 v[78:79], v[78:79], v[2:3] op_sel_hi:[1,0]
ds_write_b128 v1, v[64:67] offset:2048
v_pk_add_f32 v[80:81], v[80:81], v[2:3] op_sel_hi:[1,0]
v_pk_add_f32 v[82:83], v[82:83], v[2:3] op_sel_hi:[1,0]
ds_write_b128 v1, v[68:71] offset:3072
v_pk_add_f32 v[84:85], v[84:85], v[2:3] op_sel_hi:[1,0]
v_pk_add_f32 v[86:87], v[86:87], v[2:3] op_sel_hi:[1,0]
s_nop 1
v_pk_add_f32 v[8:9], v[8:9], v[72:73]
v_pk_add_f32 v[10:11], v[10:11], v[74:75]
v_pk_add_f32 v[12:13], v[12:13], v[76:77]
v_pk_add_f32 v[14:15], v[14:15], v[78:79]
v_pk_add_f32 v[16:17], v[16:17], v[80:81]
v_pk_add_f32 v[18:19], v[18:19], v[82:83]
v_pk_add_f32 v[20:21], v[20:21], v[84:85]
v_pk_add_f32 v[22:23], v[22:23], v[86:87]
s_branch L_red_29
L_rw_30:
s_cmp_lg_u32 s3, 1
s_cbranch_scc1 L_rw_31
v_add_u32 v1, 66560, v6
ds_write_b128 v1, v[8:11] offset:0
v_lshlrev_b32 v72, 16, v128
v_and_b32 v73, s83, v128
ds_write_b128 v1, v[12:15] offset:1024
v_lshlrev_b32 v74, 16, v129
v_and_b32 v75, s83, v129
ds_write_b128 v1, v[16:19] offset:2048
v_lshlrev_b32 v76, 16, v130
v_and_b32 v77, s83, v130
ds_write_b128 v1, v[20:23] offset:3072
v_lshlrev_b32 v78, 16, v131
v_and_b32 v79, s83, v131
v_add_u32 v1, 99328, v6
ds_write_b128 v1, v[40:43] offset:0
v_lshlrev_b32 v80, 16, v132
v_and_b32 v81, s83, v132
ds_write_b128 v1, v[44:47] offset:1024
v_lshlrev_b32 v82, 16, v133
v_and_b32 v83, s83, v133
ds_write_b128 v1, v[48:51] offset:2048
v_lshlrev_b32 v84, 16, v134
v_and_b32 v85, s83, v134
ds_write_b128 v1, v[52:55] offset:3072
v_lshlrev_b32 v86, 16, v135
v_and_b32 v87, s83, v135
v_add_u32 v1, 107520, v6
ds_write_b128 v1, v[56:59] offset:0
v_pk_add_f32 v[72:73], v[72:73], v[2:3] op_sel_hi:[1,0]
v_pk_add_f32 v[74:75], v[74:75], v[2:3] op_sel_hi:[1,0]
ds_write_b128 v1, v[60:63] offset:1024
v_pk_add_f32 v[76:77], v[76:77], v[2:3] op_sel_hi:[1,0]
v_pk_add_f32 v[78:79], v[78:79], v[2:3] op_sel_hi:[1,0]
ds_write_b128 v1, v[64:67] offset:2048
v_pk_add_f32 v[80:81], v[80:81], v[2:3] op_sel_hi:[1,0]
v_pk_add_f32 v[82:83], v[82:83], v[2:3] op_sel_hi:[1,0]
ds_write_b128 v1, v[68:71] offset:3072
v_pk_add_f32 v[84:85], v[84:85], v[2:3] op_sel_hi:[1,0]
v_pk_add_f32 v[86:87], v[86:87], v[2:3] op_sel_hi:[1,0]
s_nop 1
v_pk_add_f32 v[8:9], v[24:25], v[72:73]
v_pk_add_f32 v[10:11], v[26:27], v[74:75]
v_pk_add_f32 v[12:13], v[28:29], v[76:77]
v_pk_add_f32 v[14:15], v[30:31], v[78:79]
v_pk_add_f32 v[16:17], v[32:33], v[80:81]
v_pk_add_f32 v[18:19], v[34:35], v[82:83]
v_pk_add_f32 v[20:21], v[36:37], v[84:85]
v_pk_add_f32 v[22:23], v[38:39], v[86:87]
s_branch L_red_29
L_rw_31:
s_cmp_lg_u32 s3, 2
s_cbranch_scc1 L_rw_32
v_add_u32 v1, 70656, v6
ds_write_b128 v1, v[8:11] offset:0
v_lshlrev_b32 v72, 16, v128
v_and_b32 v73, s83, v128
ds_write_b128 v1, v[12:15] offset:1024
v_lshlrev_b32 v74, 16, v129
v_and_b32 v75, s83, v129
ds_write_b128 v1, v[16:19] offset:2048
v_lshlrev_b32 v76, 16, v130
v_and_b32 v77, s83, v130
ds_write_b128 v1, v[20:23] offset:3072
v_lshlrev_b32 v78, 16, v131
v_and_b32 v79, s83, v131
v_add_u32 v1, 78848, v6
ds_write_b128 v1, v[24:27] offset:0
v_lshlrev_b32 v80, 16, v132
v_and_b32 v81, s83, v132
ds_write_b128 v1, v[28:31] offset:1024
v_lshlrev_b32 v82, 16, v133
v_and_b32 v83, s83, v133
ds_write_b128 v1, v[32:35] offset:2048
v_lshlrev_b32 v84, 16, v134
v_and_b32 v85, s83, v134
ds_write_b128 v1, v[36:39] offset:3072
v_lshlrev_b32 v86, 16, v135
v_and_b32 v87, s83, v135
v_add_u32 v1, 111616, v6
ds_write_b128 v1, v[56:59] offset:0
v_pk_add_f32 v[72:73], v[72:73], v[2:3] op_sel_hi:[1,0]
v_pk_add_f32 v[74:75], v[74:75], v[2:3] op_sel_hi:[1,0]
ds_write_b128 v1, v[60:63] offset:1024
v_pk_add_f32 v[76:77], v[76:77], v[2:3] op_sel_hi:[1,0]
v_pk_add_f32 v[78:79], v[78:79], v[2:3] op_sel_hi:[1,0]
ds_write_b128 v1, v[64:67] offset:2048
v_pk_add_f32 v[80:81], v[80:81], v[2:3] op_sel_hi:[1,0]
v_pk_add_f32 v[82:83], v[82:83], v[2:3] op_sel_hi:[1,0]
ds_write_b128 v1, v[68:71] offset:3072
v_pk_add_f32 v[84:85], v[84:85], v[2:3] op_sel_hi:[1,0]
v_pk_add_f32 v[86:87], v[86:87], v[2:3] op_sel_hi:[1,0]
s_nop 1
v_pk_add_f32 v[8:9], v[40:41], v[72:73]
v_pk_add_f32 v[10:11], v[42:43], v[74:75]
v_pk_add_f32 v[12:13], v[44:45], v[76:77]
v_pk_add_f32 v[14:15], v[46:47], v[78:79]
v_pk_add_f32 v[16:17], v[48:49], v[80:81]
v_pk_add_f32 v[18:19], v[50:51], v[82:83]
v_pk_add_f32 v[20:21], v[52:53], v[84:85]
v_pk_add_f32 v[22:23], v[54:55], v[86:87]
s_branch L_red_29
L_rw_32:
v_add_u32 v1, 74752, v6
ds_write_b128 v1, v[8:11] offset:0
v_lshlrev_b32 v72, 16, v128
v_and_b32 v73, s83, v128
ds_write_b128 v1, v[12:15] offset:1024
v_lshlrev_b32 v74, 16, v129
v_and_b32 v75, s83, v129
ds_write_b128 v1, v[16:19] offset:2048
v_lshlrev_b32 v76, 16, v130
v_and_b32 v77, s83, v130
ds_write_b128 v1, v[20:23] offset:3072
v_lshlrev_b32 v78, 16, v131
v_and_b32 v79, s83, v131
v_add_u32 v1, 82944, v6
ds_write_b128 v1, v[24:27] offset:0
v_lshlrev_b32 v80, 16, v132
v_and_b32 v81, s83, v132
ds_write_b128 v1, v[28:31] offset:1024
v_lshlrev_b32 v82, 16, v133
v_and_b32 v83, s83, v133
ds_write_b128 v1, v[32:35] offset:2048
v_lshlrev_b32 v84, 16, v134
v_and_b32 v85, s83, v134
ds_write_b128 v1, v[36:39] offset:3072
v_lshlrev_b32 v86, 16, v135
v_and_b32 v87, s83, v135
v_add_u32 v1, 91136, v6
ds_write_b128 v1, v[40:43] offset:0
v_pk_add_f32 v[72:73], v[72:73], v[2:3] op_sel_hi:[1,0]
v_pk_add_f32 v[74:75], v[74:75], v[2:3] op_sel_hi:[1,0]
ds_write_b128 v1, v[44:47] offset:1024
v_pk_add_f32 v[76:77], v[76:77], v[2:3] op_sel_hi:[1,0]
v_pk_add_f32 v[78:79], v[78:79], v[2:3] op_sel_hi:[1,0]
ds_write_b128 v1, v[48:51] offset:2048
v_pk_add_f32 v[80:81], v[80:81], v[2:3] op_sel_hi:[1,0]
v_pk_add_f32 v[82:83], v[82:83], v[2:3] op_sel_hi:[1,0]
ds_write_b128 v1, v[52:55] offset:3072
v_pk_add_f32 v[84:85], v[84:85], v[2:3] op_sel_hi:[1,0]
v_pk_add_f32 v[86:87], v[86:87], v[2:3] op_sel_hi:[1,0]
s_nop 1
v_pk_add_f32 v[8:9], v[56:57], v[72:73]
v_pk_add_f32 v[10:11], v[58:59], v[74:75]
v_pk_add_f32 v[12:13], v[60:61], v[76:77]
v_pk_add_f32 v[14:15], v[62:63], v[78:79]
v_pk_add_f32 v[16:17], v[64:65], v[80:81]
v_pk_add_f32 v[18:19], v[66:67], v[82:83]
v_pk_add_f32 v[20:21], v[68:69], v[84:85]
v_pk_add_f32 v[22:23], v[70:71], v[86:87]
L_red_29:
s_mul_i32 s48, s3, 12288
s_add_u32 s48, s48, 66560
v_add_u32 v1, s48, v6
s_waitcnt lgkmcnt(0)
s_barrier
ds_read_b128 v[72:75], v1 offset:0
ds_read_b128 v[76:79], v1 offset:1024
ds_read_b128 v[80:83], v1 offset:2048
ds_read_b128 v[84:87], v1 offset:3072
ds_read_b128 v[88:91], v1 offset:4096
ds_read_b128 v[92:95], v1 offset:5120
ds_read_b128 v[96:99], v1 offset:6144
ds_read_b128 v[100:103], v1 offset:7168
ds_read_b128 v[104:107], v1 offset:8192
ds_read_b128 v[108:111], v1 offset:9216
ds_read_b128 v[112:115], v1 offset:10240
ds_read_b128 v[116:119], v1 offset:11264
s_waitcnt lgkmcnt(4)
v_pk_add_f32 v[72:73], v[72:73], v[88:89]
v_pk_add_f32 v[74:75], v[74:75], v[90:91]
v_pk_add_f32 v[76:77], v[76:77], v[92:93]
v_pk_add_f32 v[78:79], v[78:79], v[94:95]
v_pk_add_f32 v[80:81], v[80:81], v[96:97]
v_pk_add_f32 v[82:83], v[82:83], v[98:99]
v_pk_add_f32 v[84:85], v[84:85], v[100:101]
v_pk_add_f32 v[86:87], v[86:87], v[102:103]
v_pk_add_f32 v[8:9], v[8:9], v[72:73]
v_pk_add_f32 v[10:11], v[10:11], v[74:75]
v_pk_add_f32 v[12:13], v[12:13], v[76:77]
v_pk_add_f32 v[14:15], v[14:15], v[78:79]
v_pk_add_f32 v[16:17], v[16:17], v[80:81]
v_pk_add_f32 v[18:19], v[18:19], v[82:83]
v_pk_add_f32 v[20:21], v[20:21], v[84:85]
v_pk_add_f32 v[22:23], v[22:23], v[86:87]
s_waitcnt lgkmcnt(0)
v_pk_add_f32 v[8:9], v[8:9], v[104:105]
v_pk_add_f32 v[10:11], v[10:11], v[106:107]
v_pk_add_f32 v[12:13], v[12:13], v[108:109]
v_pk_add_f32 v[14:15], v[14:15], v[110:111]
v_pk_add_f32 v[16:17], v[16:17], v[112:113]
v_pk_add_f32 v[18:19], v[18:19], v[114:115]
v_pk_add_f32 v[20:21], v[20:21], v[116:117]
v_pk_add_f32 v[22:23], v[22:23], v[118:119]
v_cvt_pk_bf16_f32 v96, v8, v9
v_cvt_pk_bf16_f32 v97, v10, v11
v_cvt_pk_bf16_f32 v98, v12, v13
v_cvt_pk_bf16_f32 v99, v14, v15
v_cvt_pk_bf16_f32 v100, v16, v17
v_cvt_pk_bf16_f32 v101, v18, v19
v_cvt_pk_bf16_f32 v102, v20, v21
v_cvt_pk_bf16_f32 v103, v22, v23
v_permlane32_swap_b32 v96, v98
v_permlane32_swap_b32 v97, v99
v_permlane32_swap_b32 v100, v102
v_permlane32_swap_b32 v101, v103
buffer_store_dwordx4 v[96:99], v151, s[36:39], s66 offen offset:0
buffer_store_dwordx4 v[100:103], v151, s[36:39], s66 offen offset:32
s_waitcnt vmcnt(0)
s_waitcnt vmcnt(0)
s_endpgm
L_fallback:
s_nop 15
s_waitcnt vmcnt(0) lgkmcnt(0)
s_lshl_b32 s48, s56, 17
s_lshl_b32 s49, s3, 12
s_add_u32 s53, s48, s49
s_add_u32 s53, s53, 0x300000
v_mov_b32 v20, 0xff800000
v_mov_b32 v21, 0xff800000
s_mov_b32 s58, s53
s_mov_b32 s52, 8
L_fb1:
s_barrier
s_mov_b32 m0, s59
s_nop 0
buffer_load_dwordx4 v6, s[40:43], s58 offen sc1 lds
buffer_load_dwordx4 v6, s[40:43], s58 offen offset:1024 sc1 lds
s_add_u32 m0, s59, 32
s_nop 0
buffer_load_dwordx4 v6, s[40:43], s58 offen offset:2048 sc1 lds
buffer_load_dwordx4 v6, s[40:43], s58 offen offset:3072 sc1 lds
s_add_u32 s58, s58, 16384
s_waitcnt vmcnt(0)
s_barrier
ds_read_b128 v[16:19], v6 offset:0
s_waitcnt lgkmcnt(0)
v_mfma_f32_32x32x16_bf16 v[40:55], v[16:19], v[8:11], 0
v_mfma_f32_32x32x16_bf16 v[56:71], v[16:19], v[12:15], 0
s_nop 10
v_max3_f32 v20, v20, v40, v41
v_max3_f32 v20, v20, v42, v43
v_max3_f32 v20, v20, v44, v45
v_max3_f32 v20, v20, v46, v47
v_max3_f32 v20, v20, v48, v49
v_max3_f32 v20, v20, v50, v51
v_max3_f32 v20, v20, v52, v53
v_max3_f32 v20, v20, v54, v55
v_max3_f32 v21, v21, v56, v57
v_max3_f32 v21, v21, v58, v59
v_max3_f32 v21, v21, v60, v61
v_max3_f32 v21, v21, v62, v63
v_max3_f32 v21, v21, v64, v65
v_max3_f32 v21, v21, v66, v67
v_max3_f32 v21, v21, v68, v69
v_max3_f32 v21, v21, v70, v71
ds_read_b128 v[16:19], v6 offset:2080
s_waitcnt lgkmcnt(0)
v_mfma_f32_32x32x16_bf16 v[40:55], v[16:19], v[8:11], 0
v_mfma_f32_32x32x16_bf16 v[56:71], v[16:19], v[12:15], 0
s_nop 10
v_max3_f32 v20, v20, v40, v41
v_max3_f32 v20, v20, v42, v43
v_max3_f32 v20, v20, v44, v45
v_max3_f32 v20, v20, v46, v47
v_max3_f32 v20, v20, v48, v49
v_max3_f32 v20, v20, v50, v51
v_max3_f32 v20, v20, v52, v53
v_max3_f32 v20, v20, v54, v55
v_max3_f32 v21, v21, v56, v57
v_max3_f32 v21, v21, v58, v59
v_max3_f32 v21, v21, v60, v61
v_max3_f32 v21, v21, v62, v63
v_max3_f32 v21, v21, v64, v65
v_max3_f32 v21, v21, v66, v67
v_max3_f32 v21, v21, v68, v69
v_max3_f32 v21, v21, v70, v71
ds_read_b128 v[16:19], v6 offset:4160
s_waitcnt lgkmcnt(0)
v_mfma_f32_32x32x16_bf16 v[40:55], v[16:19], v[8:11], 0
v_mfma_f32_32x32x16_bf16 v[56:71], v[16:19], v[12:15], 0
s_nop 10
v_max3_f32 v20, v20, v40, v41
v_max3_f32 v20, v20, v42, v43
v_max3_f32 v20, v20, v44, v45
v_max3_f32 v20, v20, v46, v47
v_max3_f32 v20, v20, v48, v49
v_max3_f32 v20, v20, v50, v51
v_max3_f32 v20, v20, v52, v53
v_max3_f32 v20, v20, v54, v55
v_max3_f32 v21, v21, v56, v57
v_max3_f32 v21, v21, v58, v59
v_max3_f32 v21, v21, v60, v61
v_max3_f32 v21, v21, v62, v63
v_max3_f32 v21, v21, v64, v65
v_max3_f32 v21, v21, v66, v67
v_max3_f32 v21, v21, v68, v69
v_max3_f32 v21, v21, v70, v71
ds_read_b128 v[16:19], v6 offset:6240
s_waitcnt lgkmcnt(0)
v_mfma_f32_32x32x16_bf16 v[40:55], v[16:19], v[8:11], 0
v_mfma_f32_32x32x16_bf16 v[56:71], v[16:19], v[12:15], 0
s_nop 10
v_max3_f32 v20, v20, v40, v41
v_max3_f32 v20, v20, v42, v43
v_max3_f32 v20, v20, v44, v45
v_max3_f32 v20, v20, v46, v47
v_max3_f32 v20, v20, v48, v49
v_max3_f32 v20, v20, v50, v51
v_max3_f32 v20, v20, v52, v53
v_max3_f32 v20, v20, v54, v55
v_max3_f32 v21, v21, v56, v57
v_max3_f32 v21, v21, v58, v59
v_max3_f32 v21, v21, v60, v61
v_max3_f32 v21, v21, v62, v63
v_max3_f32 v21, v21, v64, v65
v_max3_f32 v21, v21, v66, v67
v_max3_f32 v21, v21, v68, v69
v_max3_f32 v21, v21, v70, v71
ds_read_b128 v[16:19], v6 offset:8320
s_waitcnt lgkmcnt(0)
v_mfma_f32_32x32x16_bf16 v[40:55], v[16:19], v[8:11], 0
v_mfma_f32_32x32x16_bf16 v[56:71], v[16:19], v[12:15], 0
s_nop 10
v_max3_f32 v20, v20, v40, v41
v_max3_f32 v20, v20, v42, v43
v_max3_f32 v20, v20, v44, v45
v_max3_f32 v20, v20, v46, v47
v_max3_f32 v20, v20, v48, v49
v_max3_f32 v20, v20, v50, v51
v_max3_f32 v20, v20, v52, v53
v_max3_f32 v20, v20, v54, v55
v_max3_f32 v21, v21, v56, v57
v_max3_f32 v21, v21, v58, v59
v_max3_f32 v21, v21, v60, v61
v_max3_f32 v21, v21, v62, v63
v_max3_f32 v21, v21, v64, v65
v_max3_f32 v21, v21, v66, v67
v_max3_f32 v21, v21, v68, v69
v_max3_f32 v21, v21, v70, v71
ds_read_b128 v[16:19], v6 offset:10400
s_waitcnt lgkmcnt(0)
v_mfma_f32_32x32x16_bf16 v[40:55], v[16:19], v[8:11], 0
v_mfma_f32_32x32x16_bf16 v[56:71], v[16:19], v[12:15], 0
s_nop 10
v_max3_f32 v20, v20, v40, v41
v_max3_f32 v20, v20, v42, v43
v_max3_f32 v20, v20, v44, v45
v_max3_f32 v20, v20, v46, v47
v_max3_f32 v20, v20, v48, v49
v_max3_f32 v20, v20, v50, v51
v_max3_f32 v20, v20, v52, v53
v_max3_f32 v20, v20, v54, v55
v_max3_f32 v21, v21, v56, v57
v_max3_f32 v21, v21, v58, v59
v_max3_f32 v21, v21, v60, v61
v_max3_f32 v21, v21, v62, v63
v_max3_f32 v21, v21, v64, v65
v_max3_f32 v21, v21, v66, v67
v_max3_f32 v21, v21, v68, v69
v_max3_f32 v21, v21, v70, v71
ds_read_b128 v[16:19], v6 offset:12480
s_waitcnt lgkmcnt(0)
v_mfma_f32_32x32x16_bf16 v[40:55], v[16:19], v[8:11], 0
v_mfma_f32_32x32x16_bf16 v[56:71], v[16:19], v[12:15], 0
s_nop 10
v_max3_f32 v20, v20, v40, v41
v_max3_f32 v20, v20, v42, v43
v_max3_f32 v20, v20, v44, v45
v_max3_f32 v20, v20, v46, v47
v_max3_f32 v20, v20, v48, v49
v_max3_f32 v20, v20, v50, v51
v_max3_f32 v20, v20, v52, v53
v_max3_f32 v20, v20, v54, v55
v_max3_f32 v21, v21, v56, v57
v_max3_f32 v21, v21, v58, v59
v_max3_f32 v21, v21, v60, v61
v_max3_f32 v21, v21, v62, v63
v_max3_f32 v21, v21, v64, v65
v_max3_f32 v21, v21, v66, v67
v_max3_f32 v21, v21, v68, v69
v_max3_f32 v21, v21, v70, v71
ds_read_b128 v[16:19], v6 offset:14560
s_waitcnt lgkmcnt(0)
v_mfma_f32_32x32x16_bf16 v[40:55], v[16:19], v[8:11], 0
v_mfma_f32_32x32x16_bf16 v[56:71], v[16:19], v[12:15], 0
s_nop 10
v_max3_f32 v20, v20, v40, v41
v_max3_f32 v20, v20, v42, v43
v_max3_f32 v20, v20, v44, v45
v_max3_f32 v20, v20, v46, v47
v_max3_f32 v20, v20, v48, v49
v_max3_f32 v20, v20, v50, v51
v_max3_f32 v20, v20, v52, v53
v_max3_f32 v20, v20, v54, v55
v_max3_f32 v21, v21, v56, v57
v_max3_f32 v21, v21, v58, v59
v_max3_f32 v21, v21, v60, v61
v_max3_f32 v21, v21, v62, v63
v_max3_f32 v21, v21, v64, v65
v_max3_f32 v21, v21, v66, v67
v_max3_f32 v21, v21, v68, v69
v_max3_f32 v21, v21, v70, v71
s_sub_u32 s52, s52, 1
s_cmp_lg_u32 s52, 0
s_cbranch_scc1 L_fb1
v_mov_b32 v1, v20
s_nop 1
v_permlane32_swap_b32 v20, v1
v_max_f32 v20, v20, v1
v_mov_b32 v1, v21
s_nop 1
v_permlane32_swap_b32 v21, v1
v_max_f32 v21, v21, v1
v_mov_b32 v88, 0
v_mov_b32 v89, 0
v_mov_b32 v90, 0
v_mov_b32 v91, 0
v_mov_b32 v92, 0
v_mov_b32 v93, 0
v_mov_b32 v94, 0
v_mov_b32 v95, 0
v_mov_b32 v96, 0
v_mov_b32 v97, 0
v_mov_b32 v98, 0
v_mov_b32 v99, 0
v_mov_b32 v100, 0
v_mov_b32 v101, 0
v_mov_b32 v102, 0
v_mov_b32 v103, 0
v_mov_b32 v104, 0
v_mov_b32 v105, 0
v_mov_b32 v106, 0
v_mov_b32 v107, 0
v_mov_b32 v108, 0
v_mov_b32 v109, 0
v_mov_b32 v110, 0
v_mov_b32 v111, 0
v_mov_b32 v112, 0
v_mov_b32 v113, 0
v_mov_b32 v114, 0
v_mov_b32 v115, 0
v_mov_b32 v116, 0
v_mov_b32 v117, 0
v_mov_b32 v118, 0
v_mov_b32 v119, 0
s_mov_b32 s58, s53
s_mov_b32 s52, 8
L_fb2:
s_barrier
s_mov_b32 m0, s59
s_nop 0
buffer_load_dwordx4 v6, s[40:43], s58 offen sc1 lds
buffer_load_dwordx4 v6, s[40:43], s58 offen offset:1024 sc1 lds
s_add_u32 m0, s59, 32
s_nop 0
buffer_load_dwordx4 v6, s[40:43], s58 offen offset:2048 sc1 lds
buffer_load_dwordx4 v6, s[40:43], s58 offen offset:3072 sc1 lds
s_add_u32 s58, s58, 16384
s_waitcnt vmcnt(0)
s_barrier
ds_read_b128 v[16:19], v6 offset:0
ds_read_b128 v[24:27], v121 offset:0
ds_read_b128 v[28:31], v122 offset:0
s_waitcnt lgkmcnt(0)
v_mfma_f32_32x32x16_bf16 v[40:55], v[16:19], v[8:11], 0
v_mfma_f32_32x32x16_bf16 v[56:71], v[16:19], v[12:15], 0
s_nop 10
v_sub_f32 v40, v40, v20
v_sub_f32 v41, v41, v20
v_sub_f32 v42, v42, v20
v_sub_f32 v43, v43, v20
v_sub_f32 v44, v44, v20
v_sub_f32 v45, v45, v20
v_sub_f32 v46, v46, v20
v_sub_f32 v47, v47, v20
v_sub_f32 v48, v48, v20
v_sub_f32 v49, v49, v20
v_sub_f32 v50, v50, v20
v_sub_f32 v51, v51, v20
v_sub_f32 v52, v52, v20
v_sub_f32 v53, v53, v20
v_sub_f32 v54, v54, v20
v_sub_f32 v55, v55, v20
v_exp_f32 v40, v40
v_exp_f32 v41, v41
v_exp_f32 v42, v42
v_exp_f32 v43, v43
v_exp_f32 v44, v44
v_exp_f32 v45, v45
v_exp_f32 v46, v46
v_exp_f32 v47, v47
v_exp_f32 v48, v48
v_exp_f32 v49, v49
v_exp_f32 v50, v50
v_exp_f32 v51, v51
v_exp_f32 v52, v52
v_exp_f32 v53, v53
v_exp_f32 v54, v54
v_exp_f32 v55, v55
v_cvt_pk_bf16_f32 v72, v40, v41
v_cvt_pk_bf16_f32 v73, v42, v43
v_cvt_pk_bf16_f32 v74, v44, v45
v_cvt_pk_bf16_f32 v75, v46, v47
v_cvt_pk_bf16_f32 v76, v48, v49
v_cvt_pk_bf16_f32 v77, v50, v51
v_cvt_pk_bf16_f32 v78, v52, v53
v_cvt_pk_bf16_f32 v79, v54, v55
v_mfma_f32_32x32x16_bf16 v[88:103], v[24:27], v[72:75], v[88:103]
s_nop 0
v_mfma_f32_32x32x16_bf16 v[88:103], v[28:31], v[76:79], v[88:103]
v_sub_f32 v56, v56, v21
v_sub_f32 v57, v57, v21
v_sub_f32 v58, v58, v21
v_sub_f32 v59, v59, v21
v_sub_f32 v60, v60, v21
v_sub_f32 v61, v61, v21
v_sub_f32 v62, v62, v21
v_sub_f32 v63, v63, v21
v_sub_f32 v64, v64, v21
v_sub_f32 v65, v65, v21
v_sub_f32 v66, v66, v21
v_sub_f32 v67, v67, v21
v_sub_f32 v68, v68, v21
v_sub_f32 v69, v69, v21
v_sub_f32 v70, v70, v21
v_sub_f32 v71, v71, v21
v_exp_f32 v56, v56
v_exp_f32 v57, v57
v_exp_f32 v58, v58
v_exp_f32 v59, v59
v_exp_f32 v60, v60
v_exp_f32 v61, v61
v_exp_f32 v62, v62
v_exp_f32 v63, v63
v_exp_f32 v64, v64
v_exp_f32 v65, v65
v_exp_f32 v66, v66
v_exp_f32 v67, v67
v_exp_f32 v68, v68
v_exp_f32 v69, v69
v_exp_f32 v70, v70
v_exp_f32 v71, v71
v_cvt_pk_bf16_f32 v80, v56, v57
v_cvt_pk_bf16_f32 v81, v58, v59
v_cvt_pk_bf16_f32 v82, v60, v61
v_cvt_pk_bf16_f32 v83, v62, v63
v_cvt_pk_bf16_f32 v84, v64, v65
v_cvt_pk_bf16_f32 v85, v66, v67
v_cvt_pk_bf16_f32 v86, v68, v69
v_cvt_pk_bf16_f32 v87, v70, v71
v_mfma_f32_32x32x16_bf16 v[104:119], v[24:27], v[80:83], v[104:119]
s_nop 0
v_mfma_f32_32x32x16_bf16 v[104:119], v[28:31], v[84:87], v[104:119]
ds_read_b128 v[16:19], v6 offset:2080
ds_read_b128 v[24:27], v121 offset:2080
ds_read_b128 v[28:31], v122 offset:2080
s_waitcnt lgkmcnt(0)
v_mfma_f32_32x32x16_bf16 v[40:55], v[16:19], v[8:11], 0
v_mfma_f32_32x32x16_bf16 v[56:71], v[16:19], v[12:15], 0
s_nop 10
v_sub_f32 v40, v40, v20
v_sub_f32 v41, v41, v20
v_sub_f32 v42, v42, v20
v_sub_f32 v43, v43, v20
v_sub_f32 v44, v44, v20
v_sub_f32 v45, v45, v20
v_sub_f32 v46, v46, v20
v_sub_f32 v47, v47, v20
v_sub_f32 v48, v48, v20
v_sub_f32 v49, v49, v20
v_sub_f32 v50, v50, v20
v_sub_f32 v51, v51, v20
v_sub_f32 v52, v52, v20
v_sub_f32 v53, v53, v20
v_sub_f32 v54, v54, v20
v_sub_f32 v55, v55, v20
v_exp_f32 v40, v40
v_exp_f32 v41, v41
v_exp_f32 v42, v42
v_exp_f32 v43, v43
v_exp_f32 v44, v44
v_exp_f32 v45, v45
v_exp_f32 v46, v46
v_exp_f32 v47, v47
v_exp_f32 v48, v48
v_exp_f32 v49, v49
v_exp_f32 v50, v50
v_exp_f32 v51, v51
v_exp_f32 v52, v52
v_exp_f32 v53, v53
v_exp_f32 v54, v54
v_exp_f32 v55, v55
v_cvt_pk_bf16_f32 v72, v40, v41
v_cvt_pk_bf16_f32 v73, v42, v43
v_cvt_pk_bf16_f32 v74, v44, v45
v_cvt_pk_bf16_f32 v75, v46, v47
v_cvt_pk_bf16_f32 v76, v48, v49
v_cvt_pk_bf16_f32 v77, v50, v51
v_cvt_pk_bf16_f32 v78, v52, v53
v_cvt_pk_bf16_f32 v79, v54, v55
v_mfma_f32_32x32x16_bf16 v[88:103], v[24:27], v[72:75], v[88:103]
s_nop 0
v_mfma_f32_32x32x16_bf16 v[88:103], v[28:31], v[76:79], v[88:103]
v_sub_f32 v56, v56, v21
v_sub_f32 v57, v57, v21
v_sub_f32 v58, v58, v21
v_sub_f32 v59, v59, v21
v_sub_f32 v60, v60, v21
v_sub_f32 v61, v61, v21
v_sub_f32 v62, v62, v21
v_sub_f32 v63, v63, v21
v_sub_f32 v64, v64, v21
v_sub_f32 v65, v65, v21
v_sub_f32 v66, v66, v21
v_sub_f32 v67, v67, v21
v_sub_f32 v68, v68, v21
v_sub_f32 v69, v69, v21
v_sub_f32 v70, v70, v21
v_sub_f32 v71, v71, v21
v_exp_f32 v56, v56
v_exp_f32 v57, v57
v_exp_f32 v58, v58
v_exp_f32 v59, v59
v_exp_f32 v60, v60
v_exp_f32 v61, v61
v_exp_f32 v62, v62
v_exp_f32 v63, v63
v_exp_f32 v64, v64
v_exp_f32 v65, v65
v_exp_f32 v66, v66
v_exp_f32 v67, v67
v_exp_f32 v68, v68
v_exp_f32 v69, v69
v_exp_f32 v70, v70
v_exp_f32 v71, v71
v_cvt_pk_bf16_f32 v80, v56, v57
v_cvt_pk_bf16_f32 v81, v58, v59
v_cvt_pk_bf16_f32 v82, v60, v61
v_cvt_pk_bf16_f32 v83, v62, v63
v_cvt_pk_bf16_f32 v84, v64, v65
v_cvt_pk_bf16_f32 v85, v66, v67
v_cvt_pk_bf16_f32 v86, v68, v69
v_cvt_pk_bf16_f32 v87, v70, v71
v_mfma_f32_32x32x16_bf16 v[104:119], v[24:27], v[80:83], v[104:119]
s_nop 0
v_mfma_f32_32x32x16_bf16 v[104:119], v[28:31], v[84:87], v[104:119]
ds_read_b128 v[16:19], v6 offset:4160
ds_read_b128 v[24:27], v121 offset:4160
ds_read_b128 v[28:31], v122 offset:4160
s_waitcnt lgkmcnt(0)
v_mfma_f32_32x32x16_bf16 v[40:55], v[16:19], v[8:11], 0
v_mfma_f32_32x32x16_bf16 v[56:71], v[16:19], v[12:15], 0
s_nop 10
v_sub_f32 v40, v40, v20
v_sub_f32 v41, v41, v20
v_sub_f32 v42, v42, v20
v_sub_f32 v43, v43, v20
v_sub_f32 v44, v44, v20
v_sub_f32 v45, v45, v20
v_sub_f32 v46, v46, v20
v_sub_f32 v47, v47, v20
v_sub_f32 v48, v48, v20
v_sub_f32 v49, v49, v20
v_sub_f32 v50, v50, v20
v_sub_f32 v51, v51, v20
v_sub_f32 v52, v52, v20
v_sub_f32 v53, v53, v20
v_sub_f32 v54, v54, v20
v_sub_f32 v55, v55, v20
v_exp_f32 v40, v40
v_exp_f32 v41, v41
v_exp_f32 v42, v42
v_exp_f32 v43, v43
v_exp_f32 v44, v44
v_exp_f32 v45, v45
v_exp_f32 v46, v46
v_exp_f32 v47, v47
v_exp_f32 v48, v48
v_exp_f32 v49, v49
v_exp_f32 v50, v50
v_exp_f32 v51, v51
v_exp_f32 v52, v52
v_exp_f32 v53, v53
v_exp_f32 v54, v54
v_exp_f32 v55, v55
v_cvt_pk_bf16_f32 v72, v40, v41
v_cvt_pk_bf16_f32 v73, v42, v43
v_cvt_pk_bf16_f32 v74, v44, v45
v_cvt_pk_bf16_f32 v75, v46, v47
v_cvt_pk_bf16_f32 v76, v48, v49
v_cvt_pk_bf16_f32 v77, v50, v51
v_cvt_pk_bf16_f32 v78, v52, v53
v_cvt_pk_bf16_f32 v79, v54, v55
v_mfma_f32_32x32x16_bf16 v[88:103], v[24:27], v[72:75], v[88:103]
s_nop 0
v_mfma_f32_32x32x16_bf16 v[88:103], v[28:31], v[76:79], v[88:103]
v_sub_f32 v56, v56, v21
v_sub_f32 v57, v57, v21
v_sub_f32 v58, v58, v21
v_sub_f32 v59, v59, v21
v_sub_f32 v60, v60, v21
v_sub_f32 v61, v61, v21
v_sub_f32 v62, v62, v21
v_sub_f32 v63, v63, v21
v_sub_f32 v64, v64, v21
v_sub_f32 v65, v65, v21
v_sub_f32 v66, v66, v21
v_sub_f32 v67, v67, v21
v_sub_f32 v68, v68, v21
v_sub_f32 v69, v69, v21
v_sub_f32 v70, v70, v21
v_sub_f32 v71, v71, v21
v_exp_f32 v56, v56
v_exp_f32 v57, v57
v_exp_f32 v58, v58
v_exp_f32 v59, v59
v_exp_f32 v60, v60
v_exp_f32 v61, v61
v_exp_f32 v62, v62
v_exp_f32 v63, v63
v_exp_f32 v64, v64
v_exp_f32 v65, v65
v_exp_f32 v66, v66
v_exp_f32 v67, v67
v_exp_f32 v68, v68
v_exp_f32 v69, v69
v_exp_f32 v70, v70
v_exp_f32 v71, v71
v_cvt_pk_bf16_f32 v80, v56, v57
v_cvt_pk_bf16_f32 v81, v58, v59
v_cvt_pk_bf16_f32 v82, v60, v61
v_cvt_pk_bf16_f32 v83, v62, v63
v_cvt_pk_bf16_f32 v84, v64, v65
v_cvt_pk_bf16_f32 v85, v66, v67
v_cvt_pk_bf16_f32 v86, v68, v69
v_cvt_pk_bf16_f32 v87, v70, v71
v_mfma_f32_32x32x16_bf16 v[104:119], v[24:27], v[80:83], v[104:119]
s_nop 0
v_mfma_f32_32x32x16_bf16 v[104:119], v[28:31], v[84:87], v[104:119]
ds_read_b128 v[16:19], v6 offset:6240
ds_read_b128 v[24:27], v121 offset:6240
ds_read_b128 v[28:31], v122 offset:6240
s_waitcnt lgkmcnt(0)
v_mfma_f32_32x32x16_bf16 v[40:55], v[16:19], v[8:11], 0
v_mfma_f32_32x32x16_bf16 v[56:71], v[16:19], v[12:15], 0
s_nop 10
v_sub_f32 v40, v40, v20
v_sub_f32 v41, v41, v20
v_sub_f32 v42, v42, v20
v_sub_f32 v43, v43, v20
v_sub_f32 v44, v44, v20
v_sub_f32 v45, v45, v20
v_sub_f32 v46, v46, v20
v_sub_f32 v47, v47, v20
v_sub_f32 v48, v48, v20
v_sub_f32 v49, v49, v20
v_sub_f32 v50, v50, v20
v_sub_f32 v51, v51, v20
v_sub_f32 v52, v52, v20
v_sub_f32 v53, v53, v20
v_sub_f32 v54, v54, v20
v_sub_f32 v55, v55, v20
v_exp_f32 v40, v40
v_exp_f32 v41, v41
v_exp_f32 v42, v42
v_exp_f32 v43, v43
v_exp_f32 v44, v44
v_exp_f32 v45, v45
v_exp_f32 v46, v46
v_exp_f32 v47, v47
v_exp_f32 v48, v48
v_exp_f32 v49, v49
v_exp_f32 v50, v50
v_exp_f32 v51, v51
v_exp_f32 v52, v52
v_exp_f32 v53, v53
v_exp_f32 v54, v54
v_exp_f32 v55, v55
v_cvt_pk_bf16_f32 v72, v40, v41
v_cvt_pk_bf16_f32 v73, v42, v43
v_cvt_pk_bf16_f32 v74, v44, v45
v_cvt_pk_bf16_f32 v75, v46, v47
v_cvt_pk_bf16_f32 v76, v48, v49
v_cvt_pk_bf16_f32 v77, v50, v51
v_cvt_pk_bf16_f32 v78, v52, v53
v_cvt_pk_bf16_f32 v79, v54, v55
v_mfma_f32_32x32x16_bf16 v[88:103], v[24:27], v[72:75], v[88:103]
s_nop 0
v_mfma_f32_32x32x16_bf16 v[88:103], v[28:31], v[76:79], v[88:103]
v_sub_f32 v56, v56, v21
v_sub_f32 v57, v57, v21
v_sub_f32 v58, v58, v21
v_sub_f32 v59, v59, v21
v_sub_f32 v60, v60, v21
v_sub_f32 v61, v61, v21
v_sub_f32 v62, v62, v21
v_sub_f32 v63, v63, v21
v_sub_f32 v64, v64, v21
v_sub_f32 v65, v65, v21
v_sub_f32 v66, v66, v21
v_sub_f32 v67, v67, v21
v_sub_f32 v68, v68, v21
v_sub_f32 v69, v69, v21
v_sub_f32 v70, v70, v21
v_sub_f32 v71, v71, v21
v_exp_f32 v56, v56
v_exp_f32 v57, v57
v_exp_f32 v58, v58
v_exp_f32 v59, v59
v_exp_f32 v60, v60
v_exp_f32 v61, v61
v_exp_f32 v62, v62
v_exp_f32 v63, v63
v_exp_f32 v64, v64
v_exp_f32 v65, v65
v_exp_f32 v66, v66
v_exp_f32 v67, v67
v_exp_f32 v68, v68
v_exp_f32 v69, v69
v_exp_f32 v70, v70
v_exp_f32 v71, v71
v_cvt_pk_bf16_f32 v80, v56, v57
v_cvt_pk_bf16_f32 v81, v58, v59
v_cvt_pk_bf16_f32 v82, v60, v61
v_cvt_pk_bf16_f32 v83, v62, v63
v_cvt_pk_bf16_f32 v84, v64, v65
v_cvt_pk_bf16_f32 v85, v66, v67
v_cvt_pk_bf16_f32 v86, v68, v69
v_cvt_pk_bf16_f32 v87, v70, v71
v_mfma_f32_32x32x16_bf16 v[104:119], v[24:27], v[80:83], v[104:119]
s_nop 0
v_mfma_f32_32x32x16_bf16 v[104:119], v[28:31], v[84:87], v[104:119]
ds_read_b128 v[16:19], v6 offset:8320
ds_read_b128 v[24:27], v121 offset:8320
ds_read_b128 v[28:31], v122 offset:8320
s_waitcnt lgkmcnt(0)
v_mfma_f32_32x32x16_bf16 v[40:55], v[16:19], v[8:11], 0
v_mfma_f32_32x32x16_bf16 v[56:71], v[16:19], v[12:15], 0
s_nop 10
v_sub_f32 v40, v40, v20
v_sub_f32 v41, v41, v20
v_sub_f32 v42, v42, v20
v_sub_f32 v43, v43, v20
v_sub_f32 v44, v44, v20
v_sub_f32 v45, v45, v20
v_sub_f32 v46, v46, v20
v_sub_f32 v47, v47, v20
v_sub_f32 v48, v48, v20
v_sub_f32 v49, v49, v20
v_sub_f32 v50, v50, v20
v_sub_f32 v51, v51, v20
v_sub_f32 v52, v52, v20
v_sub_f32 v53, v53, v20
v_sub_f32 v54, v54, v20
v_sub_f32 v55, v55, v20
v_exp_f32 v40, v40
v_exp_f32 v41, v41
v_exp_f32 v42, v42
v_exp_f32 v43, v43
v_exp_f32 v44, v44
v_exp_f32 v45, v45
v_exp_f32 v46, v46
v_exp_f32 v47, v47
v_exp_f32 v48, v48
v_exp_f32 v49, v49
v_exp_f32 v50, v50
v_exp_f32 v51, v51
v_exp_f32 v52, v52
v_exp_f32 v53, v53
v_exp_f32 v54, v54
v_exp_f32 v55, v55
v_cvt_pk_bf16_f32 v72, v40, v41
v_cvt_pk_bf16_f32 v73, v42, v43
v_cvt_pk_bf16_f32 v74, v44, v45
v_cvt_pk_bf16_f32 v75, v46, v47
v_cvt_pk_bf16_f32 v76, v48, v49
v_cvt_pk_bf16_f32 v77, v50, v51
v_cvt_pk_bf16_f32 v78, v52, v53
v_cvt_pk_bf16_f32 v79, v54, v55
v_mfma_f32_32x32x16_bf16 v[88:103], v[24:27], v[72:75], v[88:103]
s_nop 0
v_mfma_f32_32x32x16_bf16 v[88:103], v[28:31], v[76:79], v[88:103]
v_sub_f32 v56, v56, v21
v_sub_f32 v57, v57, v21
v_sub_f32 v58, v58, v21
v_sub_f32 v59, v59, v21
v_sub_f32 v60, v60, v21
v_sub_f32 v61, v61, v21
v_sub_f32 v62, v62, v21
v_sub_f32 v63, v63, v21
v_sub_f32 v64, v64, v21
v_sub_f32 v65, v65, v21
v_sub_f32 v66, v66, v21
v_sub_f32 v67, v67, v21
v_sub_f32 v68, v68, v21
v_sub_f32 v69, v69, v21
v_sub_f32 v70, v70, v21
v_sub_f32 v71, v71, v21
v_exp_f32 v56, v56
v_exp_f32 v57, v57
v_exp_f32 v58, v58
v_exp_f32 v59, v59
v_exp_f32 v60, v60
v_exp_f32 v61, v61
v_exp_f32 v62, v62
v_exp_f32 v63, v63
v_exp_f32 v64, v64
v_exp_f32 v65, v65
v_exp_f32 v66, v66
v_exp_f32 v67, v67
v_exp_f32 v68, v68
v_exp_f32 v69, v69
v_exp_f32 v70, v70
v_exp_f32 v71, v71
v_cvt_pk_bf16_f32 v80, v56, v57
v_cvt_pk_bf16_f32 v81, v58, v59
v_cvt_pk_bf16_f32 v82, v60, v61
v_cvt_pk_bf16_f32 v83, v62, v63
v_cvt_pk_bf16_f32 v84, v64, v65
v_cvt_pk_bf16_f32 v85, v66, v67
v_cvt_pk_bf16_f32 v86, v68, v69
v_cvt_pk_bf16_f32 v87, v70, v71
v_mfma_f32_32x32x16_bf16 v[104:119], v[24:27], v[80:83], v[104:119]
s_nop 0
v_mfma_f32_32x32x16_bf16 v[104:119], v[28:31], v[84:87], v[104:119]
ds_read_b128 v[16:19], v6 offset:10400
ds_read_b128 v[24:27], v121 offset:10400
ds_read_b128 v[28:31], v122 offset:10400
s_waitcnt lgkmcnt(0)
v_mfma_f32_32x32x16_bf16 v[40:55], v[16:19], v[8:11], 0
v_mfma_f32_32x32x16_bf16 v[56:71], v[16:19], v[12:15], 0
s_nop 10
v_sub_f32 v40, v40, v20
v_sub_f32 v41, v41, v20
v_sub_f32 v42, v42, v20
v_sub_f32 v43, v43, v20
v_sub_f32 v44, v44, v20
v_sub_f32 v45, v45, v20
v_sub_f32 v46, v46, v20
v_sub_f32 v47, v47, v20
v_sub_f32 v48, v48, v20
v_sub_f32 v49, v49, v20
v_sub_f32 v50, v50, v20
v_sub_f32 v51, v51, v20
v_sub_f32 v52, v52, v20
v_sub_f32 v53, v53, v20
v_sub_f32 v54, v54, v20
v_sub_f32 v55, v55, v20
v_exp_f32 v40, v40
v_exp_f32 v41, v41
v_exp_f32 v42, v42
v_exp_f32 v43, v43
v_exp_f32 v44, v44
v_exp_f32 v45, v45
v_exp_f32 v46, v46
v_exp_f32 v47, v47
v_exp_f32 v48, v48
v_exp_f32 v49, v49
v_exp_f32 v50, v50
v_exp_f32 v51, v51
v_exp_f32 v52, v52
v_exp_f32 v53, v53
v_exp_f32 v54, v54
v_exp_f32 v55, v55
v_cvt_pk_bf16_f32 v72, v40, v41
v_cvt_pk_bf16_f32 v73, v42, v43
v_cvt_pk_bf16_f32 v74, v44, v45
v_cvt_pk_bf16_f32 v75, v46, v47
v_cvt_pk_bf16_f32 v76, v48, v49
v_cvt_pk_bf16_f32 v77, v50, v51
v_cvt_pk_bf16_f32 v78, v52, v53
v_cvt_pk_bf16_f32 v79, v54, v55
v_mfma_f32_32x32x16_bf16 v[88:103], v[24:27], v[72:75], v[88:103]
s_nop 0
v_mfma_f32_32x32x16_bf16 v[88:103], v[28:31], v[76:79], v[88:103]
v_sub_f32 v56, v56, v21
v_sub_f32 v57, v57, v21
v_sub_f32 v58, v58, v21
v_sub_f32 v59, v59, v21
v_sub_f32 v60, v60, v21
v_sub_f32 v61, v61, v21
v_sub_f32 v62, v62, v21
v_sub_f32 v63, v63, v21
v_sub_f32 v64, v64, v21
v_sub_f32 v65, v65, v21
v_sub_f32 v66, v66, v21
v_sub_f32 v67, v67, v21
v_sub_f32 v68, v68, v21
v_sub_f32 v69, v69, v21
v_sub_f32 v70, v70, v21
v_sub_f32 v71, v71, v21
v_exp_f32 v56, v56
v_exp_f32 v57, v57
v_exp_f32 v58, v58
v_exp_f32 v59, v59
v_exp_f32 v60, v60
v_exp_f32 v61, v61
v_exp_f32 v62, v62
v_exp_f32 v63, v63
v_exp_f32 v64, v64
v_exp_f32 v65, v65
v_exp_f32 v66, v66
v_exp_f32 v67, v67
v_exp_f32 v68, v68
v_exp_f32 v69, v69
v_exp_f32 v70, v70
v_exp_f32 v71, v71
v_cvt_pk_bf16_f32 v80, v56, v57
v_cvt_pk_bf16_f32 v81, v58, v59
v_cvt_pk_bf16_f32 v82, v60, v61
v_cvt_pk_bf16_f32 v83, v62, v63
v_cvt_pk_bf16_f32 v84, v64, v65
v_cvt_pk_bf16_f32 v85, v66, v67
v_cvt_pk_bf16_f32 v86, v68, v69
v_cvt_pk_bf16_f32 v87, v70, v71
v_mfma_f32_32x32x16_bf16 v[104:119], v[24:27], v[80:83], v[104:119]
s_nop 0
v_mfma_f32_32x32x16_bf16 v[104:119], v[28:31], v[84:87], v[104:119]
ds_read_b128 v[16:19], v6 offset:12480
ds_read_b128 v[24:27], v121 offset:12480
ds_read_b128 v[28:31], v122 offset:12480
s_waitcnt lgkmcnt(0)
v_mfma_f32_32x32x16_bf16 v[40:55], v[16:19], v[8:11], 0
v_mfma_f32_32x32x16_bf16 v[56:71], v[16:19], v[12:15], 0
s_nop 10
v_sub_f32 v40, v40, v20
v_sub_f32 v41, v41, v20
v_sub_f32 v42, v42, v20
v_sub_f32 v43, v43, v20
v_sub_f32 v44, v44, v20
v_sub_f32 v45, v45, v20
v_sub_f32 v46, v46, v20
v_sub_f32 v47, v47, v20
v_sub_f32 v48, v48, v20
v_sub_f32 v49, v49, v20
v_sub_f32 v50, v50, v20
v_sub_f32 v51, v51, v20
v_sub_f32 v52, v52, v20
v_sub_f32 v53, v53, v20
v_sub_f32 v54, v54, v20
v_sub_f32 v55, v55, v20
v_exp_f32 v40, v40
v_exp_f32 v41, v41
v_exp_f32 v42, v42
v_exp_f32 v43, v43
v_exp_f32 v44, v44
v_exp_f32 v45, v45
v_exp_f32 v46, v46
v_exp_f32 v47, v47
v_exp_f32 v48, v48
v_exp_f32 v49, v49
v_exp_f32 v50, v50
v_exp_f32 v51, v51
v_exp_f32 v52, v52
v_exp_f32 v53, v53
v_exp_f32 v54, v54
v_exp_f32 v55, v55
v_cvt_pk_bf16_f32 v72, v40, v41
v_cvt_pk_bf16_f32 v73, v42, v43
v_cvt_pk_bf16_f32 v74, v44, v45
v_cvt_pk_bf16_f32 v75, v46, v47
v_cvt_pk_bf16_f32 v76, v48, v49
v_cvt_pk_bf16_f32 v77, v50, v51
v_cvt_pk_bf16_f32 v78, v52, v53
v_cvt_pk_bf16_f32 v79, v54, v55
v_mfma_f32_32x32x16_bf16 v[88:103], v[24:27], v[72:75], v[88:103]
s_nop 0
v_mfma_f32_32x32x16_bf16 v[88:103], v[28:31], v[76:79], v[88:103]
v_sub_f32 v56, v56, v21
v_sub_f32 v57, v57, v21
v_sub_f32 v58, v58, v21
v_sub_f32 v59, v59, v21
v_sub_f32 v60, v60, v21
v_sub_f32 v61, v61, v21
v_sub_f32 v62, v62, v21
v_sub_f32 v63, v63, v21
v_sub_f32 v64, v64, v21
v_sub_f32 v65, v65, v21
v_sub_f32 v66, v66, v21
v_sub_f32 v67, v67, v21
v_sub_f32 v68, v68, v21
v_sub_f32 v69, v69, v21
v_sub_f32 v70, v70, v21
v_sub_f32 v71, v71, v21
v_exp_f32 v56, v56
v_exp_f32 v57, v57
v_exp_f32 v58, v58
v_exp_f32 v59, v59
v_exp_f32 v60, v60
v_exp_f32 v61, v61
v_exp_f32 v62, v62
v_exp_f32 v63, v63
v_exp_f32 v64, v64
v_exp_f32 v65, v65
v_exp_f32 v66, v66
v_exp_f32 v67, v67
v_exp_f32 v68, v68
v_exp_f32 v69, v69
v_exp_f32 v70, v70
v_exp_f32 v71, v71
v_cvt_pk_bf16_f32 v80, v56, v57
v_cvt_pk_bf16_f32 v81, v58, v59
v_cvt_pk_bf16_f32 v82, v60, v61
v_cvt_pk_bf16_f32 v83, v62, v63
v_cvt_pk_bf16_f32 v84, v64, v65
v_cvt_pk_bf16_f32 v85, v66, v67
v_cvt_pk_bf16_f32 v86, v68, v69
v_cvt_pk_bf16_f32 v87, v70, v71
v_mfma_f32_32x32x16_bf16 v[104:119], v[24:27], v[80:83], v[104:119]
s_nop 0
v_mfma_f32_32x32x16_bf16 v[104:119], v[28:31], v[84:87], v[104:119]
ds_read_b128 v[16:19], v6 offset:14560
ds_read_b128 v[24:27], v121 offset:14560
ds_read_b128 v[28:31], v122 offset:14560
s_waitcnt lgkmcnt(0)
v_mfma_f32_32x32x16_bf16 v[40:55], v[16:19], v[8:11], 0
v_mfma_f32_32x32x16_bf16 v[56:71], v[16:19], v[12:15], 0
s_nop 10
v_sub_f32 v40, v40, v20
v_sub_f32 v41, v41, v20
v_sub_f32 v42, v42, v20
v_sub_f32 v43, v43, v20
v_sub_f32 v44, v44, v20
v_sub_f32 v45, v45, v20
v_sub_f32 v46, v46, v20
v_sub_f32 v47, v47, v20
v_sub_f32 v48, v48, v20
v_sub_f32 v49, v49, v20
v_sub_f32 v50, v50, v20
v_sub_f32 v51, v51, v20
v_sub_f32 v52, v52, v20
v_sub_f32 v53, v53, v20
v_sub_f32 v54, v54, v20
v_sub_f32 v55, v55, v20
v_exp_f32 v40, v40
v_exp_f32 v41, v41
v_exp_f32 v42, v42
v_exp_f32 v43, v43
v_exp_f32 v44, v44
v_exp_f32 v45, v45
v_exp_f32 v46, v46
v_exp_f32 v47, v47
v_exp_f32 v48, v48
v_exp_f32 v49, v49
v_exp_f32 v50, v50
v_exp_f32 v51, v51
v_exp_f32 v52, v52
v_exp_f32 v53, v53
v_exp_f32 v54, v54
v_exp_f32 v55, v55
v_cvt_pk_bf16_f32 v72, v40, v41
v_cvt_pk_bf16_f32 v73, v42, v43
v_cvt_pk_bf16_f32 v74, v44, v45
v_cvt_pk_bf16_f32 v75, v46, v47
v_cvt_pk_bf16_f32 v76, v48, v49
v_cvt_pk_bf16_f32 v77, v50, v51
v_cvt_pk_bf16_f32 v78, v52, v53
v_cvt_pk_bf16_f32 v79, v54, v55
v_mfma_f32_32x32x16_bf16 v[88:103], v[24:27], v[72:75], v[88:103]
s_nop 0
v_mfma_f32_32x32x16_bf16 v[88:103], v[28:31], v[76:79], v[88:103]
v_sub_f32 v56, v56, v21
v_sub_f32 v57, v57, v21
v_sub_f32 v58, v58, v21
v_sub_f32 v59, v59, v21
v_sub_f32 v60, v60, v21
v_sub_f32 v61, v61, v21
v_sub_f32 v62, v62, v21
v_sub_f32 v63, v63, v21
v_sub_f32 v64, v64, v21
v_sub_f32 v65, v65, v21
v_sub_f32 v66, v66, v21
v_sub_f32 v67, v67, v21
v_sub_f32 v68, v68, v21
v_sub_f32 v69, v69, v21
v_sub_f32 v70, v70, v21
v_sub_f32 v71, v71, v21
v_exp_f32 v56, v56
v_exp_f32 v57, v57
v_exp_f32 v58, v58
v_exp_f32 v59, v59
v_exp_f32 v60, v60
v_exp_f32 v61, v61
v_exp_f32 v62, v62
v_exp_f32 v63, v63
v_exp_f32 v64, v64
v_exp_f32 v65, v65
v_exp_f32 v66, v66
v_exp_f32 v67, v67
v_exp_f32 v68, v68
v_exp_f32 v69, v69
v_exp_f32 v70, v70
v_exp_f32 v71, v71
v_cvt_pk_bf16_f32 v80, v56, v57
v_cvt_pk_bf16_f32 v81, v58, v59
v_cvt_pk_bf16_f32 v82, v60, v61
v_cvt_pk_bf16_f32 v83, v62, v63
v_cvt_pk_bf16_f32 v84, v64, v65
v_cvt_pk_bf16_f32 v85, v66, v67
v_cvt_pk_bf16_f32 v86, v68, v69
v_cvt_pk_bf16_f32 v87, v70, v71
v_mfma_f32_32x32x16_bf16 v[104:119], v[24:27], v[80:83], v[104:119]
s_nop 0
v_mfma_f32_32x32x16_bf16 v[104:119], v[28:31], v[84:87], v[104:119]
s_sub_u32 s52, s52, 1
s_cmp_lg_u32 s52, 0
s_nop 9
s_cbranch_scc1 L_fb2
s_barrier
s_mul_i32 s87, s3, 16384
s_add_u32 m0, s87, 66560
s_nop 0
buffer_load_dwordx4 v140, s[16:19], s84 offen lds
buffer_load_dwordx4 v141, s[16:19], s84 offen offset:1024 lds
s_add_u32 s84, s84, 16384
s_add_u32 m0, s87, 68608
s_nop 0
buffer_load_dwordx4 v140, s[16:19], s84 offen lds
buffer_load_dwordx4 v141, s[16:19], s84 offen offset:1024 lds
s_add_u32 s84, s84, 16384
s_add_u32 m0, s87, 70656
s_nop 0
buffer_load_dwordx4 v140, s[16:19], s84 offen lds
buffer_load_dwordx4 v141, s[16:19], s84 offen offset:1024 lds
s_add_u32 s84, s84, 16384
s_add_u32 m0, s87, 72704
s_nop 0
buffer_load_dwordx4 v140, s[16:19], s84 offen lds
buffer_load_dwordx4 v141, s[16:19], s84 offen offset:1024 lds
s_add_u32 s84, s84, 16384
s_add_u32 m0, s87, 74752
s_nop 0
buffer_load_dwordx4 v140, s[16:19], s84 offen lds
buffer_load_dwordx4 v141, s[16:19], s84 offen offset:1024 lds
s_add_u32 s84, s84, 16384
s_add_u32 m0, s87, 76800
s_nop 0
buffer_load_dwordx4 v140, s[16:19], s84 offen lds
buffer_load_dwordx4 v141, s[16:19], s84 offen offset:1024 lds
s_add_u32 s84, s84, 16384
s_add_u32 m0, s87, 78848
s_nop 0
buffer_load_dwordx4 v140, s[16:19], s84 offen lds
buffer_load_dwordx4 v141, s[16:19], s84 offen offset:1024 lds
s_add_u32 s84, s84, 16384
s_add_u32 m0, s87, 80896
s_nop 0
buffer_load_dwordx4 v140, s[16:19], s84 offen lds
buffer_load_dwordx4 v141, s[16:19], s84 offen offset:1024 lds
s_add_u32 s84, s84, 16384
buffer_load_dwordx4 a[0:3], v136, s[20:23], s85 offen
buffer_load_dwordx4 a[4:7], v137, s[20:23], s85 offen
s_add_u32 s85, s85, 44032
buffer_load_dwordx4 a[8:11], v136, s[20:23], s85 offen
buffer_load_dwordx4 a[12:15], v137, s[20:23], s85 offen
s_add_u32 s85, s85, 44032
buffer_load_dwordx4 a[16:19], v136, s[20:23], s85 offen
buffer_load_dwordx4 a[20:23], v137, s[20:23], s85 offen
s_add_u32 s85, s85, 44032
buffer_load_dwordx4 a[24:27], v136, s[20:23], s85 offen
buffer_load_dwordx4 a[28:31], v137, s[20:23], s85 offen
s_add_u32 s85, s85, 44032
buffer_load_dwordx4 a[32:35], v136, s[20:23], s85 offen
buffer_load_dwordx4 a[36:39], v137, s[20:23], s85 offen
s_add_u32 s85, s85, 44032
buffer_load_dwordx4 a[40:43], v136, s[20:23], s85 offen
buffer_load_dwordx4 a[44:47], v137, s[20:23], s85 offen
s_add_u32 s85, s85, 44032
buffer_load_dwordx4 a[48:51], v136, s[20:23], s85 offen
buffer_load_dwordx4 a[52:55], v137, s[20:23], s85 offen
s_add_u32 s85, s85, 44032
buffer_load_dwordx4 a[56:59], v136, s[20:23], s85 offen
buffer_load_dwordx4 a[60:63], v137, s[20:23], s85 offen
s_add_u32 s85, s85, 44032
buffer_load_dwordx4 a[64:67], v136, s[20:23], s85 offen
buffer_load_dwordx4 a[68:71], v137, s[20:23], s85 offen
s_add_u32 s85, s85, 44032
buffer_load_dwordx4 a[72:75], v136, s[20:23], s85 offen
buffer_load_dwordx4 a[76:79], v137, s[20:23], s85 offen
s_add_u32 s85, s85, 44032
buffer_load_dwordx4 a[80:83], v136, s[20:23], s85 offen
buffer_load_dwordx4 a[84:87], v137, s[20:23], s85 offen
s_add_u32 s85, s85, 44032
buffer_load_dwordx4 a[88:91], v136, s[20:23], s85 offen
buffer_load_dwordx4 a[92:95], v137, s[20:23], s85 offen
s_add_u32 s85, s85, 44032
buffer_load_dwordx4 a[96:99], v136, s[20:23], s85 offen
buffer_load_dwordx4 a[100:103], v137, s[20:23], s85 offen
s_add_u32 s85, s85, 44032
s_waitcnt vmcnt(0)
buffer_load_dwordx4 a[104:107], v136, s[20:23], s85 offen
buffer_load_dwordx4 a[108:111], v137, s[20:23], s85 offen
s_add_u32 s85, s85, 44032
buffer_load_dwordx4 a[112:115], v136, s[20:23], s85 offen
buffer_load_dwordx4 a[116:119], v137, s[20:23], s85 offen
s_add_u32 s85, s85, 44032
buffer_load_dwordx4 a[120:123], v136, s[20:23], s85 offen
buffer_load_dwordx4 a[124:127], v137, s[20:23], s85 offen
s_add_u32 s85, s85, 44032
buffer_load_dwordx4 a[128:131], v136, s[20:23], s85 offen
buffer_load_dwordx4 a[132:135], v137, s[20:23], s85 offen
s_add_u32 s85, s85, 44032
buffer_load_dwordx4 a[136:139], v136, s[20:23], s85 offen
buffer_load_dwordx4 a[140:143], v137, s[20:23], s85 offen
s_add_u32 s85, s85, 44032
buffer_load_dwordx4 a[144:147], v136, s[20:23], s85 offen
buffer_load_dwordx4 a[148:151], v137, s[20:23], s85 offen
s_add_u32 s85, s85, 44032
buffer_load_dwordx4 a[152:155], v136, s[20:23], s85 offen
buffer_load_dwordx4 a[156:159], v137, s[20:23], s85 offen
s_add_u32 s85, s85, 44032
buffer_load_dwordx4 a[160:163], v136, s[20:23], s85 offen
buffer_load_dwordx4 a[164:167], v137, s[20:23], s85 offen
s_add_u32 s85, s85, 44032
buffer_load_dwordx4 a[168:171], v136, s[20:23], s85 offen
buffer_load_dwordx4 a[172:175], v137, s[20:23], s85 offen
s_add_u32 s85, s85, 44032
buffer_load_dwordx4 a[176:179], v136, s[20:23], s85 offen
buffer_load_dwordx4 a[180:183], v137, s[20:23], s85 offen
s_add_u32 s85, s85, 44032
buffer_load_dwordx4 a[184:187], v136, s[20:23], s85 offen
buffer_load_dwordx4 a[188:191], v137, s[20:23], s85 offen
s_add_u32 s85, s85, 44032
buffer_load_dwordx4 a[192:195], v136, s[20:23], s85 offen
buffer_load_dwordx4 a[196:199], v137, s[20:23], s85 offen
s_add_u32 s85, s85, 44032
buffer_load_dwordx4 a[200:203], v136, s[20:23], s85 offen
buffer_load_dwordx4 a[204:207], v137, s[20:23], s85 offen
s_add_u32 s85, s85, 44032
buffer_load_dwordx4 a[208:211], v136, s[20:23], s85 offen
buffer_load_dwordx4 a[212:215], v137, s[20:23], s85 offen
s_add_u32 s85, s85, 44032
buffer_load_dwordx4 a[216:219], v136, s[20:23], s85 offen
buffer_load_dwordx4 a[220:223], v137, s[20:23], s85 offen
s_add_u32 s85, s85, 44032
buffer_load_dwordx4 a[224:227], v136, s[20:23], s85 offen
buffer_load_dwordx4 a[228:231], v137, s[20:23], s85 offen
s_add_u32 s85, s85, 44032
buffer_load_dwordx4 a[232:235], v136, s[20:23], s85 offen
buffer_load_dwordx4 a[236:239], v137, s[20:23], s85 offen
s_add_u32 s85, s85, 44032
buffer_load_dwordx4 a[240:243], v136, s[20:23], s85 offen
buffer_load_dwordx4 a[244:247], v137, s[20:23], s85 offen
s_add_u32 s85, s85, 44032
buffer_load_dwordx4 a[248:251], v136, s[20:23], s85 offen
buffer_load_dwordx4 a[252:255], v137, s[20:23], s85 offen
s_add_u32 s85, s85, 44032
buffer_load_dwordx4 v[152:155], v138, s[24:27], s86 offen
buffer_load_dwordx4 v[156:159], v139, s[24:27], s86 offen offset:1024
s_add_u32 s86, s86, 65536
buffer_load_dwordx4 v[160:163], v138, s[24:27], s86 offen
buffer_load_dwordx4 v[164:167], v139, s[24:27], s86 offen offset:1024
s_add_u32 s86, s86, 65536
s_waitcnt vmcnt(0)
buffer_load_dwordx4 v[168:171], v138, s[24:27], s86 offen
buffer_load_dwordx4 v[172:175], v139, s[24:27], s86 offen offset:1024
s_add_u32 s86, s86, 65536
buffer_load_dwordx4 v[176:179], v138, s[24:27], s86 offen
buffer_load_dwordx4 v[180:183], v139, s[24:27], s86 offen offset:1024
s_add_u32 s86, s86, 65536
buffer_load_dwordx4 v[184:187], v138, s[24:27], s86 offen
buffer_load_dwordx4 v[188:191], v139, s[24:27], s86 offen offset:1024
s_add_u32 s86, s86, 65536
buffer_load_dwordx4 v[192:195], v138, s[24:27], s86 offen
buffer_load_dwordx4 v[196:199], v139, s[24:27], s86 offen offset:1024
s_add_u32 s86, s86, 65536
buffer_load_dwordx4 v[200:203], v138, s[24:27], s86 offen
buffer_load_dwordx4 v[204:207], v139, s[24:27], s86 offen offset:1024
s_add_u32 s86, s86, 65536
buffer_load_dwordx4 v[208:211], v138, s[24:27], s86 offen
buffer_load_dwordx4 v[212:215], v139, s[24:27], s86 offen offset:1024
s_add_u32 s86, s86, 65536
buffer_load_dwordx4 v[216:219], v138, s[24:27], s86 offen
buffer_load_dwordx4 v[220:223], v139, s[24:27], s86 offen offset:1024
s_add_u32 s86, s86, 65536
buffer_load_dwordx4 v[224:227], v138, s[24:27], s86 offen
buffer_load_dwordx4 v[228:231], v139, s[24:27], s86 offen offset:1024
s_add_u32 s86, s86, 65536
buffer_load_dwordx4 v[232:235], v138, s[24:27], s86 offen
buffer_load_dwordx4 v[236:239], v139, s[24:27], s86 offen offset:1024
s_add_u32 s86, s86, 65536
buffer_load_dwordx4 v[240:243], v138, s[24:27], s86 offen
buffer_load_dwordx4 v[244:247], v139, s[24:27], s86 offen offset:1024
s_add_u32 s86, s86, 65536
buffer_load_dwordx4 v[248:251], v138, s[24:27], s86 offen
buffer_load_dwordx4 v[252:255], v139, s[24:27], s86 offen offset:1024
s_add_u32 s86, s86, 65536
s_mul_i32 s87, s3, 6144
s_add_u32 m0, s87, 132096
s_nop 0
buffer_load_dwordx4 v138, s[24:27], s86 offen lds
buffer_load_dwordx4 v139, s[24:27], s86 offen offset:1024 lds
s_add_u32 s86, s86, 65536
s_add_u32 m0, s87, 134144
s_nop 0
buffer_load_dwordx4 v138, s[24:27], s86 offen lds
buffer_load_dwordx4 v139, s[24:27], s86 offen offset:1024 lds
s_add_u32 s86, s86, 65536
s_add_u32 m0, s87, 136192
s_nop 0
buffer_load_dwordx4 v138, s[24:27], s86 offen lds
buffer_load_dwordx4 v139, s[24:27], s86 offen offset:1024 lds
s_add_u32 s86, s86, 65536
s_lshl_b32 s87, s3, 12
s_add_u32 m0, s87, 0
s_nop 0
buffer_load_dwordx4 v138, s[24:27], s86 offen lds
buffer_load_dwordx4 v139, s[24:27], s86 offen offset:1024 lds
s_add_u32 s86, s86, 65536
s_add_u32 m0, s87, 2048
s_nop 0
buffer_load_dwordx4 v138, s[24:27], s86 offen lds
buffer_load_dwordx4 v139, s[24:27], s86 offen offset:1024 lds
s_add_u32 s86, s86, 65536
s_add_u32 m0, s87, 16640
s_nop 0
buffer_load_dwordx4 v138, s[24:27], s86 offen lds
buffer_load_dwordx4 v139, s[24:27], s86 offen offset:1024 lds
s_add_u32 s86, s86, 65536
s_add_u32 m0, s87, 18688
s_nop 0
buffer_load_dwordx4 v138, s[24:27], s86 offen lds
buffer_load_dwordx4 v139, s[24:27], s86 offen offset:1024 lds
s_add_u32 s86, s86, 65536
buffer_load_dwordx2 v[144:145], v142, s[8:11], s78 offen offset:0
buffer_load_dwordx2 v[146:147], v142, s[8:11], s78 offen offset:16
buffer_load_dwordx2 v[148:149], v142, s[8:11], s78 offen offset:32
buffer_load_dwordx2 v[150:151], v142, s[8:11], s78 offen offset:48
v_lshrrev_b32 v1, 5, v0
v_lshlrev_b32 v1, 3, v1
buffer_load_dwordx2 v[136:137], v1, s[28:31], s73 offen offset:0
buffer_load_dwordx2 v[140:141], v1, s[28:31], s73 offen offset:16
buffer_load_dwordx2 v[142:143], v1, s[28:31], s73 offen offset:32
buffer_load_dwordx2 v[126:127], v1, s[28:31], s73 offen offset:48
v_and_b32 v2, 31, v0
v_lshlrev_b32 v2, 1, v2
buffer_load_ushort v125, v2, s[32:35], s77 offen
s_waitcnt vmcnt(0)
s_waitcnt vmcnt(0)
s_branch L_attn_epi
L_exit:
s_endpgm
.section .rodata,"a"
.p2align 6
.amdhsa_kernel sequential_preLN__mha_block__mixer_token_mlp__prompt_kernel
  .amdhsa_next_free_vgpr 512
  .amdhsa_next_free_sgpr 102
  .amdhsa_accum_offset 256
  .amdhsa_group_segment_fixed_size 0
  .amdhsa_kernarg_size 88
  .amdhsa_user_sgpr_count 2
  .amdhsa_user_sgpr_kernarg_segment_ptr 1
  .amdhsa_system_sgpr_workgroup_id_x 1
.end_amdhsa_kernel
```
